```python
import torch

def _softmax(x, axis=-1):
    return torch.softmax(x, dim=axis)
def _gelu(x):
    return torch.nn.functional.gelu(x, approximate="tanh")
def _silu(x):
    return torch.nn.functional.silu(x)
def _sigmoid(x):
    return torch.sigmoid(x)
def _layernorm(x, axis=-1, eps=1e-5):
    m = x.mean(dim=axis, keepdim=True)
    v = x.var(dim=axis, keepdim=True, unbiased=False)
    return (x - m) / torch.sqrt(v + eps)
def _scatter_add(tgt, idx, src, axis=0):
    return tgt.clone().index_add_(axis, idx, src)
def _segment_sum(src, seg, n):
    out = torch.zeros((n,) + src.shape[1:], dtype=src.dtype)
    return out.index_add_(0, seg, src)
def _pad(x, pw):
    flat = tuple(v for pair in reversed(pw) for v in pair)
    return torch.nn.functional.pad(x, flat)

kernel_name = 'sequential_preLN__softmax_full_mha__glu_gated_swiglu__prompt'

def setup_inputs():

    _w = (lambda a: (lambda t: t.to(torch.bfloat16) if t.is_floating_point() else t)(torch.as_tensor(a)))
    def _A_setup():
        B, S, D = 1, 2048, 640
        return {
            "x": _w((lambda *s: torch.randn(*s, dtype=torch.bfloat16) * 0.05)(B, S, D)),
            "wqkv": _w((lambda *s: torch.randn(*s, dtype=torch.bfloat16) * 0.05)(D, 3 * D)),
            "wo": _w((lambda *s: torch.randn(*s, dtype=torch.bfloat16) * 0.05)(D, D)),
        }
    _A_in = _A_setup()

    def _B_setup():
        B, S, D, F = 1, 2048, 640, 1728
        return {
            "x": _w((lambda *s: torch.randn(*s, dtype=torch.bfloat16) * 0.05)(B, S, D)),
            "w1": _w((lambda *s: torch.randn(*s, dtype=torch.bfloat16) * 0.4)(D, F) * (2.0 / D) ** 0.5),
            "w3": _w((lambda *s: torch.randn(*s, dtype=torch.bfloat16) * 0.4)(D, F) * (2.0 / D) ** 0.5),
            "w2": _w((lambda *s: torch.randn(*s, dtype=torch.bfloat16) * 0.4)(F, D) * (2.0 / F) ** 0.5),
        }
    _B_in = _B_setup()

    return {
        "A_x": _A_in["x"],
        "A_wqkv": _A_in["wqkv"],
        "A_wo": _A_in["wo"],
        "B_x": _B_in["x"],
        "B_w1": _B_in["w1"],
        "B_w3": _B_in["w3"],
        "B_w2": _B_in["w2"],
    }

def reference(A_x, A_wqkv, A_wo, B_x, B_w1, B_w3, B_w2):
    def _A_ref(x, wqkv, wo):
        B, S, D = x.shape
        H = 32; Dh = D // H
        qkv = (lambda x, *d: x.permute(*d))((x @ wqkv).reshape(B, S, 3, H, Dh), 2, 0, 3, 1, 4)
        q, k, v = qkv[0], qkv[1], qkv[2]
        scale = Dh ** -0.5
        scores = torch.einsum("bhqd,bhkd->bhqk", q, k) * scale
        p = _softmax(scores, axis=-1)
        o = torch.einsum("bhqk,bhkd->bhqd", p, v)
        return (lambda x, *d: x.permute(*d))(o, 0, 2, 1, 3).reshape(B, S, D) @ wo

    def _B_ref(x, w1, w3, w2):
        gate = torch.einsum("bsd,df->bsf", x, w1)
        up = torch.einsum("bsd,df->bsf", x, w3)
        h = _silu(gate) * up
        out = torch.einsum("bsf,fd->bsd", h, w2)
        return out

    x = A_x
    h = x + _A_ref(_layernorm(x, axis=-1), A_wqkv, A_wo)
    h2 = h + _B_ref(_layernorm(h, axis=-1), B_w1, B_w3, B_w2)
    return h2
```

```asm
; @launch grid=(1280,1,1) block=(512,1,1) lds=163840
.amdgcn_target "amdgcn-amd-amdhsa--gfx950"
.text
.globl sequential_preLN__softmax_full_mha__glu_gated_swiglu__prompt_kernel
.p2align 8
.type sequential_preLN__softmax_full_mha__glu_gated_swiglu__prompt_kernel,@function
sequential_preLN__softmax_full_mha__glu_gated_swiglu__prompt_kernel:
  s_cmp_ge_u32 s2, 256
  s_cbranch_scc1 L_mega_disp
qkv_kernel:
  s_load_dwordx4 s[4:7], s[0:1], 0
  s_load_dwordx2 s[36:37], s[0:1], 72
  s_load_dwordx2 s[34:35], s[0:1], 64
  s_cmp_lg_u32 s2, 0
  s_cbranch_scc1 L_qkv_kernel_nononce_2
  v_readfirstlane_b32 s56, v0
  s_nop 3
  s_cmp_ge_u32 s56, 64
  s_cbranch_scc1 L_qkv_kernel_nononce_2
  s_memrealtime s[56:57]
  s_load_dwordx2 s[58:59], s[0:1], 64
  s_waitcnt lgkmcnt(0)
  s_or_b32 s100, s56, 1
  s_mov_b32 s60, s58
  s_and_b32 s61, s59, 0xffff
  s_mov_b32 s62, 256
  s_mov_b32 s63, 0x20000
  s_mov_b64 exec, 1
  v_mov_b32 v10, 0
  v_mov_b32 v11, s100
  buffer_store_dword v11, v10, s[60:63], 0 offen sc1
  s_mov_b64 exec, -1
L_qkv_kernel_nononce_2:
  s_and_b32 s22, s2, 7
  s_lshr_b32 s23, s2, 3
  s_lshr_b32 s24, s22, 1
  s_lshl_b32 s24, s24, 2
  s_and_b32 s25, s23, 3
  s_add_u32 s19, s24, s25
  s_and_b32 s24, s22, 1
  s_lshl_b32 s24, s24, 3
  s_lshr_b32 s25, s23, 2
  s_add_u32 s20, s24, s25
  s_cmp_ge_u32 s20, 15
  s_cbranch_scc1 L_qkv_kernel_colsum_3
  v_and_b32 v1, 63, v0
  v_lshrrev_b32 v2, 6, v0
  s_nop 0
  v_readfirstlane_b32 s16, v2
  v_lshrrev_b32 v2, 3, v1
  v_lshrrev_b32 v3, 4, v1
  v_and_b32 v4, 7, v1
  v_xor_b32 v5, v4, v3
  v_xor_b32 v6, 4, v5
  s_lshl_b32 s22, s16, 4
  v_add_u32 v2, s22, v2
  v_mul_u32_u24 v2, 1280, v2
  v_lshl_add_u32 v12, v5, 4, v2
  v_lshl_add_u32 v13, v6, 4, v2
  v_add_u32 v13, 10240, v13
  v_bfe_u32 v4, v1, 2, 2
  v_and_b32 v5, 3, v3
  v_xor_b32 v4, v4, v5
  v_and_b32 v5, 3, v1
  v_lshl_add_u32 v4, v4, 2, v5
  s_lshl_b32 s22, s16, 3
  v_add_u32 v3, s22, v3
  v_mul_u32_u24 v3, 3840, v3
  v_lshl_add_u32 v14, v4, 4, v3
  s_mul_i32 s26, s19, 163840
  s_lshl_b32 s27, s20, 8
  s_lshl_b32 s28, s16, 11
  s_lshr_b32 s17, s16, 2
  s_and_b32 s18, s16, 3
  s_waitcnt lgkmcnt(0)
  s_mov_b32 s8, s4
  s_and_b32 s9, s5, 0xffff
  s_mov_b32 s10, 2621440
  s_mov_b32 s11, 0x20000
  s_mov_b32 s56, s34
  s_and_b32 s57, s35, 0xffff
  s_mov_b32 s58, 256
  s_mov_b32 s59, 0x20000
  s_mov_b32 s12, s6
  s_and_b32 s13, s7, 0xffff
  s_mov_b32 s14, 2457600
  s_mov_b32 s15, 0x20000
  s_add_u32 m0, s28, 0
  s_add_u32 s30, s26, 0
  buffer_load_dwordx4 v12, s[8:11], s30 offen lds
  s_add_u32 m0, s28, 1024
  s_add_u32 s31, s27, 0
  buffer_load_dwordx4 v13, s[8:11], s30 offen lds
  s_add_u32 m0, s28, 16384
  s_add_u32 s30, s31, 15360
  buffer_load_dwordx4 v14, s[12:15], s31 offen lds
  s_add_u32 m0, s28, 17408
  s_nop 0
  buffer_load_dwordx4 v14, s[12:15], s30 offen lds
  s_add_u32 m0, s28, 32768
  s_add_u32 s30, s26, 128
  buffer_load_dwordx4 v12, s[8:11], s30 offen lds
  s_add_u32 m0, s28, 33792
  s_add_u32 s31, s27, 245760
  buffer_load_dwordx4 v13, s[8:11], s30 offen lds
  s_add_u32 m0, s28, 49152
  s_add_u32 s30, s31, 15360
  buffer_load_dwordx4 v14, s[12:15], s31 offen lds
  s_add_u32 m0, s28, 50176
  s_nop 0
  buffer_load_dwordx4 v14, s[12:15], s30 offen lds
  s_getpc_b64 s[48:49]
L_qkv_kernel_here_4:
  s_lshr_b32 s54, s2, 3
  s_and_b32 s54, s54, 31
  s_lshl_b32 s54, s54, 10
  v_lshrrev_b32 v60, 6, v0
  v_lshlrev_b32 v60, 7, v60
  v_add_u32 v60, s54, v60
  s_mov_b64 s[50:51], exec
  s_mov_b64 exec, 1
  s_sub_u32 s52, s48, 0x100000
  s_subb_u32 s53, s49, 0
  v_min_u32 v59, qkv_kernel_end - qkv_kernel - 4, v60
  v_add_u32 v59, qkv_kernel - L_qkv_kernel_here_4 + 0x100000, v59
  global_load_dword v58, v59, s[52:53]
  v_min_u32 v59, attn_kernel_end - attn_kernel - 4, v60
  v_add_u32 v59, attn_kernel - L_qkv_kernel_here_4 + 0x100000, v59
  global_load_dword v58, v59, s[52:53]
  s_mov_b64 exec, s[50:51]
  s_add_u32 s36, s36, 0
  s_addc_u32 s37, s37, 0
  s_and_b32 s37, s37, 0xffff
  s_mov_b32 s38, 7864320
  s_mov_b32 s39, 0x20000
  s_lshl_b32 s22, s17, 1
  s_add_u32 s22, s22, s18
  v_and_b32 v2, 31, v1
  v_lshrrev_b32 v3, 5, v1
  s_lshl_b32 s23, s17, 6
  v_add_u32 v4, s23, v2
  v_lshlrev_b32 v4, 7, v4
  v_bfe_u32 v5, v1, 1, 3
  v_bfe_u32 v6, v1, 2, 2
  v_lshl_add_u32 v7, v3, 3, v6
  v_lshlrev_b32 v7, 8, v7
  v_xor_b32 v6, s18, v6
  v_lshl_add_u32 v7, v6, 6, v7
  v_bfe_u32 v6, v1, 4, 1
  v_lshl_add_u32 v7, v6, 5, v7
  v_and_b32 v6, 3, v1
  v_lshl_add_u32 v7, v6, 3, v7
  v_add_u32 v7, 16384, v7
  s_add_u32 s23, s22, 0
  s_and_b32 s23, s23, 3
  s_lshl_b32 s24, s23, 1
  s_lshl_b32 s25, s23, 12
  v_add_u32 v6, s24, v3
  v_xor_b32 v6, v6, v5
  v_lshl_add_u32 v15, v6, 4, v4
  v_add_u32 v19, 0x10000, v15
  v_add_u32 v23, s25, v7
  v_add_u32 v27, 0x10000, v23
  s_add_u32 s23, s22, 1
  s_and_b32 s23, s23, 3
  s_lshl_b32 s24, s23, 1
  s_lshl_b32 s25, s23, 12
  v_add_u32 v6, s24, v3
  v_xor_b32 v6, v6, v5
  v_lshl_add_u32 v16, v6, 4, v4
  v_add_u32 v20, 0x10000, v16
  v_add_u32 v24, s25, v7
  v_add_u32 v28, 0x10000, v24
  s_add_u32 s23, s22, 2
  s_and_b32 s23, s23, 3
  s_lshl_b32 s24, s23, 1
  s_lshl_b32 s25, s23, 12
  v_add_u32 v6, s24, v3
  v_xor_b32 v6, v6, v5
  v_lshl_add_u32 v17, v6, 4, v4
  v_add_u32 v21, 0x10000, v17
  v_add_u32 v25, s25, v7
  v_add_u32 v29, 0x10000, v25
  s_add_u32 s23, s22, 3
  s_and_b32 s23, s23, 3
  s_lshl_b32 s24, s23, 1
  s_lshl_b32 s25, s23, 12
  v_add_u32 v6, s24, v3
  v_xor_b32 v6, v6, v5
  v_lshl_add_u32 v18, v6, 4, v4
  v_add_u32 v22, 0x10000, v18
  v_add_u32 v26, s25, v7
  v_add_u32 v30, 0x10000, v26
  v_mov_b32 v32, 0
  v_mov_b32 v33, 0
  v_mov_b32 v34, 0
  v_mov_b32 v35, 0
  v_mov_b32 v36, 0
  v_mov_b32 v37, 0
  v_mov_b32 v38, 0
  v_mov_b32 v39, 0
  v_bfe_u32 v6, v1, 4, 1
  v_bfe_u32 v8, v1, 3, 1
  v_cmp_eq_u32 vcc, v6, v8
  v_mov_b32 v6, 0x3f803f80
  v_mov_b32 v8, 0
  v_cndmask_b32 v44, v8, v6, vcc
  v_cndmask_b32 v45, v8, v6, vcc
  v_cndmask_b32 v46, v8, v6, vcc
  v_cndmask_b32 v47, v8, v6, vcc
  s_mov_b32 s29, 0xffff0000
  s_mul_i32 s21, s20, 52
  s_lshr_b32 s21, s21, 8
  s_cmp_eq_u32 s21, 2
  s_cbranch_scc1 L_qkv_kernel_vpath_5
  v_and_b32 v2, 31, v1
  v_lshrrev_b32 v3, 5, v1
  v_lshlrev_b32 v69, 4, v1
  s_mul_i32 s42, s21, 5
  s_sub_u32 s42, s20, s42
  s_getpc_b64 s[44:45]
L_qkv_kernel_here_7:
  s_add_u32 s44, s44, L_qkv_kernel_tab - L_qkv_kernel_here_7
  s_addc_u32 s45, s45, 0
  s_mul_i32 s46, s42, 640
  s_lshl_b32 s47, s16, 4
  s_add_u32 s46, s46, s47
  s_add_u32 s46, s44, s46
  s_addc_u32 s47, s45, 0
  s_load_dwordx4 s[80:83], s[46:47], 0
  s_load_dwordx4 s[84:87], s[46:47], 128
  s_load_dwordx4 s[88:91], s[46:47], 256
  s_load_dwordx4 s[92:95], s[46:47], 384
  s_load_dwordx4 s[96:99], s[46:47], 512
  s_lshl_b32 s48, s42, 2
  s_add_u32 s48, s48, s18
  s_lshl_b32 s48, s48, 5
  v_lshlrev_b32 v4, 4, v3
  v_add_u32 v4, s48, v4
  s_add_u32 s44, s44, 6400
  s_addc_u32 s45, s45, 0
  global_load_dwordx4 v[72:75], v4, s[44:45]
  s_waitcnt vmcnt(7) lgkmcnt(0)
  s_barrier
  ds_read_b128 v[168:171], v15 offset:0
  ds_read_b64_tr_b16 v[184:185], v23 offset:0
  ds_read_b64_tr_b16 v[186:187], v23 offset:1024
  ds_read_b128 v[172:175], v15 offset:4096
  s_waitcnt lgkmcnt(1)
  v_mfma_f32_32x32x16_bf16 v[88:103], v[184:187], v[168:171], 0
  ds_read_b128 v[152:155], v16 offset:0
  ds_read_b64_tr_b16 v[200:201], v24 offset:0
  v_lshlrev_b32 v78, 16, v168
  v_and_b32 v79, s29, v168
  v_lshlrev_b32 v80, 16, v169
  v_and_b32 v81, s29, v169
  s_waitcnt lgkmcnt(2)
  v_mfma_f32_32x32x16_bf16 v[104:119], v[184:187], v[172:175], 0
  ds_read_b64_tr_b16 v[202:203], v24 offset:1024
  ds_read_b128 v[156:159], v16 offset:4096
  v_fmac_f32 v32, v78, v78
  v_fmac_f32 v34, v79, v79
  v_lshlrev_b32 v82, 16, v170
  v_and_b32 v83, s29, v170
  v_mfma_f32_16x16x32_bf16 v[48:51], v[44:47], v[168:171], 0
  v_mfma_f32_16x16x32_bf16 v[52:55], v[44:47], v[172:175], 0
  v_mfma_f32_16x16x32_bf16 v[40:43], v[44:47], v[184:187], 0
  v_fmac_f32 v32, v80, v80
  v_fmac_f32 v34, v81, v81
  v_lshlrev_b32 v84, 16, v171
  s_add_u32 m0, s28, 65536
  s_add_u32 s30, s26, 256
  buffer_load_dwordx4 v12, s[8:11], s30 offen lds
  s_add_u32 m0, s28, 66560
  s_add_u32 s31, s27, 491520
  buffer_load_dwordx4 v13, s[8:11], s30 offen lds
  s_waitcnt lgkmcnt(1)
  v_mfma_f32_32x32x16_bf16 v[88:103], v[200:203], v[152:155], v[88:103]
  ds_read_b128 v[120:123], v17 offset:0
  ds_read_b64_tr_b16 v[184:185], v25 offset:0
  v_and_b32 v85, s29, v171
  v_fmac_f32 v32, v82, v82
  v_fmac_f32 v34, v83, v83
  v_lshlrev_b32 v78, 16, v172
  s_waitcnt lgkmcnt(2)
  v_mfma_f32_32x32x16_bf16 v[104:119], v[200:203], v[156:159], v[104:119]
  ds_read_b64_tr_b16 v[186:187], v25 offset:1024
  ds_read_b128 v[124:127], v17 offset:4096
  v_and_b32 v79, s29, v172
  v_fmac_f32 v32, v84, v84
  v_fmac_f32 v34, v85, v85
  v_lshlrev_b32 v80, 16, v173
  v_mfma_f32_16x16x32_bf16 v[40:43], v[44:47], v[200:203], v[40:43]
  v_and_b32 v81, s29, v173
  v_fmac_f32 v33, v78, v78
  v_fmac_f32 v35, v79, v79
  s_add_u32 m0, s28, 81920
  s_add_u32 s30, s31, 15360
  buffer_load_dwordx4 v14, s[12:15], s31 offen lds
  s_add_u32 m0, s28, 82944
  s_nop 0
  buffer_load_dwordx4 v14, s[12:15], s30 offen lds
  s_waitcnt lgkmcnt(1)
  v_mfma_f32_32x32x16_bf16 v[88:103], v[184:187], v[120:123], v[88:103]
  ds_read_b128 v[152:155], v18 offset:0
  ds_read_b64_tr_b16 v[200:201], v26 offset:0
  v_lshlrev_b32 v82, 16, v174
  v_and_b32 v83, s29, v174
  v_fmac_f32 v33, v80, v80
  v_fmac_f32 v35, v81, v81
  s_waitcnt lgkmcnt(2)
  v_mfma_f32_32x32x16_bf16 v[104:119], v[184:187], v[124:127], v[104:119]
  ds_read_b64_tr_b16 v[202:203], v26 offset:1024
  ds_read_b128 v[156:159], v18 offset:4096
  v_lshlrev_b32 v84, 16, v175
  v_and_b32 v85, s29, v175
  v_fmac_f32 v33, v82, v82
  v_fmac_f32 v35, v83, v83
  v_fmac_f32 v33, v84, v84
  v_fmac_f32 v35, v85, v85
  s_add_u32 m0, s28, 98304
  s_add_u32 s30, s26, 384
  buffer_load_dwordx4 v12, s[8:11], s30 offen lds
  s_add_u32 m0, s28, 99328
  s_add_u32 s31, s27, 737280
  buffer_load_dwordx4 v13, s[8:11], s30 offen lds
  s_waitcnt vmcnt(9) lgkmcnt(0)
  s_barrier
  v_mfma_f32_32x32x16_bf16 v[88:103], v[200:203], v[152:155], v[88:103]
  ds_read_b128 v[168:171], v15 offset:32768
  ds_read_b64_tr_b16 v[184:185], v23 offset:32768
  v_mfma_f32_32x32x16_bf16 v[104:119], v[200:203], v[156:159], v[104:119]
  ds_read_b64_tr_b16 v[186:187], v23 offset:33792
  ds_read_b128 v[172:175], v15 offset:36864
  s_add_u32 m0, s28, 114688
  s_add_u32 s30, s31, 15360
  buffer_load_dwordx4 v14, s[12:15], s31 offen lds
  s_add_u32 m0, s28, 115712
  s_nop 0
  buffer_load_dwordx4 v14, s[12:15], s30 offen lds
  s_waitcnt lgkmcnt(1)
  v_mfma_f32_32x32x16_bf16 v[88:103], v[184:187], v[168:171], v[88:103]
  ds_read_b128 v[152:155], v16 offset:32768
  ds_read_b64_tr_b16 v[200:201], v24 offset:32768
  v_lshlrev_b32 v78, 16, v168
  v_and_b32 v79, s29, v168
  v_lshlrev_b32 v80, 16, v169
  v_and_b32 v81, s29, v169
  s_waitcnt lgkmcnt(2)
  v_mfma_f32_32x32x16_bf16 v[104:119], v[184:187], v[172:175], v[104:119]
  ds_read_b64_tr_b16 v[202:203], v24 offset:33792
  ds_read_b128 v[156:159], v16 offset:36864
  v_fmac_f32 v32, v78, v78
  v_fmac_f32 v34, v79, v79
  v_lshlrev_b32 v82, 16, v170
  v_and_b32 v83, s29, v170
  v_mfma_f32_16x16x32_bf16 v[48:51], v[44:47], v[168:171], v[48:51]
  v_mfma_f32_16x16x32_bf16 v[52:55], v[44:47], v[172:175], v[52:55]
  v_mfma_f32_16x16x32_bf16 v[40:43], v[44:47], v[184:187], v[40:43]
  v_fmac_f32 v32, v80, v80
  v_fmac_f32 v34, v81, v81
  v_lshlrev_b32 v84, 16, v171
  s_add_u32 m0, s28, 0
  s_add_u32 s30, s26, 512
  buffer_load_dwordx4 v12, s[8:11], s30 offen lds
  s_waitcnt lgkmcnt(1)
  v_mfma_f32_32x32x16_bf16 v[88:103], v[200:203], v[152:155], v[88:103]
  ds_read_b128 v[120:123], v17 offset:32768
  ds_read_b64_tr_b16 v[184:185], v25 offset:32768
  v_and_b32 v85, s29, v171
  v_fmac_f32 v32, v82, v82
  v_fmac_f32 v34, v83, v83
  v_lshlrev_b32 v78, 16, v172
  s_waitcnt lgkmcnt(2)
  v_mfma_f32_32x32x16_bf16 v[104:119], v[200:203], v[156:159], v[104:119]
  ds_read_b64_tr_b16 v[186:187], v25 offset:33792
  ds_read_b128 v[124:127], v17 offset:36864
  v_and_b32 v79, s29, v172
  v_fmac_f32 v32, v84, v84
  v_fmac_f32 v34, v85, v85
  v_lshlrev_b32 v80, 16, v173
  v_mfma_f32_16x16x32_bf16 v[40:43], v[44:47], v[200:203], v[40:43]
  v_and_b32 v81, s29, v173
  v_fmac_f32 v33, v78, v78
  v_fmac_f32 v35, v79, v79
  s_add_u32 m0, s28, 1024
  s_add_u32 s31, s27, 983040
  buffer_load_dwordx4 v13, s[8:11], s30 offen lds
  s_waitcnt lgkmcnt(1)
  v_mfma_f32_32x32x16_bf16 v[88:103], v[184:187], v[120:123], v[88:103]
  ds_read_b128 v[152:155], v18 offset:32768
  ds_read_b64_tr_b16 v[200:201], v26 offset:32768
  v_lshlrev_b32 v82, 16, v174
  v_and_b32 v83, s29, v174
  v_fmac_f32 v33, v80, v80
  v_fmac_f32 v35, v81, v81
  s_waitcnt lgkmcnt(2)
  v_mfma_f32_32x32x16_bf16 v[104:119], v[184:187], v[124:127], v[104:119]
  ds_read_b64_tr_b16 v[202:203], v26 offset:33792
  ds_read_b128 v[156:159], v18 offset:36864
  v_lshlrev_b32 v84, 16, v175
  v_and_b32 v85, s29, v175
  v_fmac_f32 v33, v82, v82
  v_fmac_f32 v35, v83, v83
  v_fmac_f32 v33, v84, v84
  v_fmac_f32 v35, v85, v85
  s_add_u32 m0, s28, 16384
  s_add_u32 s30, s31, 15360
  buffer_load_dwordx4 v14, s[12:15], s31 offen lds
  s_waitcnt vmcnt(7) lgkmcnt(0)
  s_barrier
  v_mfma_f32_32x32x16_bf16 v[88:103], v[200:203], v[152:155], v[88:103]
  ds_read_b128 v[168:171], v19 offset:0
  ds_read_b64_tr_b16 v[184:185], v27 offset:0
  v_mfma_f32_32x32x16_bf16 v[104:119], v[200:203], v[156:159], v[104:119]
  ds_read_b64_tr_b16 v[186:187], v27 offset:1024
  ds_read_b128 v[172:175], v19 offset:4096
  s_add_u32 m0, s28, 17408
  s_nop 0
  buffer_load_dwordx4 v14, s[12:15], s30 offen lds
  s_waitcnt lgkmcnt(1)
  v_mfma_f32_32x32x16_bf16 v[88:103], v[184:187], v[168:171], v[88:103]
  ds_read_b128 v[152:155], v20 offset:0
  ds_read_b64_tr_b16 v[200:201], v28 offset:0
  v_lshlrev_b32 v78, 16, v168
  v_and_b32 v79, s29, v168
  v_lshlrev_b32 v80, 16, v169
  v_and_b32 v81, s29, v169
  s_waitcnt lgkmcnt(2)
  v_mfma_f32_32x32x16_bf16 v[104:119], v[184:187], v[172:175], v[104:119]
  ds_read_b64_tr_b16 v[202:203], v28 offset:1024
  ds_read_b128 v[156:159], v20 offset:4096
  v_fmac_f32 v32, v78, v78
  v_fmac_f32 v34, v79, v79
  v_lshlrev_b32 v82, 16, v170
  v_and_b32 v83, s29, v170
  v_mfma_f32_16x16x32_bf16 v[48:51], v[44:47], v[168:171], v[48:51]
  v_mfma_f32_16x16x32_bf16 v[52:55], v[44:47], v[172:175], v[52:55]
  v_mfma_f32_16x16x32_bf16 v[40:43], v[44:47], v[184:187], v[40:43]
  v_fmac_f32 v32, v80, v80
  v_fmac_f32 v34, v81, v81
  v_lshlrev_b32 v84, 16, v171
  s_add_u32 m0, s28, 32768
  s_add_u32 s30, s26, 640
  buffer_load_dwordx4 v12, s[8:11], s30 offen lds
  s_waitcnt lgkmcnt(1)
  v_mfma_f32_32x32x16_bf16 v[88:103], v[200:203], v[152:155], v[88:103]
  ds_read_b128 v[120:123], v21 offset:0
  ds_read_b64_tr_b16 v[184:185], v29 offset:0
  v_and_b32 v85, s29, v171
  v_fmac_f32 v32, v82, v82
  v_fmac_f32 v34, v83, v83
  v_lshlrev_b32 v78, 16, v172
  s_waitcnt lgkmcnt(2)
  v_mfma_f32_32x32x16_bf16 v[104:119], v[200:203], v[156:159], v[104:119]
  ds_read_b64_tr_b16 v[186:187], v29 offset:1024
  ds_read_b128 v[124:127], v21 offset:4096
  v_and_b32 v79, s29, v172
  v_fmac_f32 v32, v84, v84
  v_fmac_f32 v34, v85, v85
  v_lshlrev_b32 v80, 16, v173
  v_mfma_f32_16x16x32_bf16 v[40:43], v[44:47], v[200:203], v[40:43]
  v_and_b32 v81, s29, v173
  v_fmac_f32 v33, v78, v78
  v_fmac_f32 v35, v79, v79
  s_add_u32 m0, s28, 33792
  s_add_u32 s31, s27, 1228800
  buffer_load_dwordx4 v13, s[8:11], s30 offen lds
  s_waitcnt lgkmcnt(1)
  v_mfma_f32_32x32x16_bf16 v[88:103], v[184:187], v[120:123], v[88:103]
  ds_read_b128 v[152:155], v22 offset:0
  ds_read_b64_tr_b16 v[200:201], v30 offset:0
  v_lshlrev_b32 v82, 16, v174
  v_and_b32 v83, s29, v174
  v_fmac_f32 v33, v80, v80
  v_fmac_f32 v35, v81, v81
  s_waitcnt lgkmcnt(2)
  v_mfma_f32_32x32x16_bf16 v[104:119], v[184:187], v[124:127], v[104:119]
  ds_read_b64_tr_b16 v[202:203], v30 offset:1024
  ds_read_b128 v[156:159], v22 offset:4096
  v_lshlrev_b32 v84, 16, v175
  v_and_b32 v85, s29, v175
  v_fmac_f32 v33, v82, v82
  v_fmac_f32 v35, v83, v83
  v_fmac_f32 v33, v84, v84
  v_fmac_f32 v35, v85, v85
  s_add_u32 m0, s28, 49152
  s_add_u32 s30, s31, 15360
  buffer_load_dwordx4 v14, s[12:15], s31 offen lds
  s_waitcnt vmcnt(7) lgkmcnt(0)
  s_barrier
  v_mfma_f32_32x32x16_bf16 v[88:103], v[200:203], v[152:155], v[88:103]
  ds_read_b128 v[168:171], v19 offset:32768
  ds_read_b64_tr_b16 v[184:185], v27 offset:32768
  v_mfma_f32_32x32x16_bf16 v[104:119], v[200:203], v[156:159], v[104:119]
  ds_read_b64_tr_b16 v[186:187], v27 offset:33792
  ds_read_b128 v[172:175], v19 offset:36864
  s_add_u32 m0, s28, 50176
  s_nop 0
  buffer_load_dwordx4 v14, s[12:15], s30 offen lds
  s_waitcnt lgkmcnt(1)
  v_mfma_f32_32x32x16_bf16 v[88:103], v[184:187], v[168:171], v[88:103]
  ds_read_b128 v[152:155], v20 offset:32768
  ds_read_b64_tr_b16 v[200:201], v28 offset:32768
  v_lshlrev_b32 v78, 16, v168
  v_and_b32 v79, s29, v168
  v_lshlrev_b32 v80, 16, v169
  v_and_b32 v81, s29, v169
  s_waitcnt lgkmcnt(2)
  v_mfma_f32_32x32x16_bf16 v[104:119], v[184:187], v[172:175], v[104:119]
  ds_read_b64_tr_b16 v[202:203], v28 offset:33792
  ds_read_b128 v[156:159], v20 offset:36864
  v_fmac_f32 v32, v78, v78
  v_fmac_f32 v34, v79, v79
  v_lshlrev_b32 v82, 16, v170
  v_and_b32 v83, s29, v170
  v_mfma_f32_16x16x32_bf16 v[48:51], v[44:47], v[168:171], v[48:51]
  v_mfma_f32_16x16x32_bf16 v[52:55], v[44:47], v[172:175], v[52:55]
  v_mfma_f32_16x16x32_bf16 v[40:43], v[44:47], v[184:187], v[40:43]
  v_fmac_f32 v32, v80, v80
  v_fmac_f32 v34, v81, v81
  v_lshlrev_b32 v84, 16, v171
  s_add_u32 m0, s28, 65536
  s_add_u32 s30, s26, 768
  buffer_load_dwordx4 v12, s[8:11], s30 offen lds
  s_waitcnt lgkmcnt(1)
  v_mfma_f32_32x32x16_bf16 v[88:103], v[200:203], v[152:155], v[88:103]
  ds_read_b128 v[120:123], v21 offset:32768
  ds_read_b64_tr_b16 v[184:185], v29 offset:32768
  v_and_b32 v85, s29, v171
  v_fmac_f32 v32, v82, v82
  v_fmac_f32 v34, v83, v83
  v_lshlrev_b32 v78, 16, v172
  s_waitcnt lgkmcnt(2)
  v_mfma_f32_32x32x16_bf16 v[104:119], v[200:203], v[156:159], v[104:119]
  ds_read_b64_tr_b16 v[186:187], v29 offset:33792
  ds_read_b128 v[124:127], v21 offset:36864
  v_and_b32 v79, s29, v172
  v_fmac_f32 v32, v84, v84
  v_fmac_f32 v34, v85, v85
  v_lshlrev_b32 v80, 16, v173
  v_mfma_f32_16x16x32_bf16 v[40:43], v[44:47], v[200:203], v[40:43]
  v_and_b32 v81, s29, v173
  v_fmac_f32 v33, v78, v78
  v_fmac_f32 v35, v79, v79
  s_add_u32 m0, s28, 66560
  s_add_u32 s31, s27, 1474560
  buffer_load_dwordx4 v13, s[8:11], s30 offen lds
  s_waitcnt lgkmcnt(1)
  v_mfma_f32_32x32x16_bf16 v[88:103], v[184:187], v[120:123], v[88:103]
  ds_read_b128 v[152:155], v22 offset:32768
  ds_read_b64_tr_b16 v[200:201], v30 offset:32768
  v_lshlrev_b32 v82, 16, v174
  v_and_b32 v83, s29, v174
  v_fmac_f32 v33, v80, v80
  v_fmac_f32 v35, v81, v81
  s_waitcnt lgkmcnt(2)
  v_mfma_f32_32x32x16_bf16 v[104:119], v[184:187], v[124:127], v[104:119]
  ds_read_b64_tr_b16 v[202:203], v30 offset:33792
  ds_read_b128 v[156:159], v22 offset:36864
  v_lshlrev_b32 v84, 16, v175
  v_and_b32 v85, s29, v175
  v_fmac_f32 v33, v82, v82
  v_fmac_f32 v35, v83, v83
  v_fmac_f32 v33, v84, v84
  v_fmac_f32 v35, v85, v85
  s_add_u32 m0, s28, 81920
  s_add_u32 s30, s31, 15360
  buffer_load_dwordx4 v14, s[12:15], s31 offen lds
  s_waitcnt vmcnt(7) lgkmcnt(0)
  s_barrier
  v_mfma_f32_32x32x16_bf16 v[88:103], v[200:203], v[152:155], v[88:103]
  ds_read_b128 v[168:171], v15 offset:0
  ds_read_b64_tr_b16 v[184:185], v23 offset:0
  v_mfma_f32_32x32x16_bf16 v[104:119], v[200:203], v[156:159], v[104:119]
  ds_read_b64_tr_b16 v[186:187], v23 offset:1024
  ds_read_b128 v[172:175], v15 offset:4096
  s_add_u32 m0, s28, 82944
  s_nop 0
  buffer_load_dwordx4 v14, s[12:15], s30 offen lds
  s_waitcnt lgkmcnt(1)
  v_mfma_f32_32x32x16_bf16 v[88:103], v[184:187], v[168:171], v[88:103]
  ds_read_b128 v[152:155], v16 offset:0
  ds_read_b64_tr_b16 v[200:201], v24 offset:0
  v_lshlrev_b32 v78, 16, v168
  v_and_b32 v79, s29, v168
  v_lshlrev_b32 v80, 16, v169
  v_and_b32 v81, s29, v169
  s_waitcnt lgkmcnt(2)
  v_mfma_f32_32x32x16_bf16 v[104:119], v[184:187], v[172:175], v[104:119]
  ds_read_b64_tr_b16 v[202:203], v24 offset:1024
  ds_read_b128 v[156:159], v16 offset:4096
  v_fmac_f32 v32, v78, v78
  v_fmac_f32 v34, v79, v79
  v_lshlrev_b32 v82, 16, v170
  v_and_b32 v83, s29, v170
  v_mfma_f32_16x16x32_bf16 v[48:51], v[44:47], v[168:171], v[48:51]
  v_mfma_f32_16x16x32_bf16 v[52:55], v[44:47], v[172:175], v[52:55]
  v_mfma_f32_16x16x32_bf16 v[40:43], v[44:47], v[184:187], v[40:43]
  v_fmac_f32 v32, v80, v80
  v_fmac_f32 v34, v81, v81
  v_lshlrev_b32 v84, 16, v171
  s_add_u32 m0, s28, 98304
  s_add_u32 s30, s26, 896
  buffer_load_dwordx4 v12, s[8:11], s30 offen lds
  s_waitcnt lgkmcnt(1)
  v_mfma_f32_32x32x16_bf16 v[88:103], v[200:203], v[152:155], v[88:103]
  ds_read_b128 v[120:123], v17 offset:0
  ds_read_b64_tr_b16 v[184:185], v25 offset:0
  v_and_b32 v85, s29, v171
  v_fmac_f32 v32, v82, v82
  v_fmac_f32 v34, v83, v83
  v_lshlrev_b32 v78, 16, v172
  s_waitcnt lgkmcnt(2)
  v_mfma_f32_32x32x16_bf16 v[104:119], v[200:203], v[156:159], v[104:119]
  ds_read_b64_tr_b16 v[186:187], v25 offset:1024
  ds_read_b128 v[124:127], v17 offset:4096
  v_and_b32 v79, s29, v172
  v_fmac_f32 v32, v84, v84
  v_fmac_f32 v34, v85, v85
  v_lshlrev_b32 v80, 16, v173
  v_mfma_f32_16x16x32_bf16 v[40:43], v[44:47], v[200:203], v[40:43]
  v_and_b32 v81, s29, v173
  v_fmac_f32 v33, v78, v78
  v_fmac_f32 v35, v79, v79
  s_add_u32 m0, s28, 99328
  s_add_u32 s31, s27, 1720320
  buffer_load_dwordx4 v13, s[8:11], s30 offen lds
  s_waitcnt lgkmcnt(1)
  v_mfma_f32_32x32x16_bf16 v[88:103], v[184:187], v[120:123], v[88:103]
  ds_read_b128 v[152:155], v18 offset:0
  ds_read_b64_tr_b16 v[200:201], v26 offset:0
  v_lshlrev_b32 v82, 16, v174
  v_and_b32 v83, s29, v174
  v_fmac_f32 v33, v80, v80
  v_fmac_f32 v35, v81, v81
  s_waitcnt lgkmcnt(2)
  v_mfma_f32_32x32x16_bf16 v[104:119], v[184:187], v[124:127], v[104:119]
  ds_read_b64_tr_b16 v[202:203], v26 offset:1024
  ds_read_b128 v[156:159], v18 offset:4096
  v_lshlrev_b32 v84, 16, v175
  v_and_b32 v85, s29, v175
  v_fmac_f32 v33, v82, v82
  v_fmac_f32 v35, v83, v83
  v_fmac_f32 v33, v84, v84
  v_fmac_f32 v35, v85, v85
  s_add_u32 m0, s28, 114688
  s_add_u32 s30, s31, 15360
  buffer_load_dwordx4 v14, s[12:15], s31 offen lds
  s_waitcnt vmcnt(7) lgkmcnt(0)
  s_barrier
  v_mfma_f32_32x32x16_bf16 v[88:103], v[200:203], v[152:155], v[88:103]
  ds_read_b128 v[168:171], v15 offset:32768
  ds_read_b64_tr_b16 v[184:185], v23 offset:32768
  v_mfma_f32_32x32x16_bf16 v[104:119], v[200:203], v[156:159], v[104:119]
  ds_read_b64_tr_b16 v[186:187], v23 offset:33792
  ds_read_b128 v[172:175], v15 offset:36864
  s_add_u32 m0, s28, 115712
  s_nop 0
  buffer_load_dwordx4 v14, s[12:15], s30 offen lds
  s_waitcnt lgkmcnt(1)
  v_mfma_f32_32x32x16_bf16 v[88:103], v[184:187], v[168:171], v[88:103]
  ds_read_b128 v[152:155], v16 offset:32768
  ds_read_b64_tr_b16 v[200:201], v24 offset:32768
  v_lshlrev_b32 v78, 16, v168
  v_and_b32 v79, s29, v168
  v_lshlrev_b32 v80, 16, v169
  v_and_b32 v81, s29, v169
  s_waitcnt lgkmcnt(2)
  v_mfma_f32_32x32x16_bf16 v[104:119], v[184:187], v[172:175], v[104:119]
  ds_read_b64_tr_b16 v[202:203], v24 offset:33792
  ds_read_b128 v[156:159], v16 offset:36864
  v_fmac_f32 v32, v78, v78
  v_fmac_f32 v34, v79, v79
  v_lshlrev_b32 v82, 16, v170
  v_and_b32 v83, s29, v170
  v_mfma_f32_16x16x32_bf16 v[48:51], v[44:47], v[168:171], v[48:51]
  v_mfma_f32_16x16x32_bf16 v[52:55], v[44:47], v[172:175], v[52:55]
  v_mfma_f32_16x16x32_bf16 v[40:43], v[44:47], v[184:187], v[40:43]
  v_fmac_f32 v32, v80, v80
  v_fmac_f32 v34, v81, v81
  v_lshlrev_b32 v84, 16, v171
  s_add_u32 m0, s28, 0
  s_add_u32 s30, s26, 1024
  buffer_load_dwordx4 v12, s[8:11], s30 offen lds
  s_waitcnt lgkmcnt(1)
  v_mfma_f32_32x32x16_bf16 v[88:103], v[200:203], v[152:155], v[88:103]
  ds_read_b128 v[120:123], v17 offset:32768
  ds_read_b64_tr_b16 v[184:185], v25 offset:32768
  v_and_b32 v85, s29, v171
  v_fmac_f32 v32, v82, v82
  v_fmac_f32 v34, v83, v83
  v_lshlrev_b32 v78, 16, v172
  s_waitcnt lgkmcnt(2)
  v_mfma_f32_32x32x16_bf16 v[104:119], v[200:203], v[156:159], v[104:119]
  ds_read_b64_tr_b16 v[186:187], v25 offset:33792
  ds_read_b128 v[124:127], v17 offset:36864
  v_and_b32 v79, s29, v172
  v_fmac_f32 v32, v84, v84
  v_fmac_f32 v34, v85, v85
  v_lshlrev_b32 v80, 16, v173
  v_mfma_f32_16x16x32_bf16 v[40:43], v[44:47], v[200:203], v[40:43]
  v_and_b32 v81, s29, v173
  v_fmac_f32 v33, v78, v78
  v_fmac_f32 v35, v79, v79
  s_add_u32 m0, s28, 1024
  s_add_u32 s31, s27, 1966080
  buffer_load_dwordx4 v13, s[8:11], s30 offen lds
  s_waitcnt lgkmcnt(1)
  v_mfma_f32_32x32x16_bf16 v[88:103], v[184:187], v[120:123], v[88:103]
  ds_read_b128 v[152:155], v18 offset:32768
  ds_read_b64_tr_b16 v[200:201], v26 offset:32768
  v_lshlrev_b32 v82, 16, v174
  v_and_b32 v83, s29, v174
  v_fmac_f32 v33, v80, v80
  v_fmac_f32 v35, v81, v81
  s_waitcnt lgkmcnt(2)
  v_mfma_f32_32x32x16_bf16 v[104:119], v[184:187], v[124:127], v[104:119]
  ds_read_b64_tr_b16 v[202:203], v26 offset:33792
  ds_read_b128 v[156:159], v18 offset:36864
  v_lshlrev_b32 v84, 16, v175
  v_and_b32 v85, s29, v175
  v_fmac_f32 v33, v82, v82
  v_fmac_f32 v35, v83, v83
  v_fmac_f32 v33, v84, v84
  v_fmac_f32 v35, v85, v85
  s_add_u32 m0, s28, 16384
  s_add_u32 s30, s31, 15360
  buffer_load_dwordx4 v14, s[12:15], s31 offen lds
  s_waitcnt vmcnt(7) lgkmcnt(0)
  s_barrier
  v_mfma_f32_32x32x16_bf16 v[88:103], v[200:203], v[152:155], v[88:103]
  ds_read_b128 v[168:171], v19 offset:0
  ds_read_b64_tr_b16 v[184:185], v27 offset:0
  v_mfma_f32_32x32x16_bf16 v[104:119], v[200:203], v[156:159], v[104:119]
  ds_read_b64_tr_b16 v[186:187], v27 offset:1024
  ds_read_b128 v[172:175], v19 offset:4096
  s_add_u32 m0, s28, 17408
  s_nop 0
  buffer_load_dwordx4 v14, s[12:15], s30 offen lds
  s_waitcnt lgkmcnt(1)
  v_mfma_f32_32x32x16_bf16 v[88:103], v[184:187], v[168:171], v[88:103]
  ds_read_b128 v[152:155], v20 offset:0
  ds_read_b64_tr_b16 v[200:201], v28 offset:0
  v_lshlrev_b32 v78, 16, v168
  v_and_b32 v79, s29, v168
  v_lshlrev_b32 v80, 16, v169
  v_and_b32 v81, s29, v169
  s_waitcnt lgkmcnt(2)
  v_mfma_f32_32x32x16_bf16 v[104:119], v[184:187], v[172:175], v[104:119]
  ds_read_b64_tr_b16 v[202:203], v28 offset:1024
  ds_read_b128 v[156:159], v20 offset:4096
  v_fmac_f32 v32, v78, v78
  v_fmac_f32 v34, v79, v79
  v_lshlrev_b32 v82, 16, v170
  v_and_b32 v83, s29, v170
  v_mfma_f32_16x16x32_bf16 v[48:51], v[44:47], v[168:171], v[48:51]
  v_mfma_f32_16x16x32_bf16 v[52:55], v[44:47], v[172:175], v[52:55]
  v_mfma_f32_16x16x32_bf16 v[40:43], v[44:47], v[184:187], v[40:43]
  v_fmac_f32 v32, v80, v80
  v_fmac_f32 v34, v81, v81
  v_lshlrev_b32 v84, 16, v171
  s_add_u32 m0, s28, 32768
  s_add_u32 s30, s26, 1152
  buffer_load_dwordx4 v12, s[8:11], s30 offen lds
  s_waitcnt lgkmcnt(1)
  v_mfma_f32_32x32x16_bf16 v[88:103], v[200:203], v[152:155], v[88:103]
  ds_read_b128 v[120:123], v21 offset:0
  ds_read_b64_tr_b16 v[184:185], v29 offset:0
  v_and_b32 v85, s29, v171
  v_fmac_f32 v32, v82, v82
  v_fmac_f32 v34, v83, v83
  v_lshlrev_b32 v78, 16, v172
  s_waitcnt lgkmcnt(2)
  v_mfma_f32_32x32x16_bf16 v[104:119], v[200:203], v[156:159], v[104:119]
  ds_read_b64_tr_b16 v[186:187], v29 offset:1024
  ds_read_b128 v[124:127], v21 offset:4096
  v_and_b32 v79, s29, v172
  v_fmac_f32 v32, v84, v84
  v_fmac_f32 v34, v85, v85
  v_lshlrev_b32 v80, 16, v173
  v_mfma_f32_16x16x32_bf16 v[40:43], v[44:47], v[200:203], v[40:43]
  v_and_b32 v81, s29, v173
  v_fmac_f32 v33, v78, v78
  v_fmac_f32 v35, v79, v79
  s_add_u32 m0, s28, 33792
  s_add_u32 s31, s27, 2211840
  buffer_load_dwordx4 v13, s[8:11], s30 offen lds
  s_waitcnt lgkmcnt(1)
  v_mfma_f32_32x32x16_bf16 v[88:103], v[184:187], v[120:123], v[88:103]
  ds_read_b128 v[152:155], v22 offset:0
  ds_read_b64_tr_b16 v[200:201], v30 offset:0
  v_lshlrev_b32 v82, 16, v174
  v_and_b32 v83, s29, v174
  v_fmac_f32 v33, v80, v80
  v_fmac_f32 v35, v81, v81
  s_waitcnt lgkmcnt(2)
  v_mfma_f32_32x32x16_bf16 v[104:119], v[184:187], v[124:127], v[104:119]
  ds_read_b64_tr_b16 v[202:203], v30 offset:1024
  ds_read_b128 v[156:159], v22 offset:4096
  v_lshlrev_b32 v84, 16, v175
  v_and_b32 v85, s29, v175
  v_fmac_f32 v33, v82, v82
  v_fmac_f32 v35, v83, v83
  v_fmac_f32 v33, v84, v84
  v_fmac_f32 v35, v85, v85
  s_add_u32 m0, s28, 49152
  s_add_u32 s30, s31, 15360
  buffer_load_dwordx4 v14, s[12:15], s31 offen lds
  s_waitcnt vmcnt(7) lgkmcnt(0)
  s_barrier
  v_mfma_f32_32x32x16_bf16 v[88:103], v[200:203], v[152:155], v[88:103]
  ds_read_b128 v[168:171], v19 offset:32768
  ds_read_b64_tr_b16 v[184:185], v27 offset:32768
  v_mfma_f32_32x32x16_bf16 v[104:119], v[200:203], v[156:159], v[104:119]
  ds_read_b64_tr_b16 v[186:187], v27 offset:33792
  ds_read_b128 v[172:175], v19 offset:36864
  s_add_u32 m0, s28, 50176
  s_nop 0
  buffer_load_dwordx4 v14, s[12:15], s30 offen lds
  s_waitcnt lgkmcnt(1)
  v_mfma_f32_32x32x16_bf16 v[88:103], v[184:187], v[168:171], v[88:103]
  ds_read_b128 v[152:155], v20 offset:32768
  ds_read_b64_tr_b16 v[200:201], v28 offset:32768
  v_lshlrev_b32 v78, 16, v168
  v_and_b32 v79, s29, v168
  v_lshlrev_b32 v80, 16, v169
  v_and_b32 v81, s29, v169
  s_waitcnt lgkmcnt(2)
  v_mfma_f32_32x32x16_bf16 v[104:119], v[184:187], v[172:175], v[104:119]
  ds_read_b64_tr_b16 v[202:203], v28 offset:33792
  ds_read_b128 v[156:159], v20 offset:36864
  v_fmac_f32 v32, v78, v78
  v_fmac_f32 v34, v79, v79
  v_lshlrev_b32 v82, 16, v170
  v_and_b32 v83, s29, v170
  v_mfma_f32_16x16x32_bf16 v[48:51], v[44:47], v[168:171], v[48:51]
  v_mfma_f32_16x16x32_bf16 v[52:55], v[44:47], v[172:175], v[52:55]
  v_mfma_f32_16x16x32_bf16 v[40:43], v[44:47], v[184:187], v[40:43]
  v_fmac_f32 v32, v80, v80
  v_fmac_f32 v34, v81, v81
  v_lshlrev_b32 v84, 16, v171
  s_waitcnt lgkmcnt(1)
  v_mfma_f32_32x32x16_bf16 v[88:103], v[200:203], v[152:155], v[88:103]
  ds_read_b128 v[120:123], v21 offset:32768
  ds_read_b64_tr_b16 v[184:185], v29 offset:32768
  v_and_b32 v85, s29, v171
  v_fmac_f32 v32, v82, v82
  v_fmac_f32 v34, v83, v83
  v_lshlrev_b32 v78, 16, v172
  s_waitcnt lgkmcnt(2)
  v_mfma_f32_32x32x16_bf16 v[104:119], v[200:203], v[156:159], v[104:119]
  ds_read_b64_tr_b16 v[186:187], v29 offset:33792
  ds_read_b128 v[124:127], v21 offset:36864
  v_and_b32 v79, s29, v172
  v_fmac_f32 v32, v84, v84
  v_fmac_f32 v34, v85, v85
  v_lshlrev_b32 v80, 16, v173
  v_mfma_f32_16x16x32_bf16 v[40:43], v[44:47], v[200:203], v[40:43]
  v_and_b32 v81, s29, v173
  v_fmac_f32 v33, v78, v78
  v_fmac_f32 v35, v79, v79
  s_waitcnt lgkmcnt(1)
  v_mfma_f32_32x32x16_bf16 v[88:103], v[184:187], v[120:123], v[88:103]
  ds_read_b128 v[152:155], v22 offset:32768
  ds_read_b64_tr_b16 v[200:201], v30 offset:32768
  v_lshlrev_b32 v82, 16, v174
  v_and_b32 v83, s29, v174
  v_fmac_f32 v33, v80, v80
  v_fmac_f32 v35, v81, v81
  s_waitcnt lgkmcnt(2)
  v_mfma_f32_32x32x16_bf16 v[104:119], v[184:187], v[124:127], v[104:119]
  ds_read_b64_tr_b16 v[202:203], v30 offset:33792
  ds_read_b128 v[156:159], v22 offset:36864
  v_lshlrev_b32 v84, 16, v175
  v_and_b32 v85, s29, v175
  v_fmac_f32 v33, v82, v82
  v_fmac_f32 v35, v83, v83
  v_fmac_f32 v33, v84, v84
  v_fmac_f32 v35, v85, v85
  s_waitcnt vmcnt(4) lgkmcnt(0)
  s_barrier
  v_mfma_f32_32x32x16_bf16 v[88:103], v[200:203], v[152:155], v[88:103]
  ds_read_b128 v[168:171], v15 offset:0
  ds_read_b64_tr_b16 v[184:185], v23 offset:0
  v_mfma_f32_32x32x16_bf16 v[104:119], v[200:203], v[156:159], v[104:119]
  ds_read_b64_tr_b16 v[186:187], v23 offset:1024
  ds_read_b128 v[172:175], v15 offset:4096
  s_waitcnt lgkmcnt(1)
  v_mfma_f32_32x32x16_bf16 v[88:103], v[184:187], v[168:171], v[88:103]
  ds_read_b128 v[152:155], v16 offset:0
  ds_read_b64_tr_b16 v[200:201], v24 offset:0
  v_lshlrev_b32 v78, 16, v168
  v_and_b32 v79, s29, v168
  v_lshlrev_b32 v80, 16, v169
  v_and_b32 v81, s29, v169
  s_waitcnt lgkmcnt(2)
  v_mfma_f32_32x32x16_bf16 v[104:119], v[184:187], v[172:175], v[104:119]
  ds_read_b64_tr_b16 v[202:203], v24 offset:1024
  ds_read_b128 v[156:159], v16 offset:4096
  v_fmac_f32 v32, v78, v78
  v_fmac_f32 v34, v79, v79
  v_lshlrev_b32 v82, 16, v170
  v_and_b32 v83, s29, v170
  v_mfma_f32_16x16x32_bf16 v[48:51], v[44:47], v[168:171], v[48:51]
  v_mfma_f32_16x16x32_bf16 v[52:55], v[44:47], v[172:175], v[52:55]
  v_mfma_f32_16x16x32_bf16 v[40:43], v[44:47], v[184:187], v[40:43]
  v_fmac_f32 v32, v80, v80
  v_fmac_f32 v34, v81, v81
  v_lshlrev_b32 v84, 16, v171
  s_waitcnt lgkmcnt(1)
  v_mfma_f32_32x32x16_bf16 v[88:103], v[200:203], v[152:155], v[88:103]
  ds_read_b128 v[120:123], v17 offset:0
  ds_read_b64_tr_b16 v[184:185], v25 offset:0
  v_and_b32 v85, s29, v171
  v_fmac_f32 v32, v82, v82
  v_fmac_f32 v34, v83, v83
  v_lshlrev_b32 v78, 16, v172
  s_waitcnt lgkmcnt(2)
  v_mfma_f32_32x32x16_bf16 v[104:119], v[200:203], v[156:159], v[104:119]
  ds_read_b64_tr_b16 v[186:187], v25 offset:1024
  ds_read_b128 v[124:127], v17 offset:4096
  v_and_b32 v79, s29, v172
  v_fmac_f32 v32, v84, v84
  v_fmac_f32 v34, v85, v85
  v_lshlrev_b32 v80, 16, v173
  v_mfma_f32_16x16x32_bf16 v[40:43], v[44:47], v[200:203], v[40:43]
  v_and_b32 v81, s29, v173
  v_fmac_f32 v33, v78, v78
  v_fmac_f32 v35, v79, v79
  s_waitcnt lgkmcnt(1)
  v_mfma_f32_32x32x16_bf16 v[88:103], v[184:187], v[120:123], v[88:103]
  ds_read_b128 v[152:155], v18 offset:0
  ds_read_b64_tr_b16 v[200:201], v26 offset:0
  v_lshlrev_b32 v82, 16, v174
  v_and_b32 v83, s29, v174
  v_fmac_f32 v33, v80, v80
  v_fmac_f32 v35, v81, v81
  s_waitcnt lgkmcnt(2)
  v_mfma_f32_32x32x16_bf16 v[104:119], v[184:187], v[124:127], v[104:119]
  ds_read_b64_tr_b16 v[202:203], v26 offset:1024
  ds_read_b128 v[156:159], v18 offset:4096
  v_lshlrev_b32 v84, 16, v175
  v_and_b32 v85, s29, v175
  v_fmac_f32 v33, v82, v82
  v_fmac_f32 v35, v83, v83
  v_fmac_f32 v33, v84, v84
  v_fmac_f32 v35, v85, v85
  s_waitcnt vmcnt(0) lgkmcnt(0)
  s_barrier
  v_mfma_f32_32x32x16_bf16 v[88:103], v[200:203], v[152:155], v[88:103]
  ds_read_b128 v[168:171], v15 offset:32768
  ds_read_b64_tr_b16 v[184:185], v23 offset:32768
  v_mfma_f32_32x32x16_bf16 v[104:119], v[200:203], v[156:159], v[104:119]
  ds_read_b64_tr_b16 v[186:187], v23 offset:33792
  ds_read_b128 v[172:175], v15 offset:36864
  s_waitcnt lgkmcnt(1)
  v_mfma_f32_32x32x16_bf16 v[88:103], v[184:187], v[168:171], v[88:103]
  ds_read_b128 v[152:155], v16 offset:32768
  ds_read_b64_tr_b16 v[200:201], v24 offset:32768
  v_lshlrev_b32 v78, 16, v168
  v_and_b32 v79, s29, v168
  v_lshlrev_b32 v80, 16, v169
  v_and_b32 v81, s29, v169
  s_waitcnt lgkmcnt(2)
  v_mfma_f32_32x32x16_bf16 v[104:119], v[184:187], v[172:175], v[104:119]
  ds_read_b64_tr_b16 v[202:203], v24 offset:33792
  ds_read_b128 v[156:159], v16 offset:36864
  v_fmac_f32 v32, v78, v78
  v_fmac_f32 v34, v79, v79
  v_lshlrev_b32 v82, 16, v170
  v_and_b32 v83, s29, v170
  v_mfma_f32_16x16x32_bf16 v[48:51], v[44:47], v[168:171], v[48:51]
  v_mfma_f32_16x16x32_bf16 v[52:55], v[44:47], v[172:175], v[52:55]
  v_mfma_f32_16x16x32_bf16 v[40:43], v[44:47], v[184:187], v[40:43]
  v_fmac_f32 v32, v80, v80
  v_fmac_f32 v34, v81, v81
  v_lshlrev_b32 v84, 16, v171
  s_waitcnt lgkmcnt(1)
  v_mfma_f32_32x32x16_bf16 v[88:103], v[200:203], v[152:155], v[88:103]
  ds_read_b128 v[120:123], v17 offset:32768
  ds_read_b64_tr_b16 v[184:185], v25 offset:32768
  v_and_b32 v85, s29, v171
  v_fmac_f32 v32, v82, v82
  v_fmac_f32 v34, v83, v83
  v_lshlrev_b32 v78, 16, v172
  s_waitcnt lgkmcnt(2)
  v_mfma_f32_32x32x16_bf16 v[104:119], v[200:203], v[156:159], v[104:119]
  ds_read_b64_tr_b16 v[186:187], v25 offset:33792
  ds_read_b128 v[124:127], v17 offset:36864
  v_and_b32 v79, s29, v172
  v_fmac_f32 v32, v84, v84
  v_fmac_f32 v34, v85, v85
  v_lshlrev_b32 v80, 16, v173
  v_mfma_f32_16x16x32_bf16 v[40:43], v[44:47], v[200:203], v[40:43]
  v_and_b32 v81, s29, v173
  v_fmac_f32 v33, v78, v78
  v_fmac_f32 v35, v79, v79
  s_waitcnt lgkmcnt(1)
  v_mfma_f32_32x32x16_bf16 v[88:103], v[184:187], v[120:123], v[88:103]
  ds_read_b128 v[152:155], v18 offset:32768
  ds_read_b64_tr_b16 v[200:201], v26 offset:32768
  v_lshlrev_b32 v82, 16, v174
  v_and_b32 v83, s29, v174
  v_fmac_f32 v33, v80, v80
  v_fmac_f32 v35, v81, v81
  s_waitcnt lgkmcnt(2)
  v_mfma_f32_32x32x16_bf16 v[104:119], v[184:187], v[124:127], v[104:119]
  ds_read_b64_tr_b16 v[202:203], v26 offset:33792
  ds_read_b128 v[156:159], v18 offset:36864
  v_lshlrev_b32 v84, 16, v175
  v_and_b32 v85, s29, v175
  v_fmac_f32 v33, v82, v82
  v_fmac_f32 v35, v83, v83
  v_fmac_f32 v33, v84, v84
  v_fmac_f32 v35, v85, v85
  s_waitcnt lgkmcnt(1)
  v_mfma_f32_32x32x16_bf16 v[88:103], v[200:203], v[152:155], v[88:103]
  s_waitcnt lgkmcnt(0)
  v_mfma_f32_32x32x16_bf16 v[104:119], v[200:203], v[156:159], v[104:119]
  s_lshr_b32 s43, s19, 1
  s_mul_i32 s43, s43, 30720
  s_and_b32 s41, s19, 1
  s_cmp_eq_u32 s21, 0
  s_cselect_b32 s23, 20480, 0
  s_add_u32 s43, s43, s23
  s_mul_i32 s81, s81, s41
  s_add_u32 s80, s80, s81
  s_add_u32 s80, s80, s43
  s_mul_i32 s85, s85, s41
  s_add_u32 s84, s84, s85
  s_add_u32 s84, s84, s43
  s_mul_i32 s89, s89, s41
  s_add_u32 s88, s88, s89
  s_add_u32 s88, s88, s43
  s_mul_i32 s93, s93, s41
  s_add_u32 s92, s92, s93
  s_add_u32 s92, s92, s43
  s_mul_i32 s97, s97, s41
  s_add_u32 s96, s96, s97
  s_add_u32 s96, s96, s43
  v_and_b32 v10, 31, v1
  s_lshl_b32 s22, s17, 11
  v_lshl_add_u32 v11, v10, 4, s22
  s_lshl_b32 s22, s17, 9
  v_lshl_add_u32 v10, v10, 3, s22
  v_cmp_gt_i32 vcc, 0, v72
  v_and_b32 v72, 0xffff, v72
  v_mov_b32 v4, 1024
  v_mov_b32 v5, 256
  v_cndmask_b32 v61, v11, v10, vcc
  v_cndmask_b32 v4, v4, v5, vcc
  v_add_u32 v61, v61, v72
  v_add_u32 v62, v61, v4
  v_cmp_gt_i32 vcc, 0, v73
  v_and_b32 v73, 0xffff, v73
  v_mov_b32 v4, 1024
  v_mov_b32 v5, 256
  v_cndmask_b32 v63, v11, v10, vcc
  v_cndmask_b32 v4, v4, v5, vcc
  v_add_u32 v63, v63, v73
  v_add_u32 v64, v63, v4
  v_cmp_gt_i32 vcc, 0, v74
  v_and_b32 v74, 0xffff, v74
  v_mov_b32 v4, 1024
  v_mov_b32 v5, 256
  v_cndmask_b32 v65, v11, v10, vcc
  v_cndmask_b32 v4, v4, v5, vcc
  v_add_u32 v65, v65, v74
  v_add_u32 v66, v65, v4
  v_cmp_gt_i32 vcc, 0, v75
  v_and_b32 v75, 0xffff, v75
  v_mov_b32 v4, 1024
  v_mov_b32 v5, 256
  v_cndmask_b32 v67, v11, v10, vcc
  v_cndmask_b32 v4, v4, v5, vcc
  v_add_u32 v67, v67, v75
  v_add_u32 v68, v67, v4
  s_branch L_qkv_kernel_epi_6
L_qkv_kernel_vpath_5:
  v_and_b32 v2, 31, v1
  v_lshrrev_b32 v3, 5, v1
  v_lshlrev_b32 v69, 4, v1
  s_mul_i32 s42, s21, 5
  s_sub_u32 s42, s20, s42
  s_getpc_b64 s[44:45]
L_qkv_kernel_here_8:
  s_add_u32 s44, s44, L_qkv_kernel_tab - L_qkv_kernel_here_8
  s_addc_u32 s45, s45, 0
  s_mul_i32 s46, s42, 640
  s_lshl_b32 s47, s16, 4
  s_add_u32 s46, s46, s47
  s_add_u32 s46, s44, s46
  s_addc_u32 s47, s45, 0
  s_load_dwordx4 s[80:83], s[46:47], 3200
  s_load_dwordx4 s[84:87], s[46:47], 3328
  s_load_dwordx4 s[88:91], s[46:47], 3456
  s_load_dwordx4 s[92:95], s[46:47], 3584
  s_load_dwordx4 s[96:99], s[46:47], 3712
  s_mul_i32 s40, s42, 6560
  s_lshr_b32 s40, s40, 10
  s_lshl_b32 s22, s42, 7
  s_lshl_b32 s23, s18, 5
  s_add_u32 s22, s22, s23
  v_add_u32 v5, s22, v2
  v_mul_u32_u24 v7, 3277, v5
  v_lshrrev_b32 v7, 16, v7
  v_mul_u32_u24 v8, 20, v7
  v_sub_u32 v5, v5, v8
  v_subrev_u32 v7, s40, v7
  v_mul_u32_u24 v7, 5120, v7
  v_lshl_add_u32 v7, v5, 4, v7
  v_mul_u32_u24 v8, 320, v3
  v_add_u32 v7, v7, v8
  s_mul_i32 s22, s17, 2560
  v_add_u32 v61, s22, v7
  s_waitcnt vmcnt(6) lgkmcnt(0)
  s_barrier
  ds_read_b128 v[168:171], v15 offset:0
  ds_read_b64_tr_b16 v[184:185], v23 offset:0
  ds_read_b64_tr_b16 v[186:187], v23 offset:1024
  ds_read_b128 v[172:175], v15 offset:4096
  s_waitcnt lgkmcnt(1)
  v_mfma_f32_32x32x16_bf16 v[88:103], v[168:171], v[184:187], 0
  ds_read_b128 v[152:155], v16 offset:0
  ds_read_b64_tr_b16 v[200:201], v24 offset:0
  v_lshlrev_b32 v78, 16, v168
  v_and_b32 v79, s29, v168
  v_lshlrev_b32 v80, 16, v169
  v_and_b32 v81, s29, v169
  s_waitcnt lgkmcnt(2)
  v_mfma_f32_32x32x16_bf16 v[104:119], v[172:175], v[184:187], 0
  ds_read_b64_tr_b16 v[202:203], v24 offset:1024
  ds_read_b128 v[156:159], v16 offset:4096
  v_fmac_f32 v32, v78, v78
  v_fmac_f32 v34, v79, v79
  v_lshlrev_b32 v82, 16, v170
  v_and_b32 v83, s29, v170
  v_mfma_f32_16x16x32_bf16 v[48:51], v[44:47], v[168:171], 0
  v_mfma_f32_16x16x32_bf16 v[52:55], v[44:47], v[172:175], 0
  v_mfma_f32_16x16x32_bf16 v[40:43], v[44:47], v[184:187], 0
  v_fmac_f32 v32, v80, v80
  v_fmac_f32 v34, v81, v81
  v_lshlrev_b32 v84, 16, v171
  s_add_u32 m0, s28, 65536
  s_add_u32 s30, s26, 256
  buffer_load_dwordx4 v12, s[8:11], s30 offen lds
  s_add_u32 m0, s28, 66560
  s_add_u32 s31, s27, 491520
  buffer_load_dwordx4 v13, s[8:11], s30 offen lds
  s_waitcnt lgkmcnt(1)
  v_mfma_f32_32x32x16_bf16 v[88:103], v[152:155], v[200:203], v[88:103]
  ds_read_b128 v[120:123], v17 offset:0
  ds_read_b64_tr_b16 v[184:185], v25 offset:0
  v_and_b32 v85, s29, v171
  v_fmac_f32 v32, v82, v82
  v_fmac_f32 v34, v83, v83
  v_lshlrev_b32 v78, 16, v172
  s_waitcnt lgkmcnt(2)
  v_mfma_f32_32x32x16_bf16 v[104:119], v[156:159], v[200:203], v[104:119]
  ds_read_b64_tr_b16 v[186:187], v25 offset:1024
  ds_read_b128 v[124:127], v17 offset:4096
  v_and_b32 v79, s29, v172
  v_fmac_f32 v32, v84, v84
  v_fmac_f32 v34, v85, v85
  v_lshlrev_b32 v80, 16, v173
  v_mfma_f32_16x16x32_bf16 v[40:43], v[44:47], v[200:203], v[40:43]
  v_and_b32 v81, s29, v173
  v_fmac_f32 v33, v78, v78
  v_fmac_f32 v35, v79, v79
  s_add_u32 m0, s28, 81920
  s_add_u32 s30, s31, 15360
  buffer_load_dwordx4 v14, s[12:15], s31 offen lds
  s_add_u32 m0, s28, 82944
  s_nop 0
  buffer_load_dwordx4 v14, s[12:15], s30 offen lds
  s_waitcnt lgkmcnt(1)
  v_mfma_f32_32x32x16_bf16 v[88:103], v[120:123], v[184:187], v[88:103]
  ds_read_b128 v[152:155], v18 offset:0
  ds_read_b64_tr_b16 v[200:201], v26 offset:0
  v_lshlrev_b32 v82, 16, v174
  v_and_b32 v83, s29, v174
  v_fmac_f32 v33, v80, v80
  v_fmac_f32 v35, v81, v81
  s_waitcnt lgkmcnt(2)
  v_mfma_f32_32x32x16_bf16 v[104:119], v[124:127], v[184:187], v[104:119]
  ds_read_b64_tr_b16 v[202:203], v26 offset:1024
  ds_read_b128 v[156:159], v18 offset:4096
  v_lshlrev_b32 v84, 16, v175
  v_and_b32 v85, s29, v175
  v_fmac_f32 v33, v82, v82
  v_fmac_f32 v35, v83, v83
  v_fmac_f32 v33, v84, v84
  v_fmac_f32 v35, v85, v85
  s_add_u32 m0, s28, 98304
  s_add_u32 s30, s26, 384
  buffer_load_dwordx4 v12, s[8:11], s30 offen lds
  s_add_u32 m0, s28, 99328
  s_add_u32 s31, s27, 737280
  buffer_load_dwordx4 v13, s[8:11], s30 offen lds
  s_waitcnt vmcnt(8) lgkmcnt(0)
  s_barrier
  v_mfma_f32_32x32x16_bf16 v[88:103], v[152:155], v[200:203], v[88:103]
  ds_read_b128 v[168:171], v15 offset:32768
  ds_read_b64_tr_b16 v[184:185], v23 offset:32768
  v_mfma_f32_32x32x16_bf16 v[104:119], v[156:159], v[200:203], v[104:119]
  ds_read_b64_tr_b16 v[186:187], v23 offset:33792
  ds_read_b128 v[172:175], v15 offset:36864
  s_add_u32 m0, s28, 114688
  s_add_u32 s30, s31, 15360
  buffer_load_dwordx4 v14, s[12:15], s31 offen lds
  s_add_u32 m0, s28, 115712
  s_nop 0
  buffer_load_dwordx4 v14, s[12:15], s30 offen lds
  s_waitcnt lgkmcnt(1)
  v_mfma_f32_32x32x16_bf16 v[88:103], v[168:171], v[184:187], v[88:103]
  ds_read_b128 v[152:155], v16 offset:32768
  ds_read_b64_tr_b16 v[200:201], v24 offset:32768
  v_lshlrev_b32 v78, 16, v168
  v_and_b32 v79, s29, v168
  v_lshlrev_b32 v80, 16, v169
  v_and_b32 v81, s29, v169
  s_waitcnt lgkmcnt(2)
  v_mfma_f32_32x32x16_bf16 v[104:119], v[172:175], v[184:187], v[104:119]
  ds_read_b64_tr_b16 v[202:203], v24 offset:33792
  ds_read_b128 v[156:159], v16 offset:36864
  v_fmac_f32 v32, v78, v78
  v_fmac_f32 v34, v79, v79
  v_lshlrev_b32 v82, 16, v170
  v_and_b32 v83, s29, v170
  v_mfma_f32_16x16x32_bf16 v[48:51], v[44:47], v[168:171], v[48:51]
  v_mfma_f32_16x16x32_bf16 v[52:55], v[44:47], v[172:175], v[52:55]
  v_mfma_f32_16x16x32_bf16 v[40:43], v[44:47], v[184:187], v[40:43]
  v_fmac_f32 v32, v80, v80
  v_fmac_f32 v34, v81, v81
  v_lshlrev_b32 v84, 16, v171
  s_add_u32 m0, s28, 0
  s_add_u32 s30, s26, 512
  buffer_load_dwordx4 v12, s[8:11], s30 offen lds
  s_waitcnt lgkmcnt(1)
  v_mfma_f32_32x32x16_bf16 v[88:103], v[152:155], v[200:203], v[88:103]
  ds_read_b128 v[120:123], v17 offset:32768
  ds_read_b64_tr_b16 v[184:185], v25 offset:32768
  v_and_b32 v85, s29, v171
  v_fmac_f32 v32, v82, v82
  v_fmac_f32 v34, v83, v83
  v_lshlrev_b32 v78, 16, v172
  s_waitcnt lgkmcnt(2)
  v_mfma_f32_32x32x16_bf16 v[104:119], v[156:159], v[200:203], v[104:119]
  ds_read_b64_tr_b16 v[186:187], v25 offset:33792
  ds_read_b128 v[124:127], v17 offset:36864
  v_and_b32 v79, s29, v172
  v_fmac_f32 v32, v84, v84
  v_fmac_f32 v34, v85, v85
  v_lshlrev_b32 v80, 16, v173
  v_mfma_f32_16x16x32_bf16 v[40:43], v[44:47], v[200:203], v[40:43]
  v_and_b32 v81, s29, v173
  v_fmac_f32 v33, v78, v78
  v_fmac_f32 v35, v79, v79
  s_add_u32 m0, s28, 1024
  s_add_u32 s31, s27, 983040
  buffer_load_dwordx4 v13, s[8:11], s30 offen lds
  s_waitcnt lgkmcnt(1)
  v_mfma_f32_32x32x16_bf16 v[88:103], v[120:123], v[184:187], v[88:103]
  ds_read_b128 v[152:155], v18 offset:32768
  ds_read_b64_tr_b16 v[200:201], v26 offset:32768
  v_lshlrev_b32 v82, 16, v174
  v_and_b32 v83, s29, v174
  v_fmac_f32 v33, v80, v80
  v_fmac_f32 v35, v81, v81
  s_waitcnt lgkmcnt(2)
  v_mfma_f32_32x32x16_bf16 v[104:119], v[124:127], v[184:187], v[104:119]
  ds_read_b64_tr_b16 v[202:203], v26 offset:33792
  ds_read_b128 v[156:159], v18 offset:36864
  v_lshlrev_b32 v84, 16, v175
  v_and_b32 v85, s29, v175
  v_fmac_f32 v33, v82, v82
  v_fmac_f32 v35, v83, v83
  v_fmac_f32 v33, v84, v84
  v_fmac_f32 v35, v85, v85
  s_add_u32 m0, s28, 16384
  s_add_u32 s30, s31, 15360
  buffer_load_dwordx4 v14, s[12:15], s31 offen lds
  s_waitcnt vmcnt(7) lgkmcnt(0)
  s_barrier
  v_mfma_f32_32x32x16_bf16 v[88:103], v[152:155], v[200:203], v[88:103]
  ds_read_b128 v[168:171], v19 offset:0
  ds_read_b64_tr_b16 v[184:185], v27 offset:0
  v_mfma_f32_32x32x16_bf16 v[104:119], v[156:159], v[200:203], v[104:119]
  ds_read_b64_tr_b16 v[186:187], v27 offset:1024
  ds_read_b128 v[172:175], v19 offset:4096
  s_add_u32 m0, s28, 17408
  s_nop 0
  buffer_load_dwordx4 v14, s[12:15], s30 offen lds
  s_waitcnt lgkmcnt(1)
  v_mfma_f32_32x32x16_bf16 v[88:103], v[168:171], v[184:187], v[88:103]
  ds_read_b128 v[152:155], v20 offset:0
  ds_read_b64_tr_b16 v[200:201], v28 offset:0
  v_lshlrev_b32 v78, 16, v168
  v_and_b32 v79, s29, v168
  v_lshlrev_b32 v80, 16, v169
  v_and_b32 v81, s29, v169
  s_waitcnt lgkmcnt(2)
  v_mfma_f32_32x32x16_bf16 v[104:119], v[172:175], v[184:187], v[104:119]
  ds_read_b64_tr_b16 v[202:203], v28 offset:1024
  ds_read_b128 v[156:159], v20 offset:4096
  v_fmac_f32 v32, v78, v78
  v_fmac_f32 v34, v79, v79
  v_lshlrev_b32 v82, 16, v170
  v_and_b32 v83, s29, v170
  v_mfma_f32_16x16x32_bf16 v[48:51], v[44:47], v[168:171], v[48:51]
  v_mfma_f32_16x16x32_bf16 v[52:55], v[44:47], v[172:175], v[52:55]
  v_mfma_f32_16x16x32_bf16 v[40:43], v[44:47], v[184:187], v[40:43]
  v_fmac_f32 v32, v80, v80
  v_fmac_f32 v34, v81, v81
  v_lshlrev_b32 v84, 16, v171
  s_add_u32 m0, s28, 32768
  s_add_u32 s30, s26, 640
  buffer_load_dwordx4 v12, s[8:11], s30 offen lds
  s_waitcnt lgkmcnt(1)
  v_mfma_f32_32x32x16_bf16 v[88:103], v[152:155], v[200:203], v[88:103]
  ds_read_b128 v[120:123], v21 offset:0
  ds_read_b64_tr_b16 v[184:185], v29 offset:0
  v_and_b32 v85, s29, v171
  v_fmac_f32 v32, v82, v82
  v_fmac_f32 v34, v83, v83
  v_lshlrev_b32 v78, 16, v172
  s_waitcnt lgkmcnt(2)
  v_mfma_f32_32x32x16_bf16 v[104:119], v[156:159], v[200:203], v[104:119]
  ds_read_b64_tr_b16 v[186:187], v29 offset:1024
  ds_read_b128 v[124:127], v21 offset:4096
  v_and_b32 v79, s29, v172
  v_fmac_f32 v32, v84, v84
  v_fmac_f32 v34, v85, v85
  v_lshlrev_b32 v80, 16, v173
  v_mfma_f32_16x16x32_bf16 v[40:43], v[44:47], v[200:203], v[40:43]
  v_and_b32 v81, s29, v173
  v_fmac_f32 v33, v78, v78
  v_fmac_f32 v35, v79, v79
  s_add_u32 m0, s28, 33792
  s_add_u32 s31, s27, 1228800
  buffer_load_dwordx4 v13, s[8:11], s30 offen lds
  s_waitcnt lgkmcnt(1)
  v_mfma_f32_32x32x16_bf16 v[88:103], v[120:123], v[184:187], v[88:103]
  ds_read_b128 v[152:155], v22 offset:0
  ds_read_b64_tr_b16 v[200:201], v30 offset:0
  v_lshlrev_b32 v82, 16, v174
  v_and_b32 v83, s29, v174
  v_fmac_f32 v33, v80, v80
  v_fmac_f32 v35, v81, v81
  s_waitcnt lgkmcnt(2)
  v_mfma_f32_32x32x16_bf16 v[104:119], v[124:127], v[184:187], v[104:119]
  ds_read_b64_tr_b16 v[202:203], v30 offset:1024
  ds_read_b128 v[156:159], v22 offset:4096
  v_lshlrev_b32 v84, 16, v175
  v_and_b32 v85, s29, v175
  v_fmac_f32 v33, v82, v82
  v_fmac_f32 v35, v83, v83
  v_fmac_f32 v33, v84, v84
  v_fmac_f32 v35, v85, v85
  s_add_u32 m0, s28, 49152
  s_add_u32 s30, s31, 15360
  buffer_load_dwordx4 v14, s[12:15], s31 offen lds
  s_waitcnt vmcnt(7) lgkmcnt(0)
  s_barrier
  v_mfma_f32_32x32x16_bf16 v[88:103], v[152:155], v[200:203], v[88:103]
  ds_read_b128 v[168:171], v19 offset:32768
  ds_read_b64_tr_b16 v[184:185], v27 offset:32768
  v_mfma_f32_32x32x16_bf16 v[104:119], v[156:159], v[200:203], v[104:119]
  ds_read_b64_tr_b16 v[186:187], v27 offset:33792
  ds_read_b128 v[172:175], v19 offset:36864
  s_add_u32 m0, s28, 50176
  s_nop 0
  buffer_load_dwordx4 v14, s[12:15], s30 offen lds
  s_waitcnt lgkmcnt(1)
  v_mfma_f32_32x32x16_bf16 v[88:103], v[168:171], v[184:187], v[88:103]
  ds_read_b128 v[152:155], v20 offset:32768
  ds_read_b64_tr_b16 v[200:201], v28 offset:32768
  v_lshlrev_b32 v78, 16, v168
  v_and_b32 v79, s29, v168
  v_lshlrev_b32 v80, 16, v169
  v_and_b32 v81, s29, v169
  s_waitcnt lgkmcnt(2)
  v_mfma_f32_32x32x16_bf16 v[104:119], v[172:175], v[184:187], v[104:119]
  ds_read_b64_tr_b16 v[202:203], v28 offset:33792
  ds_read_b128 v[156:159], v20 offset:36864
  v_fmac_f32 v32, v78, v78
  v_fmac_f32 v34, v79, v79
  v_lshlrev_b32 v82, 16, v170
  v_and_b32 v83, s29, v170
  v_mfma_f32_16x16x32_bf16 v[48:51], v[44:47], v[168:171], v[48:51]
  v_mfma_f32_16x16x32_bf16 v[52:55], v[44:47], v[172:175], v[52:55]
  v_mfma_f32_16x16x32_bf16 v[40:43], v[44:47], v[184:187], v[40:43]
  v_fmac_f32 v32, v80, v80
  v_fmac_f32 v34, v81, v81
  v_lshlrev_b32 v84, 16, v171
  s_add_u32 m0, s28, 65536
  s_add_u32 s30, s26, 768
  buffer_load_dwordx4 v12, s[8:11], s30 offen lds
  s_waitcnt lgkmcnt(1)
  v_mfma_f32_32x32x16_bf16 v[88:103], v[152:155], v[200:203], v[88:103]
  ds_read_b128 v[120:123], v21 offset:32768
  ds_read_b64_tr_b16 v[184:185], v29 offset:32768
  v_and_b32 v85, s29, v171
  v_fmac_f32 v32, v82, v82
  v_fmac_f32 v34, v83, v83
  v_lshlrev_b32 v78, 16, v172
  s_waitcnt lgkmcnt(2)
  v_mfma_f32_32x32x16_bf16 v[104:119], v[156:159], v[200:203], v[104:119]
  ds_read_b64_tr_b16 v[186:187], v29 offset:33792
  ds_read_b128 v[124:127], v21 offset:36864
  v_and_b32 v79, s29, v172
  v_fmac_f32 v32, v84, v84
  v_fmac_f32 v34, v85, v85
  v_lshlrev_b32 v80, 16, v173
  v_mfma_f32_16x16x32_bf16 v[40:43], v[44:47], v[200:203], v[40:43]
  v_and_b32 v81, s29, v173
  v_fmac_f32 v33, v78, v78
  v_fmac_f32 v35, v79, v79
  s_add_u32 m0, s28, 66560
  s_add_u32 s31, s27, 1474560
  buffer_load_dwordx4 v13, s[8:11], s30 offen lds
  s_waitcnt lgkmcnt(1)
  v_mfma_f32_32x32x16_bf16 v[88:103], v[120:123], v[184:187], v[88:103]
  ds_read_b128 v[152:155], v22 offset:32768
  ds_read_b64_tr_b16 v[200:201], v30 offset:32768
  v_lshlrev_b32 v82, 16, v174
  v_and_b32 v83, s29, v174
  v_fmac_f32 v33, v80, v80
  v_fmac_f32 v35, v81, v81
  s_waitcnt lgkmcnt(2)
  v_mfma_f32_32x32x16_bf16 v[104:119], v[124:127], v[184:187], v[104:119]
  ds_read_b64_tr_b16 v[202:203], v30 offset:33792
  ds_read_b128 v[156:159], v22 offset:36864
  v_lshlrev_b32 v84, 16, v175
  v_and_b32 v85, s29, v175
  v_fmac_f32 v33, v82, v82
  v_fmac_f32 v35, v83, v83
  v_fmac_f32 v33, v84, v84
  v_fmac_f32 v35, v85, v85
  s_add_u32 m0, s28, 81920
  s_add_u32 s30, s31, 15360
  buffer_load_dwordx4 v14, s[12:15], s31 offen lds
  s_waitcnt vmcnt(7) lgkmcnt(0)
  s_barrier
  v_mfma_f32_32x32x16_bf16 v[88:103], v[152:155], v[200:203], v[88:103]
  ds_read_b128 v[168:171], v15 offset:0
  ds_read_b64_tr_b16 v[184:185], v23 offset:0
  v_mfma_f32_32x32x16_bf16 v[104:119], v[156:159], v[200:203], v[104:119]
  ds_read_b64_tr_b16 v[186:187], v23 offset:1024
  ds_read_b128 v[172:175], v15 offset:4096
  s_add_u32 m0, s28, 82944
  s_nop 0
  buffer_load_dwordx4 v14, s[12:15], s30 offen lds
  s_waitcnt lgkmcnt(1)
  v_mfma_f32_32x32x16_bf16 v[88:103], v[168:171], v[184:187], v[88:103]
  ds_read_b128 v[152:155], v16 offset:0
  ds_read_b64_tr_b16 v[200:201], v24 offset:0
  v_lshlrev_b32 v78, 16, v168
  v_and_b32 v79, s29, v168
  v_lshlrev_b32 v80, 16, v169
  v_and_b32 v81, s29, v169
  s_waitcnt lgkmcnt(2)
  v_mfma_f32_32x32x16_bf16 v[104:119], v[172:175], v[184:187], v[104:119]
  ds_read_b64_tr_b16 v[202:203], v24 offset:1024
  ds_read_b128 v[156:159], v16 offset:4096
  v_fmac_f32 v32, v78, v78
  v_fmac_f32 v34, v79, v79
  v_lshlrev_b32 v82, 16, v170
  v_and_b32 v83, s29, v170
  v_mfma_f32_16x16x32_bf16 v[48:51], v[44:47], v[168:171], v[48:51]
  v_mfma_f32_16x16x32_bf16 v[52:55], v[44:47], v[172:175], v[52:55]
  v_mfma_f32_16x16x32_bf16 v[40:43], v[44:47], v[184:187], v[40:43]
  v_fmac_f32 v32, v80, v80
  v_fmac_f32 v34, v81, v81
  v_lshlrev_b32 v84, 16, v171
  s_add_u32 m0, s28, 98304
  s_add_u32 s30, s26, 896
  buffer_load_dwordx4 v12, s[8:11], s30 offen lds
  s_waitcnt lgkmcnt(1)
  v_mfma_f32_32x32x16_bf16 v[88:103], v[152:155], v[200:203], v[88:103]
  ds_read_b128 v[120:123], v17 offset:0
  ds_read_b64_tr_b16 v[184:185], v25 offset:0
  v_and_b32 v85, s29, v171
  v_fmac_f32 v32, v82, v82
  v_fmac_f32 v34, v83, v83
  v_lshlrev_b32 v78, 16, v172
  s_waitcnt lgkmcnt(2)
  v_mfma_f32_32x32x16_bf16 v[104:119], v[156:159], v[200:203], v[104:119]
  ds_read_b64_tr_b16 v[186:187], v25 offset:1024
  ds_read_b128 v[124:127], v17 offset:4096
  v_and_b32 v79, s29, v172
  v_fmac_f32 v32, v84, v84
  v_fmac_f32 v34, v85, v85
  v_lshlrev_b32 v80, 16, v173
  v_mfma_f32_16x16x32_bf16 v[40:43], v[44:47], v[200:203], v[40:43]
  v_and_b32 v81, s29, v173
  v_fmac_f32 v33, v78, v78
  v_fmac_f32 v35, v79, v79
  s_add_u32 m0, s28, 99328
  s_add_u32 s31, s27, 1720320
  buffer_load_dwordx4 v13, s[8:11], s30 offen lds
  s_waitcnt lgkmcnt(1)
  v_mfma_f32_32x32x16_bf16 v[88:103], v[120:123], v[184:187], v[88:103]
  ds_read_b128 v[152:155], v18 offset:0
  ds_read_b64_tr_b16 v[200:201], v26 offset:0
  v_lshlrev_b32 v82, 16, v174
  v_and_b32 v83, s29, v174
  v_fmac_f32 v33, v80, v80
  v_fmac_f32 v35, v81, v81
  s_waitcnt lgkmcnt(2)
  v_mfma_f32_32x32x16_bf16 v[104:119], v[124:127], v[184:187], v[104:119]
  ds_read_b64_tr_b16 v[202:203], v26 offset:1024
  ds_read_b128 v[156:159], v18 offset:4096
  v_lshlrev_b32 v84, 16, v175
  v_and_b32 v85, s29, v175
  v_fmac_f32 v33, v82, v82
  v_fmac_f32 v35, v83, v83
  v_fmac_f32 v33, v84, v84
  v_fmac_f32 v35, v85, v85
  s_add_u32 m0, s28, 114688
  s_add_u32 s30, s31, 15360
  buffer_load_dwordx4 v14, s[12:15], s31 offen lds
  s_waitcnt vmcnt(7) lgkmcnt(0)
  s_barrier
  v_mfma_f32_32x32x16_bf16 v[88:103], v[152:155], v[200:203], v[88:103]
  ds_read_b128 v[168:171], v15 offset:32768
  ds_read_b64_tr_b16 v[184:185], v23 offset:32768
  v_mfma_f32_32x32x16_bf16 v[104:119], v[156:159], v[200:203], v[104:119]
  ds_read_b64_tr_b16 v[186:187], v23 offset:33792
  ds_read_b128 v[172:175], v15 offset:36864
  s_add_u32 m0, s28, 115712
  s_nop 0
  buffer_load_dwordx4 v14, s[12:15], s30 offen lds
  s_waitcnt lgkmcnt(1)
  v_mfma_f32_32x32x16_bf16 v[88:103], v[168:171], v[184:187], v[88:103]
  ds_read_b128 v[152:155], v16 offset:32768
  ds_read_b64_tr_b16 v[200:201], v24 offset:32768
  v_lshlrev_b32 v78, 16, v168
  v_and_b32 v79, s29, v168
  v_lshlrev_b32 v80, 16, v169
  v_and_b32 v81, s29, v169
  s_waitcnt lgkmcnt(2)
  v_mfma_f32_32x32x16_bf16 v[104:119], v[172:175], v[184:187], v[104:119]
  ds_read_b64_tr_b16 v[202:203], v24 offset:33792
  ds_read_b128 v[156:159], v16 offset:36864
  v_fmac_f32 v32, v78, v78
  v_fmac_f32 v34, v79, v79
  v_lshlrev_b32 v82, 16, v170
  v_and_b32 v83, s29, v170
  v_mfma_f32_16x16x32_bf16 v[48:51], v[44:47], v[168:171], v[48:51]
  v_mfma_f32_16x16x32_bf16 v[52:55], v[44:47], v[172:175], v[52:55]
  v_mfma_f32_16x16x32_bf16 v[40:43], v[44:47], v[184:187], v[40:43]
  v_fmac_f32 v32, v80, v80
  v_fmac_f32 v34, v81, v81
  v_lshlrev_b32 v84, 16, v171
  s_add_u32 m0, s28, 0
  s_add_u32 s30, s26, 1024
  buffer_load_dwordx4 v12, s[8:11], s30 offen lds
  s_waitcnt lgkmcnt(1)
  v_mfma_f32_32x32x16_bf16 v[88:103], v[152:155], v[200:203], v[88:103]
  ds_read_b128 v[120:123], v17 offset:32768
  ds_read_b64_tr_b16 v[184:185], v25 offset:32768
  v_and_b32 v85, s29, v171
  v_fmac_f32 v32, v82, v82
  v_fmac_f32 v34, v83, v83
  v_lshlrev_b32 v78, 16, v172
  s_waitcnt lgkmcnt(2)
  v_mfma_f32_32x32x16_bf16 v[104:119], v[156:159], v[200:203], v[104:119]
  ds_read_b64_tr_b16 v[186:187], v25 offset:33792
  ds_read_b128 v[124:127], v17 offset:36864
  v_and_b32 v79, s29, v172
  v_fmac_f32 v32, v84, v84
  v_fmac_f32 v34, v85, v85
  v_lshlrev_b32 v80, 16, v173
  v_mfma_f32_16x16x32_bf16 v[40:43], v[44:47], v[200:203], v[40:43]
  v_and_b32 v81, s29, v173
  v_fmac_f32 v33, v78, v78
  v_fmac_f32 v35, v79, v79
  s_add_u32 m0, s28, 1024
  s_add_u32 s31, s27, 1966080
  buffer_load_dwordx4 v13, s[8:11], s30 offen lds
  s_waitcnt lgkmcnt(1)
  v_mfma_f32_32x32x16_bf16 v[88:103], v[120:123], v[184:187], v[88:103]
  ds_read_b128 v[152:155], v18 offset:32768
  ds_read_b64_tr_b16 v[200:201], v26 offset:32768
  v_lshlrev_b32 v82, 16, v174
  v_and_b32 v83, s29, v174
  v_fmac_f32 v33, v80, v80
  v_fmac_f32 v35, v81, v81
  s_waitcnt lgkmcnt(2)
  v_mfma_f32_32x32x16_bf16 v[104:119], v[124:127], v[184:187], v[104:119]
  ds_read_b64_tr_b16 v[202:203], v26 offset:33792
  ds_read_b128 v[156:159], v18 offset:36864
  v_lshlrev_b32 v84, 16, v175
  v_and_b32 v85, s29, v175
  v_fmac_f32 v33, v82, v82
  v_fmac_f32 v35, v83, v83
  v_fmac_f32 v33, v84, v84
  v_fmac_f32 v35, v85, v85
  s_add_u32 m0, s28, 16384
  s_add_u32 s30, s31, 15360
  buffer_load_dwordx4 v14, s[12:15], s31 offen lds
  s_waitcnt vmcnt(7) lgkmcnt(0)
  s_barrier
  v_mfma_f32_32x32x16_bf16 v[88:103], v[152:155], v[200:203], v[88:103]
  ds_read_b128 v[168:171], v19 offset:0
  ds_read_b64_tr_b16 v[184:185], v27 offset:0
  v_mfma_f32_32x32x16_bf16 v[104:119], v[156:159], v[200:203], v[104:119]
  ds_read_b64_tr_b16 v[186:187], v27 offset:1024
  ds_read_b128 v[172:175], v19 offset:4096
  s_add_u32 m0, s28, 17408
  s_nop 0
  buffer_load_dwordx4 v14, s[12:15], s30 offen lds
  s_waitcnt lgkmcnt(1)
  v_mfma_f32_32x32x16_bf16 v[88:103], v[168:171], v[184:187], v[88:103]
  ds_read_b128 v[152:155], v20 offset:0
  ds_read_b64_tr_b16 v[200:201], v28 offset:0
  v_lshlrev_b32 v78, 16, v168
  v_and_b32 v79, s29, v168
  v_lshlrev_b32 v80, 16, v169
  v_and_b32 v81, s29, v169
  s_waitcnt lgkmcnt(2)
  v_mfma_f32_32x32x16_bf16 v[104:119], v[172:175], v[184:187], v[104:119]
  ds_read_b64_tr_b16 v[202:203], v28 offset:1024
  ds_read_b128 v[156:159], v20 offset:4096
  v_fmac_f32 v32, v78, v78
  v_fmac_f32 v34, v79, v79
  v_lshlrev_b32 v82, 16, v170
  v_and_b32 v83, s29, v170
  v_mfma_f32_16x16x32_bf16 v[48:51], v[44:47], v[168:171], v[48:51]
  v_mfma_f32_16x16x32_bf16 v[52:55], v[44:47], v[172:175], v[52:55]
  v_mfma_f32_16x16x32_bf16 v[40:43], v[44:47], v[184:187], v[40:43]
  v_fmac_f32 v32, v80, v80
  v_fmac_f32 v34, v81, v81
  v_lshlrev_b32 v84, 16, v171
  s_add_u32 m0, s28, 32768
  s_add_u32 s30, s26, 1152
  buffer_load_dwordx4 v12, s[8:11], s30 offen lds
  s_waitcnt lgkmcnt(1)
  v_mfma_f32_32x32x16_bf16 v[88:103], v[152:155], v[200:203], v[88:103]
  ds_read_b128 v[120:123], v21 offset:0
  ds_read_b64_tr_b16 v[184:185], v29 offset:0
  v_and_b32 v85, s29, v171
  v_fmac_f32 v32, v82, v82
  v_fmac_f32 v34, v83, v83
  v_lshlrev_b32 v78, 16, v172
  s_waitcnt lgkmcnt(2)
  v_mfma_f32_32x32x16_bf16 v[104:119], v[156:159], v[200:203], v[104:119]
  ds_read_b64_tr_b16 v[186:187], v29 offset:1024
  ds_read_b128 v[124:127], v21 offset:4096
  v_and_b32 v79, s29, v172
  v_fmac_f32 v32, v84, v84
  v_fmac_f32 v34, v85, v85
  v_lshlrev_b32 v80, 16, v173
  v_mfma_f32_16x16x32_bf16 v[40:43], v[44:47], v[200:203], v[40:43]
  v_and_b32 v81, s29, v173
  v_fmac_f32 v33, v78, v78
  v_fmac_f32 v35, v79, v79
  s_add_u32 m0, s28, 33792
  s_add_u32 s31, s27, 2211840
  buffer_load_dwordx4 v13, s[8:11], s30 offen lds
  s_waitcnt lgkmcnt(1)
  v_mfma_f32_32x32x16_bf16 v[88:103], v[120:123], v[184:187], v[88:103]
  ds_read_b128 v[152:155], v22 offset:0
  ds_read_b64_tr_b16 v[200:201], v30 offset:0
  v_lshlrev_b32 v82, 16, v174
  v_and_b32 v83, s29, v174
  v_fmac_f32 v33, v80, v80
  v_fmac_f32 v35, v81, v81
  s_waitcnt lgkmcnt(2)
  v_mfma_f32_32x32x16_bf16 v[104:119], v[124:127], v[184:187], v[104:119]
  ds_read_b64_tr_b16 v[202:203], v30 offset:1024
  ds_read_b128 v[156:159], v22 offset:4096
  v_lshlrev_b32 v84, 16, v175
  v_and_b32 v85, s29, v175
  v_fmac_f32 v33, v82, v82
  v_fmac_f32 v35, v83, v83
  v_fmac_f32 v33, v84, v84
  v_fmac_f32 v35, v85, v85
  s_add_u32 m0, s28, 49152
  s_add_u32 s30, s31, 15360
  buffer_load_dwordx4 v14, s[12:15], s31 offen lds
  s_waitcnt vmcnt(7) lgkmcnt(0)
  s_barrier
  v_mfma_f32_32x32x16_bf16 v[88:103], v[152:155], v[200:203], v[88:103]
  ds_read_b128 v[168:171], v19 offset:32768
  ds_read_b64_tr_b16 v[184:185], v27 offset:32768
  v_mfma_f32_32x32x16_bf16 v[104:119], v[156:159], v[200:203], v[104:119]
  ds_read_b64_tr_b16 v[186:187], v27 offset:33792
  ds_read_b128 v[172:175], v19 offset:36864
  s_add_u32 m0, s28, 50176
  s_nop 0
  buffer_load_dwordx4 v14, s[12:15], s30 offen lds
  s_waitcnt lgkmcnt(1)
  v_mfma_f32_32x32x16_bf16 v[88:103], v[168:171], v[184:187], v[88:103]
  ds_read_b128 v[152:155], v20 offset:32768
  ds_read_b64_tr_b16 v[200:201], v28 offset:32768
  v_lshlrev_b32 v78, 16, v168
  v_and_b32 v79, s29, v168
  v_lshlrev_b32 v80, 16, v169
  v_and_b32 v81, s29, v169
  s_waitcnt lgkmcnt(2)
  v_mfma_f32_32x32x16_bf16 v[104:119], v[172:175], v[184:187], v[104:119]
  ds_read_b64_tr_b16 v[202:203], v28 offset:33792
  ds_read_b128 v[156:159], v20 offset:36864
  v_fmac_f32 v32, v78, v78
  v_fmac_f32 v34, v79, v79
  v_lshlrev_b32 v82, 16, v170
  v_and_b32 v83, s29, v170
  v_mfma_f32_16x16x32_bf16 v[48:51], v[44:47], v[168:171], v[48:51]
  v_mfma_f32_16x16x32_bf16 v[52:55], v[44:47], v[172:175], v[52:55]
  v_mfma_f32_16x16x32_bf16 v[40:43], v[44:47], v[184:187], v[40:43]
  v_fmac_f32 v32, v80, v80
  v_fmac_f32 v34, v81, v81
  v_lshlrev_b32 v84, 16, v171
  s_waitcnt lgkmcnt(1)
  v_mfma_f32_32x32x16_bf16 v[88:103], v[152:155], v[200:203], v[88:103]
  ds_read_b128 v[120:123], v21 offset:32768
  ds_read_b64_tr_b16 v[184:185], v29 offset:32768
  v_and_b32 v85, s29, v171
  v_fmac_f32 v32, v82, v82
  v_fmac_f32 v34, v83, v83
  v_lshlrev_b32 v78, 16, v172
  s_waitcnt lgkmcnt(2)
  v_mfma_f32_32x32x16_bf16 v[104:119], v[156:159], v[200:203], v[104:119]
  ds_read_b64_tr_b16 v[186:187], v29 offset:33792
  ds_read_b128 v[124:127], v21 offset:36864
  v_and_b32 v79, s29, v172
  v_fmac_f32 v32, v84, v84
  v_fmac_f32 v34, v85, v85
  v_lshlrev_b32 v80, 16, v173
  v_mfma_f32_16x16x32_bf16 v[40:43], v[44:47], v[200:203], v[40:43]
  v_and_b32 v81, s29, v173
  v_fmac_f32 v33, v78, v78
  v_fmac_f32 v35, v79, v79
  s_waitcnt lgkmcnt(1)
  v_mfma_f32_32x32x16_bf16 v[88:103], v[120:123], v[184:187], v[88:103]
  ds_read_b128 v[152:155], v22 offset:32768
  ds_read_b64_tr_b16 v[200:201], v30 offset:32768
  v_lshlrev_b32 v82, 16, v174
  v_and_b32 v83, s29, v174
  v_fmac_f32 v33, v80, v80
  v_fmac_f32 v35, v81, v81
  s_waitcnt lgkmcnt(2)
  v_mfma_f32_32x32x16_bf16 v[104:119], v[124:127], v[184:187], v[104:119]
  ds_read_b64_tr_b16 v[202:203], v30 offset:33792
  ds_read_b128 v[156:159], v22 offset:36864
  v_lshlrev_b32 v84, 16, v175
  v_and_b32 v85, s29, v175
  v_fmac_f32 v33, v82, v82
  v_fmac_f32 v35, v83, v83
  v_fmac_f32 v33, v84, v84
  v_fmac_f32 v35, v85, v85
  s_waitcnt vmcnt(4) lgkmcnt(0)
  s_barrier
  v_mfma_f32_32x32x16_bf16 v[88:103], v[152:155], v[200:203], v[88:103]
  ds_read_b128 v[168:171], v15 offset:0
  ds_read_b64_tr_b16 v[184:185], v23 offset:0
  v_mfma_f32_32x32x16_bf16 v[104:119], v[156:159], v[200:203], v[104:119]
  ds_read_b64_tr_b16 v[186:187], v23 offset:1024
  ds_read_b128 v[172:175], v15 offset:4096
  s_waitcnt lgkmcnt(1)
  v_mfma_f32_32x32x16_bf16 v[88:103], v[168:171], v[184:187], v[88:103]
  ds_read_b128 v[152:155], v16 offset:0
  ds_read_b64_tr_b16 v[200:201], v24 offset:0
  v_lshlrev_b32 v78, 16, v168
  v_and_b32 v79, s29, v168
  v_lshlrev_b32 v80, 16, v169
  v_and_b32 v81, s29, v169
  s_waitcnt lgkmcnt(2)
  v_mfma_f32_32x32x16_bf16 v[104:119], v[172:175], v[184:187], v[104:119]
  ds_read_b64_tr_b16 v[202:203], v24 offset:1024
  ds_read_b128 v[156:159], v16 offset:4096
  v_fmac_f32 v32, v78, v78
  v_fmac_f32 v34, v79, v79
  v_lshlrev_b32 v82, 16, v170
  v_and_b32 v83, s29, v170
  v_mfma_f32_16x16x32_bf16 v[48:51], v[44:47], v[168:171], v[48:51]
  v_mfma_f32_16x16x32_bf16 v[52:55], v[44:47], v[172:175], v[52:55]
  v_mfma_f32_16x16x32_bf16 v[40:43], v[44:47], v[184:187], v[40:43]
  v_fmac_f32 v32, v80, v80
  v_fmac_f32 v34, v81, v81
  v_lshlrev_b32 v84, 16, v171
  s_waitcnt lgkmcnt(1)
  v_mfma_f32_32x32x16_bf16 v[88:103], v[152:155], v[200:203], v[88:103]
  ds_read_b128 v[120:123], v17 offset:0
  ds_read_b64_tr_b16 v[184:185], v25 offset:0
  v_and_b32 v85, s29, v171
  v_fmac_f32 v32, v82, v82
  v_fmac_f32 v34, v83, v83
  v_lshlrev_b32 v78, 16, v172
  s_waitcnt lgkmcnt(2)
  v_mfma_f32_32x32x16_bf16 v[104:119], v[156:159], v[200:203], v[104:119]
  ds_read_b64_tr_b16 v[186:187], v25 offset:1024
  ds_read_b128 v[124:127], v17 offset:4096
  v_and_b32 v79, s29, v172
  v_fmac_f32 v32, v84, v84
  v_fmac_f32 v34, v85, v85
  v_lshlrev_b32 v80, 16, v173
  v_mfma_f32_16x16x32_bf16 v[40:43], v[44:47], v[200:203], v[40:43]
  v_and_b32 v81, s29, v173
  v_fmac_f32 v33, v78, v78
  v_fmac_f32 v35, v79, v79
  s_waitcnt lgkmcnt(1)
  v_mfma_f32_32x32x16_bf16 v[88:103], v[120:123], v[184:187], v[88:103]
  ds_read_b128 v[152:155], v18 offset:0
  ds_read_b64_tr_b16 v[200:201], v26 offset:0
  v_lshlrev_b32 v82, 16, v174
  v_and_b32 v83, s29, v174
  v_fmac_f32 v33, v80, v80
  v_fmac_f32 v35, v81, v81
  s_waitcnt lgkmcnt(2)
  v_mfma_f32_32x32x16_bf16 v[104:119], v[124:127], v[184:187], v[104:119]
  ds_read_b64_tr_b16 v[202:203], v26 offset:1024
  ds_read_b128 v[156:159], v18 offset:4096
  v_lshlrev_b32 v84, 16, v175
  v_and_b32 v85, s29, v175
  v_fmac_f32 v33, v82, v82
  v_fmac_f32 v35, v83, v83
  v_fmac_f32 v33, v84, v84
  v_fmac_f32 v35, v85, v85
  s_waitcnt vmcnt(0) lgkmcnt(0)
  s_barrier
  v_mfma_f32_32x32x16_bf16 v[88:103], v[152:155], v[200:203], v[88:103]
  ds_read_b128 v[168:171], v15 offset:32768
  ds_read_b64_tr_b16 v[184:185], v23 offset:32768
  v_mfma_f32_32x32x16_bf16 v[104:119], v[156:159], v[200:203], v[104:119]
  ds_read_b64_tr_b16 v[186:187], v23 offset:33792
  ds_read_b128 v[172:175], v15 offset:36864
  s_waitcnt lgkmcnt(1)
  v_mfma_f32_32x32x16_bf16 v[88:103], v[168:171], v[184:187], v[88:103]
  ds_read_b128 v[152:155], v16 offset:32768
  ds_read_b64_tr_b16 v[200:201], v24 offset:32768
  v_lshlrev_b32 v78, 16, v168
  v_and_b32 v79, s29, v168
  v_lshlrev_b32 v80, 16, v169
  v_and_b32 v81, s29, v169
  s_waitcnt lgkmcnt(2)
  v_mfma_f32_32x32x16_bf16 v[104:119], v[172:175], v[184:187], v[104:119]
  ds_read_b64_tr_b16 v[202:203], v24 offset:33792
  ds_read_b128 v[156:159], v16 offset:36864
  v_fmac_f32 v32, v78, v78
  v_fmac_f32 v34, v79, v79
  v_lshlrev_b32 v82, 16, v170
  v_and_b32 v83, s29, v170
  v_mfma_f32_16x16x32_bf16 v[48:51], v[44:47], v[168:171], v[48:51]
  v_mfma_f32_16x16x32_bf16 v[52:55], v[44:47], v[172:175], v[52:55]
  v_mfma_f32_16x16x32_bf16 v[40:43], v[44:47], v[184:187], v[40:43]
  v_fmac_f32 v32, v80, v80
  v_fmac_f32 v34, v81, v81
  v_lshlrev_b32 v84, 16, v171
  s_waitcnt lgkmcnt(1)
  v_mfma_f32_32x32x16_bf16 v[88:103], v[152:155], v[200:203], v[88:103]
  ds_read_b128 v[120:123], v17 offset:32768
  ds_read_b64_tr_b16 v[184:185], v25 offset:32768
  v_and_b32 v85, s29, v171
  v_fmac_f32 v32, v82, v82
  v_fmac_f32 v34, v83, v83
  v_lshlrev_b32 v78, 16, v172
  s_waitcnt lgkmcnt(2)
  v_mfma_f32_32x32x16_bf16 v[104:119], v[156:159], v[200:203], v[104:119]
  ds_read_b64_tr_b16 v[186:187], v25 offset:33792
  ds_read_b128 v[124:127], v17 offset:36864
  v_and_b32 v79, s29, v172
  v_fmac_f32 v32, v84, v84
  v_fmac_f32 v34, v85, v85
  v_lshlrev_b32 v80, 16, v173
  v_mfma_f32_16x16x32_bf16 v[40:43], v[44:47], v[200:203], v[40:43]
  v_and_b32 v81, s29, v173
  v_fmac_f32 v33, v78, v78
  v_fmac_f32 v35, v79, v79
  s_waitcnt lgkmcnt(1)
  v_mfma_f32_32x32x16_bf16 v[88:103], v[120:123], v[184:187], v[88:103]
  ds_read_b128 v[152:155], v18 offset:32768
  ds_read_b64_tr_b16 v[200:201], v26 offset:32768
  v_lshlrev_b32 v82, 16, v174
  v_and_b32 v83, s29, v174
  v_fmac_f32 v33, v80, v80
  v_fmac_f32 v35, v81, v81
  s_waitcnt lgkmcnt(2)
  v_mfma_f32_32x32x16_bf16 v[104:119], v[124:127], v[184:187], v[104:119]
  ds_read_b64_tr_b16 v[202:203], v26 offset:33792
  ds_read_b128 v[156:159], v18 offset:36864
  v_lshlrev_b32 v84, 16, v175
  v_and_b32 v85, s29, v175
  v_fmac_f32 v33, v82, v82
  v_fmac_f32 v35, v83, v83
  v_fmac_f32 v33, v84, v84
  v_fmac_f32 v35, v85, v85
  s_waitcnt lgkmcnt(1)
  v_mfma_f32_32x32x16_bf16 v[88:103], v[152:155], v[200:203], v[88:103]
  s_waitcnt lgkmcnt(0)
  v_mfma_f32_32x32x16_bf16 v[104:119], v[156:159], v[200:203], v[104:119]
  s_lshr_b32 s43, s19, 1
  s_mul_i32 s43, s43, 30720
  s_and_b32 s41, s19, 1
  s_add_u32 s43, s43, 10240
  s_mul_i32 s81, s81, s41
  s_add_u32 s80, s80, s81
  s_add_u32 s80, s80, s43
  s_mul_i32 s85, s85, s41
  s_add_u32 s84, s84, s85
  s_add_u32 s84, s84, s43
  s_mul_i32 s89, s89, s41
  s_add_u32 s88, s88, s89
  s_add_u32 s88, s88, s43
  s_mul_i32 s93, s93, s41
  s_add_u32 s92, s92, s93
  s_add_u32 s92, s92, s43
  s_mul_i32 s97, s97, s41
  s_add_u32 s96, s96, s97
  s_add_u32 s96, s96, s43
L_qkv_kernel_epi_6:
  v_mov_b32 v77, 0
  buffer_load_dword v76, v77, s[56:59], 0 offen sc1
  s_nop 7
  v_add_f32 v32, v32, v34
  v_add_f32 v33, v33, v35
  v_and_b32 v2, 31, v1
  v_lshrrev_b32 v3, 5, v1
  s_lshl_b32 s22, s17, 11
  s_lshl_b32 s23, s18, 3
  s_add_u32 s22, s22, s23
  s_add_u32 s22, s22, 135168
  v_lshlrev_b32 v4, 5, v2
  v_lshl_add_u32 v4, v3, 2, v4
  v_add_u32 v4, s22, v4
  ds_write_b32 v4, v32
  ds_write_b32 v4, v33 offset:1024
  s_lshl_b32 s22, s17, 10
  s_lshl_b32 s23, s18, 2
  s_add_u32 s22, s22, s23
  s_add_u32 s22, s22, 131072
  v_and_b32 v5, 15, v1
  v_lshl_add_u32 v5, v3, 4, v5
  v_lshlrev_b32 v6, 4, v5
  v_add_u32 v6, s22, v6
  ds_write_b32 v6, v48
  ds_write_b32 v6, v52 offset:512
  s_lshl_b32 s22, s18, 8
  s_lshl_b32 s23, s17, 2
  s_add_u32 s22, s22, s23
  s_add_u32 s22, s22, 139264
  v_lshlrev_b32 v5, 3, v5
  v_add_u32 v5, s22, v5
  ds_write_b32 v5, v40
  s_waitcnt lgkmcnt(0)
  s_barrier
  s_cmp_ge_u32 s16, 2
  s_cbranch_scc1 L_qkv_kernel_red2_9
  v_lshlrev_b32 v4, 5, v0
  v_add_u32 v4, 135168, v4
  v_lshlrev_b32 v5, 4, v0
  v_add_u32 v5, 131072, v5
  ds_read_b128 v[120:123], v5
  ds_read_b128 v[128:131], v4
  ds_read_b128 v[132:135], v4 offset:16
  s_waitcnt lgkmcnt(0)
  v_add_f32 v120, v120, v121
  v_add_f32 v122, v122, v123
  v_add_f32 v120, v120, v122
  v_add_f32 v128, v128, v129
  v_add_f32 v130, v130, v131
  v_add_f32 v132, v132, v133
  v_add_f32 v134, v134, v135
  v_add_f32 v128, v128, v130
  v_add_f32 v132, v132, v134
  v_add_f32 v128, v128, v132
  v_mul_f32 v120, 986500301, v120
  v_mul_f32 v128, 986500301, v128
  v_fma_f32 v128, -v120, v120, v128
  v_max_f32 v128, 0, v128
  v_add_f32 v128, 925353388, v128
  v_rsq_f32 v128, v128
  s_cmp_eq_u32 s21, 0
  s_cselect_b32 s22, 1051011932, 1.0
  v_mul_f32 v128, s22, v128
  v_sub_f32 v120, 0, v120
  v_lshlrev_b32 v4, 2, v0
  v_add_u32 v4, 141312, v4
  ds_write_b32 v4, v128
  ds_write_b32 v4, v120 offset:512
  s_branch L_qkv_kernel_red3_10
L_qkv_kernel_red2_9:
  s_cmp_ge_u32 s16, 4
  s_cbranch_scc1 L_qkv_kernel_red3_10
  v_subrev_u32 v4, 128, v0
  v_lshlrev_b32 v5, 3, v4
  v_add_u32 v5, 139264, v5
  ds_read_b64 v[120:121], v5
  s_waitcnt lgkmcnt(0)
  v_add_f32 v120, v120, v121
  v_lshlrev_b32 v4, 2, v4
  v_add_u32 v4, 142336, v4
  ds_write_b32 v4, v120
L_qkv_kernel_red3_10:
  s_waitcnt lgkmcnt(0)
  s_barrier
  s_cmp_eq_u32 s21, 2
  s_cbranch_scc1 L_qkv_kernel_vepi_11
  s_lshl_b32 s22, s17, 8
  s_add_u32 s22, s22, 141312
  v_lshl_add_u32 v4, v2, 2, s22
  ds_read_b32 v6, v4
  ds_read_b32 v7, v4 offset:512
  ds_read_b32 v8, v4 offset:128
  ds_read_b32 v9, v4 offset:640
  s_lshl_b32 s22, s18, 7
  s_add_u32 s22, s22, 142336
  v_lshl_add_u32 v4, v3, 4, s22
  ds_read_b128 v[120:123], v4 offset:0
  ds_read_b128 v[124:127], v4 offset:32
  ds_read_b128 v[128:131], v4 offset:64
  ds_read_b128 v[132:135], v4 offset:96
  s_waitcnt lgkmcnt(0)
  v_fmac_f32 v88, v120, v7
  v_fmac_f32 v89, v121, v7
  v_fmac_f32 v90, v122, v7
  v_fmac_f32 v91, v123, v7
  v_fmac_f32 v92, v124, v7
  v_fmac_f32 v93, v125, v7
  v_fmac_f32 v94, v126, v7
  v_fmac_f32 v95, v127, v7
  v_fmac_f32 v96, v128, v7
  v_fmac_f32 v97, v129, v7
  v_fmac_f32 v98, v130, v7
  v_fmac_f32 v99, v131, v7
  v_fmac_f32 v100, v132, v7
  v_fmac_f32 v101, v133, v7
  v_fmac_f32 v102, v134, v7
  v_fmac_f32 v103, v135, v7
  v_mul_f32 v88, v88, v6
  v_mul_f32 v89, v89, v6
  v_mul_f32 v90, v90, v6
  v_mul_f32 v91, v91, v6
  v_mul_f32 v92, v92, v6
  v_mul_f32 v93, v93, v6
  v_mul_f32 v94, v94, v6
  v_mul_f32 v95, v95, v6
  v_mul_f32 v96, v96, v6
  v_mul_f32 v97, v97, v6
  v_mul_f32 v98, v98, v6
  v_mul_f32 v99, v99, v6
  v_mul_f32 v100, v100, v6
  v_mul_f32 v101, v101, v6
  v_mul_f32 v102, v102, v6
  v_mul_f32 v103, v103, v6
  v_cvt_pk_bf16_f32 v144, v88, v89
  v_cvt_pk_bf16_f32 v145, v90, v91
  ds_write_b64 v61, v[144:145]
  v_cvt_pk_bf16_f32 v146, v92, v93
  v_cvt_pk_bf16_f32 v147, v94, v95
  ds_write_b64 v63, v[146:147]
  v_cvt_pk_bf16_f32 v148, v96, v97
  v_cvt_pk_bf16_f32 v149, v98, v99
  ds_write_b64 v65, v[148:149]
  v_cvt_pk_bf16_f32 v150, v100, v101
  v_cvt_pk_bf16_f32 v151, v102, v103
  ds_write_b64 v67, v[150:151]
  v_fmac_f32 v104, v120, v9
  v_fmac_f32 v105, v121, v9
  v_fmac_f32 v106, v122, v9
  v_fmac_f32 v107, v123, v9
  v_fmac_f32 v108, v124, v9
  v_fmac_f32 v109, v125, v9
  v_fmac_f32 v110, v126, v9
  v_fmac_f32 v111, v127, v9
  v_fmac_f32 v112, v128, v9
  v_fmac_f32 v113, v129, v9
  v_fmac_f32 v114, v130, v9
  v_fmac_f32 v115, v131, v9
  v_fmac_f32 v116, v132, v9
  v_fmac_f32 v117, v133, v9
  v_fmac_f32 v118, v134, v9
  v_fmac_f32 v119, v135, v9
  v_mul_f32 v104, v104, v8
  v_mul_f32 v105, v105, v8
  v_mul_f32 v106, v106, v8
  v_mul_f32 v107, v107, v8
  v_mul_f32 v108, v108, v8
  v_mul_f32 v109, v109, v8
  v_mul_f32 v110, v110, v8
  v_mul_f32 v111, v111, v8
  v_mul_f32 v112, v112, v8
  v_mul_f32 v113, v113, v8
  v_mul_f32 v114, v114, v8
  v_mul_f32 v115, v115, v8
  v_mul_f32 v116, v116, v8
  v_mul_f32 v117, v117, v8
  v_mul_f32 v118, v118, v8
  v_mul_f32 v119, v119, v8
  v_cvt_pk_bf16_f32 v152, v104, v105
  v_cvt_pk_bf16_f32 v153, v106, v107
  ds_write_b64 v62, v[152:153]
  v_cvt_pk_bf16_f32 v154, v108, v109
  v_cvt_pk_bf16_f32 v155, v110, v111
  ds_write_b64 v64, v[154:155]
  v_cvt_pk_bf16_f32 v156, v112, v113
  v_cvt_pk_bf16_f32 v157, v114, v115
  ds_write_b64 v66, v[156:157]
  v_cvt_pk_bf16_f32 v158, v116, v117
  v_cvt_pk_bf16_f32 v159, v118, v119
  ds_write_b64 v68, v[158:159]
  s_branch L_qkv_kernel_copy_12
L_qkv_kernel_vepi_11:
  s_lshl_b32 s22, s18, 7
  s_add_u32 s22, s22, 142336
  v_lshl_add_u32 v4, v2, 2, s22
  ds_read_b32 v6, v4
  s_lshl_b32 s22, s17, 8
  s_add_u32 s22, s22, 141312
  v_lshl_add_u32 v4, v3, 4, s22
  ds_read_b128 v[120:123], v4 offset:0
  ds_read_b128 v[152:155], v4 offset:512
  ds_read_b128 v[124:127], v4 offset:32
  ds_read_b128 v[156:159], v4 offset:544
  ds_read_b128 v[128:131], v4 offset:64
  ds_read_b128 v[160:163], v4 offset:576
  ds_read_b128 v[132:135], v4 offset:96
  ds_read_b128 v[164:167], v4 offset:608
  ds_read_b128 v[136:139], v4 offset:128
  ds_read_b128 v[168:171], v4 offset:640
  ds_read_b128 v[140:143], v4 offset:160
  ds_read_b128 v[172:175], v4 offset:672
  ds_read_b128 v[144:147], v4 offset:192
  ds_read_b128 v[176:179], v4 offset:704
  ds_read_b128 v[148:151], v4 offset:224
  ds_read_b128 v[180:183], v4 offset:736
  s_waitcnt lgkmcnt(0)
  v_fmac_f32 v88, v6, v152
  v_fmac_f32 v89, v6, v153
  v_fmac_f32 v90, v6, v154
  v_fmac_f32 v91, v6, v155
  v_fmac_f32 v92, v6, v156
  v_fmac_f32 v93, v6, v157
  v_fmac_f32 v94, v6, v158
  v_fmac_f32 v95, v6, v159
  v_fmac_f32 v96, v6, v160
  v_fmac_f32 v97, v6, v161
  v_fmac_f32 v98, v6, v162
  v_fmac_f32 v99, v6, v163
  v_fmac_f32 v100, v6, v164
  v_fmac_f32 v101, v6, v165
  v_fmac_f32 v102, v6, v166
  v_fmac_f32 v103, v6, v167
  v_mul_f32 v88, v88, v120
  v_mul_f32 v89, v89, v121
  v_mul_f32 v90, v90, v122
  v_mul_f32 v91, v91, v123
  v_mul_f32 v92, v92, v124
  v_mul_f32 v93, v93, v125
  v_mul_f32 v94, v94, v126
  v_mul_f32 v95, v95, v127
  v_mul_f32 v96, v96, v128
  v_mul_f32 v97, v97, v129
  v_mul_f32 v98, v98, v130
  v_mul_f32 v99, v99, v131
  v_mul_f32 v100, v100, v132
  v_mul_f32 v101, v101, v133
  v_mul_f32 v102, v102, v134
  v_mul_f32 v103, v103, v135
  v_cvt_pk_bf16_f32 v184, v88, v89
  v_cvt_pk_bf16_f32 v185, v90, v91
  v_cvt_pk_bf16_f32 v186, v92, v93
  v_cvt_pk_bf16_f32 v187, v94, v95
  ds_write_b128 v61, v[184:187] offset:0
  v_cvt_pk_bf16_f32 v188, v96, v97
  v_cvt_pk_bf16_f32 v189, v98, v99
  v_cvt_pk_bf16_f32 v190, v100, v101
  v_cvt_pk_bf16_f32 v191, v102, v103
  ds_write_b128 v61, v[188:191] offset:640
  v_fmac_f32 v104, v6, v168
  v_fmac_f32 v105, v6, v169
  v_fmac_f32 v106, v6, v170
  v_fmac_f32 v107, v6, v171
  v_fmac_f32 v108, v6, v172
  v_fmac_f32 v109, v6, v173
  v_fmac_f32 v110, v6, v174
  v_fmac_f32 v111, v6, v175
  v_fmac_f32 v112, v6, v176
  v_fmac_f32 v113, v6, v177
  v_fmac_f32 v114, v6, v178
  v_fmac_f32 v115, v6, v179
  v_fmac_f32 v116, v6, v180
  v_fmac_f32 v117, v6, v181
  v_fmac_f32 v118, v6, v182
  v_fmac_f32 v119, v6, v183
  v_mul_f32 v104, v104, v136
  v_mul_f32 v105, v105, v137
  v_mul_f32 v106, v106, v138
  v_mul_f32 v107, v107, v139
  v_mul_f32 v108, v108, v140
  v_mul_f32 v109, v109, v141
  v_mul_f32 v110, v110, v142
  v_mul_f32 v111, v111, v143
  v_mul_f32 v112, v112, v144
  v_mul_f32 v113, v113, v145
  v_mul_f32 v114, v114, v146
  v_mul_f32 v115, v115, v147
  v_mul_f32 v116, v116, v148
  v_mul_f32 v117, v117, v149
  v_mul_f32 v118, v118, v150
  v_mul_f32 v119, v119, v151
  v_cvt_pk_bf16_f32 v192, v104, v105
  v_cvt_pk_bf16_f32 v193, v106, v107
  v_cvt_pk_bf16_f32 v194, v108, v109
  v_cvt_pk_bf16_f32 v195, v110, v111
  ds_write_b128 v61, v[192:195] offset:1280
  v_cvt_pk_bf16_f32 v196, v112, v113
  v_cvt_pk_bf16_f32 v197, v114, v115
  v_cvt_pk_bf16_f32 v198, v116, v117
  v_cvt_pk_bf16_f32 v199, v118, v119
  ds_write_b128 v61, v[196:199] offset:1920
L_qkv_kernel_copy_12:
  s_waitcnt lgkmcnt(0)
  s_barrier
  s_lshl_b32 s52, s16, 10
  v_add_u32 v4, s52, v69
  ds_read_b128 v[164:167], v4 offset:0
  ds_read_b128 v[168:171], v4 offset:8192
  ds_read_b128 v[172:175], v4 offset:16384
  ds_read_b128 v[176:179], v4 offset:24576
  ds_read_b128 v[180:183], v4 offset:32768
  s_waitcnt lgkmcnt(4)
  s_mov_b64 exec, s[82:83]
  buffer_store_dwordx4 v[164:167], v69, s[36:39], s80 offen sc1
  s_waitcnt lgkmcnt(3)
  s_mov_b64 exec, s[86:87]
  buffer_store_dwordx4 v[168:171], v69, s[36:39], s84 offen sc1
  s_waitcnt lgkmcnt(2)
  s_mov_b64 exec, s[90:91]
  buffer_store_dwordx4 v[172:175], v69, s[36:39], s88 offen sc1
  s_waitcnt lgkmcnt(1)
  s_mov_b64 exec, s[94:95]
  buffer_store_dwordx4 v[176:179], v69, s[36:39], s92 offen sc1
  s_waitcnt lgkmcnt(0)
  s_mov_b64 exec, s[98:99]
  buffer_store_dwordx4 v[180:183], v69, s[36:39], s96 offen sc1
  s_mov_b64 exec, -1
L_qkv_end:
  s_waitcnt vmcnt(0)
  s_barrier
  s_cmp_lg_u32 s16, 0
  s_cbranch_scc1 L_qkv_kernel_nosig_13
  v_readfirstlane_b32 s100, v76
  s_nop 3
  s_cmp_lg_u32 s100, 0
  s_cbranch_scc1 L_qkv_kernel_nok_14
  s_mov_b32 s87, 0x40000
  v_mov_b32 v4, 0
L_qkv_kernel_nonce_15:
  buffer_load_dword v5, v4, s[56:59], 0 offen sc1
  s_waitcnt vmcnt(0)
  v_readfirstlane_b32 s100, v5
  s_nop 3
  s_cmp_lg_u32 s100, 0
  s_cbranch_scc1 L_qkv_kernel_nonce_done_16
  s_sleep 1
  s_sub_u32 s87, s87, 1
  s_cmp_lg_u32 s87, 0
  s_cbranch_scc1 L_qkv_kernel_nonce_15
L_qkv_kernel_nonce_done_16:
L_qkv_kernel_nok_14:
  s_add_u32 s96, s36, 24049664
  s_addc_u32 s97, s37, 0
  s_and_b32 s97, s97, 0xffff
  s_mov_b32 s98, 12288
  s_mov_b32 s99, 0x20000
  s_lshl_b32 s87, s20, 4
  s_add_u32 s87, s87, s19
  s_lshl_b32 s87, s87, 2
  s_add_u32 s87, s87, 0
  s_mov_b64 exec, 1
  v_mov_b32 v4, 0
  v_mov_b32 v5, s100
  buffer_store_dword v5, v4, s[96:99], s87 offen sc1
  s_mov_b64 exec, -1
L_qkv_kernel_nosig_13:
L_qkv_kernel_done_1:
  s_endpgm
L_qkv_kernel_colsum_3:
  s_load_dwordx4 s[44:47], s[0:1], 32
  v_mul_u32_u24 v2, 2428, v0
  v_lshrrev_b32 v2, 16, v2
  v_mul_u32_u24 v3, 27, v2
  v_sub_u32 v3, v0, v3
  s_and_b32 s22, s19, 7
  s_mul_i32 s22, s22, 432
  v_mul_u32_u24 v4, 138240, v2
  v_lshl_add_u32 v4, v3, 4, v4
  v_add_u32 v4, s22, v4
  s_waitcnt lgkmcnt(0)
  s_cmp_ge_u32 s19, 8
  s_cselect_b32 s8, s46, s44
  s_cselect_b32 s9, s47, s45
  s_and_b32 s9, s9, 0xffff
  s_mov_b32 s10, 2211840
  s_mov_b32 s11, 0x20000
  v_mov_b32 v120, 0
  v_mov_b32 v121, 0
  v_mov_b32 v122, 0
  v_mov_b32 v123, 0
  v_mov_b32 v124, 0
  v_mov_b32 v125, 0
  v_mov_b32 v126, 0
  v_mov_b32 v127, 0
  v_cmp_gt_u32 vcc, 16, v2
  s_and_saveexec_b64 s[40:41], vcc
  s_cbranch_execz L_qkv_kernel_cs_skip_17
  s_mov_b32 s23, 0
L_qkv_kernel_cs_loop_18:
  buffer_load_dwordx4 v[128:131], v4, s[8:11], s23 offen
  s_add_u32 s23, s23, 3456
  buffer_load_dwordx4 v[132:135], v4, s[8:11], s23 offen
  s_add_u32 s23, s23, 3456
  buffer_load_dwordx4 v[136:139], v4, s[8:11], s23 offen
  s_add_u32 s23, s23, 3456
  buffer_load_dwordx4 v[140:143], v4, s[8:11], s23 offen
  s_add_u32 s23, s23, 3456
  buffer_load_dwordx4 v[144:147], v4, s[8:11], s23 offen
  s_add_u32 s23, s23, 3456
  buffer_load_dwordx4 v[148:151], v4, s[8:11], s23 offen
  s_add_u32 s23, s23, 3456
  buffer_load_dwordx4 v[152:155], v4, s[8:11], s23 offen
  s_add_u32 s23, s23, 3456
  buffer_load_dwordx4 v[156:159], v4, s[8:11], s23 offen
  s_add_u32 s23, s23, 3456
  buffer_load_dwordx4 v[160:163], v4, s[8:11], s23 offen
  s_add_u32 s23, s23, 3456
  buffer_load_dwordx4 v[164:167], v4, s[8:11], s23 offen
  s_add_u32 s23, s23, 3456
  s_waitcnt vmcnt(9)
  v_lshlrev_b32 v6, 16, v128
  v_and_b32 v7, 0xffff0000, v128
  v_add_f32 v120, v120, v6
  v_add_f32 v121, v121, v7
  v_lshlrev_b32 v6, 16, v129
  v_and_b32 v7, 0xffff0000, v129
  v_add_f32 v122, v122, v6
  v_add_f32 v123, v123, v7
  v_lshlrev_b32 v6, 16, v130
  v_and_b32 v7, 0xffff0000, v130
  v_add_f32 v124, v124, v6
  v_add_f32 v125, v125, v7
  v_lshlrev_b32 v6, 16, v131
  v_and_b32 v7, 0xffff0000, v131
  v_add_f32 v126, v126, v6
  v_add_f32 v127, v127, v7
  s_waitcnt vmcnt(8)
  v_lshlrev_b32 v6, 16, v132
  v_and_b32 v7, 0xffff0000, v132
  v_add_f32 v120, v120, v6
  v_add_f32 v121, v121, v7
  v_lshlrev_b32 v6, 16, v133
  v_and_b32 v7, 0xffff0000, v133
  v_add_f32 v122, v122, v6
  v_add_f32 v123, v123, v7
  v_lshlrev_b32 v6, 16, v134
  v_and_b32 v7, 0xffff0000, v134
  v_add_f32 v124, v124, v6
  v_add_f32 v125, v125, v7
  v_lshlrev_b32 v6, 16, v135
  v_and_b32 v7, 0xffff0000, v135
  v_add_f32 v126, v126, v6
  v_add_f32 v127, v127, v7
  s_waitcnt vmcnt(7)
  v_lshlrev_b32 v6, 16, v136
  v_and_b32 v7, 0xffff0000, v136
  v_add_f32 v120, v120, v6
  v_add_f32 v121, v121, v7
  v_lshlrev_b32 v6, 16, v137
  v_and_b32 v7, 0xffff0000, v137
  v_add_f32 v122, v122, v6
  v_add_f32 v123, v123, v7
  v_lshlrev_b32 v6, 16, v138
  v_and_b32 v7, 0xffff0000, v138
  v_add_f32 v124, v124, v6
  v_add_f32 v125, v125, v7
  v_lshlrev_b32 v6, 16, v139
  v_and_b32 v7, 0xffff0000, v139
  v_add_f32 v126, v126, v6
  v_add_f32 v127, v127, v7
  s_waitcnt vmcnt(6)
  v_lshlrev_b32 v6, 16, v140
  v_and_b32 v7, 0xffff0000, v140
  v_add_f32 v120, v120, v6
  v_add_f32 v121, v121, v7
  v_lshlrev_b32 v6, 16, v141
  v_and_b32 v7, 0xffff0000, v141
  v_add_f32 v122, v122, v6
  v_add_f32 v123, v123, v7
  v_lshlrev_b32 v6, 16, v142
  v_and_b32 v7, 0xffff0000, v142
  v_add_f32 v124, v124, v6
  v_add_f32 v125, v125, v7
  v_lshlrev_b32 v6, 16, v143
  v_and_b32 v7, 0xffff0000, v143
  v_add_f32 v126, v126, v6
  v_add_f32 v127, v127, v7
  s_waitcnt vmcnt(5)
  v_lshlrev_b32 v6, 16, v144
  v_and_b32 v7, 0xffff0000, v144
  v_add_f32 v120, v120, v6
  v_add_f32 v121, v121, v7
  v_lshlrev_b32 v6, 16, v145
  v_and_b32 v7, 0xffff0000, v145
  v_add_f32 v122, v122, v6
  v_add_f32 v123, v123, v7
  v_lshlrev_b32 v6, 16, v146
  v_and_b32 v7, 0xffff0000, v146
  v_add_f32 v124, v124, v6
  v_add_f32 v125, v125, v7
  v_lshlrev_b32 v6, 16, v147
  v_and_b32 v7, 0xffff0000, v147
  v_add_f32 v126, v126, v6
  v_add_f32 v127, v127, v7
  s_waitcnt vmcnt(4)
  v_lshlrev_b32 v6, 16, v148
  v_and_b32 v7, 0xffff0000, v148
  v_add_f32 v120, v120, v6
  v_add_f32 v121, v121, v7
  v_lshlrev_b32 v6, 16, v149
  v_and_b32 v7, 0xffff0000, v149
  v_add_f32 v122, v122, v6
  v_add_f32 v123, v123, v7
  v_lshlrev_b32 v6, 16, v150
  v_and_b32 v7, 0xffff0000, v150
  v_add_f32 v124, v124, v6
  v_add_f32 v125, v125, v7
  v_lshlrev_b32 v6, 16, v151
  v_and_b32 v7, 0xffff0000, v151
  v_add_f32 v126, v126, v6
  v_add_f32 v127, v127, v7
  s_waitcnt vmcnt(3)
  v_lshlrev_b32 v6, 16, v152
  v_and_b32 v7, 0xffff0000, v152
  v_add_f32 v120, v120, v6
  v_add_f32 v121, v121, v7
  v_lshlrev_b32 v6, 16, v153
  v_and_b32 v7, 0xffff0000, v153
  v_add_f32 v122, v122, v6
  v_add_f32 v123, v123, v7
  v_lshlrev_b32 v6, 16, v154
  v_and_b32 v7, 0xffff0000, v154
  v_add_f32 v124, v124, v6
  v_add_f32 v125, v125, v7
  v_lshlrev_b32 v6, 16, v155
  v_and_b32 v7, 0xffff0000, v155
  v_add_f32 v126, v126, v6
  v_add_f32 v127, v127, v7
  s_waitcnt vmcnt(2)
  v_lshlrev_b32 v6, 16, v156
  v_and_b32 v7, 0xffff0000, v156
  v_add_f32 v120, v120, v6
  v_add_f32 v121, v121, v7
  v_lshlrev_b32 v6, 16, v157
  v_and_b32 v7, 0xffff0000, v157
  v_add_f32 v122, v122, v6
  v_add_f32 v123, v123, v7
  v_lshlrev_b32 v6, 16, v158
  v_and_b32 v7, 0xffff0000, v158
  v_add_f32 v124, v124, v6
  v_add_f32 v125, v125, v7
  v_lshlrev_b32 v6, 16, v159
  v_and_b32 v7, 0xffff0000, v159
  v_add_f32 v126, v126, v6
  v_add_f32 v127, v127, v7
  s_waitcnt vmcnt(1)
  v_lshlrev_b32 v6, 16, v160
  v_and_b32 v7, 0xffff0000, v160
  v_add_f32 v120, v120, v6
  v_add_f32 v121, v121, v7
  v_lshlrev_b32 v6, 16, v161
  v_and_b32 v7, 0xffff0000, v161
  v_add_f32 v122, v122, v6
  v_add_f32 v123, v123, v7
  v_lshlrev_b32 v6, 16, v162
  v_and_b32 v7, 0xffff0000, v162
  v_add_f32 v124, v124, v6
  v_add_f32 v125, v125, v7
  v_lshlrev_b32 v6, 16, v163
  v_and_b32 v7, 0xffff0000, v163
  v_add_f32 v126, v126, v6
  v_add_f32 v127, v127, v7
  s_waitcnt vmcnt(0)
  v_lshlrev_b32 v6, 16, v164
  v_and_b32 v7, 0xffff0000, v164
  v_add_f32 v120, v120, v6
  v_add_f32 v121, v121, v7
  v_lshlrev_b32 v6, 16, v165
  v_and_b32 v7, 0xffff0000, v165
  v_add_f32 v122, v122, v6
  v_add_f32 v123, v123, v7
  v_lshlrev_b32 v6, 16, v166
  v_and_b32 v7, 0xffff0000, v166
  v_add_f32 v124, v124, v6
  v_add_f32 v125, v125, v7
  v_lshlrev_b32 v6, 16, v167
  v_and_b32 v7, 0xffff0000, v167
  v_add_f32 v126, v126, v6
  v_add_f32 v127, v127, v7
  s_cmp_lt_u32 s23, 138240
  s_cbranch_scc1 L_qkv_kernel_cs_loop_18
  v_mul_u32_u24 v5, 864, v2
  v_lshl_add_u32 v5, v3, 5, v5
  ds_write_b128 v5, v[120:123]
  ds_write_b128 v5, v[124:127] offset:16
L_qkv_kernel_cs_skip_17:
  s_mov_b64 exec, s[40:41]
  s_waitcnt lgkmcnt(0)
  s_barrier
  v_cmp_gt_u32 vcc, 216, v0
  s_and_saveexec_b64 s[40:41], vcc
  s_cbranch_execz L_qkv_kernel_cs_skip2_19
  v_lshlrev_b32 v5, 2, v0
  ds_read_b32 v128, v5 offset:0
  ds_read_b32 v129, v5 offset:864
  ds_read_b32 v130, v5 offset:1728
  ds_read_b32 v131, v5 offset:2592
  ds_read_b32 v132, v5 offset:3456
  ds_read_b32 v133, v5 offset:4320
  ds_read_b32 v134, v5 offset:5184
  ds_read_b32 v135, v5 offset:6048
  ds_read_b32 v136, v5 offset:6912
  ds_read_b32 v137, v5 offset:7776
  ds_read_b32 v138, v5 offset:8640
  ds_read_b32 v139, v5 offset:9504
  ds_read_b32 v140, v5 offset:10368
  ds_read_b32 v141, v5 offset:11232
  ds_read_b32 v142, v5 offset:12096
  ds_read_b32 v143, v5 offset:12960
  s_waitcnt lgkmcnt(0)
  v_add_f32 v128, v128, v129
  v_add_f32 v128, v128, v130
  v_add_f32 v128, v128, v131
  v_add_f32 v128, v128, v132
  v_add_f32 v128, v128, v133
  v_add_f32 v128, v128, v134
  v_add_f32 v128, v128, v135
  v_add_f32 v128, v128, v136
  v_add_f32 v128, v128, v137
  v_add_f32 v128, v128, v138
  v_add_f32 v128, v128, v139
  v_add_f32 v128, v128, v140
  v_add_f32 v128, v128, v141
  v_add_f32 v128, v128, v142
  v_add_f32 v128, v128, v143
  s_add_u32 s36, s36, 20840448
  s_addc_u32 s37, s37, 0
  s_and_b32 s37, s37, 0xffff
  s_mov_b32 s38, 13824
  s_mov_b32 s39, 0x20000
  s_mul_i32 s22, s19, 864
  buffer_store_dword v128, v5, s[36:39], s22 offen sc1
L_qkv_kernel_cs_skip2_19:
  s_mov_b64 exec, -1
  v_lshrrev_b32 v8, 6, v0
  s_nop 1
  v_readfirstlane_b32 s16, v8
  s_nop 3
  s_waitcnt vmcnt(0)
  s_barrier
  s_cmp_lg_u32 s16, 0
  s_cbranch_scc1 L_qkv_kernel_nosig_20
  s_load_dwordx4 s[92:95], s[0:1], 64
  s_waitcnt lgkmcnt(0)
  s_mov_b32 s88, s92
  s_and_b32 s89, s93, 0xffff
  s_mov_b32 s90, 256
  s_mov_b32 s91, 0x20000
  s_add_u32 s96, s94, 24049664
  s_addc_u32 s97, s95, 0
  s_and_b32 s97, s97, 0xffff
  s_mov_b32 s98, 12288
  s_mov_b32 s99, 0x20000
  s_mov_b32 s87, 0x40000
  v_mov_b32 v4, 0
L_qkv_kernel_nonce_21:
  buffer_load_dword v5, v4, s[88:91], 0 offen sc1
  s_waitcnt vmcnt(0)
  v_readfirstlane_b32 s100, v5
  s_nop 3
  s_cmp_lg_u32 s100, 0
  s_cbranch_scc1 L_qkv_kernel_nonce_done_22
  s_sleep 1
  s_sub_u32 s87, s87, 1
  s_cmp_lg_u32 s87, 0
  s_cbranch_scc1 L_qkv_kernel_nonce_21
L_qkv_kernel_nonce_done_22:
  s_add_u32 s87, s19, 240
  s_lshl_b32 s87, s87, 2
  s_add_u32 s87, s87, 0
  s_mov_b64 exec, 1
  v_mov_b32 v4, 0
  v_mov_b32 v5, s100
  buffer_store_dword v5, v4, s[96:99], s87 offen sc1
  s_mov_b64 exec, -1
L_qkv_kernel_nosig_20:
  s_endpgm
.p2align 4
L_qkv_kernel_tab:
  .long 0x0, 0x1000, 0xffffffff, 0xffffffff, 0x400, 0x1000, 0xffffffff, 0xffffffff
  .long 0x800, 0x1000, 0xffffffff, 0xffffffff, 0xc00, 0x1000, 0xffffffff, 0xffffffff
  .long 0x2000, 0x400, 0xffffffff, 0xffffffff, 0x3c000, 0x1000, 0xffffffff, 0xffffffff
  .long 0x3c400, 0x1000, 0xffffffff, 0xffffffff, 0x3c800, 0x1000, 0xffffffff, 0xffffffff
  .long 0x3cc00, 0x1000, 0xffffffff, 0xffffffff, 0x3e000, 0x400, 0xffffffff, 0xffffffff
  .long 0x78000, 0x1000, 0xffffffff, 0xffffffff, 0x78400, 0x1000, 0xffffffff, 0xffffffff
  .long 0x78800, 0x1000, 0xffffffff, 0xffffffff, 0x78c00, 0x1000, 0xffffffff, 0xffffffff
  .long 0x7a000, 0x400, 0xffffffff, 0xffffffff, 0xb4000, 0x1000, 0xffffffff, 0xffffffff
  .long 0xb4400, 0x1000, 0xffffffff, 0xffffffff, 0xb4800, 0x1000, 0xffffffff, 0xffffffff
  .long 0xb4c00, 0x1000, 0xffffffff, 0xffffffff, 0xb6000, 0x400, 0xffffffff, 0xffffffff
  .long 0xf0000, 0x1000, 0xffffffff, 0xffffffff, 0xf0400, 0x1000, 0xffffffff, 0xffffffff
  .long 0xf0800, 0x1000, 0xffffffff, 0xffffffff, 0xf0c00, 0x1000, 0xffffffff, 0xffffffff
  .long 0xf2000, 0x400, 0xffffffff, 0xffffffff, 0x12c000, 0x1000, 0xffffffff, 0xffffffff
  .long 0x12c400, 0x1000, 0xffffffff, 0xffffffff, 0x12c800, 0x1000, 0xffffffff, 0xffffffff
  .long 0x12cc00, 0x1000, 0xffffffff, 0xffffffff, 0x12e000, 0x400, 0xffffffff, 0xffffffff
  .long 0x168000, 0x1000, 0xffffffff, 0x0, 0x168400, 0x1000, 0xffffffff, 0x0
  .long 0x168800, 0x1000, 0xffffffff, 0x0, 0x168c00, 0x1000, 0xffffffff, 0x0
  .long 0x16a000, 0x400, 0x0, 0x0, 0x1a4000, 0x1000, 0x0, 0x0
  .long 0x1a4400, 0x1000, 0x0, 0x0, 0x1a4800, 0x1000, 0x0, 0x0
  .long 0x1a4c00, 0x1000, 0x0, 0x0, 0x1a6000, 0x400, 0x0, 0x0
  .long 0x168000, 0x1000, 0x0, 0xffffffff, 0x168400, 0x1000, 0x0, 0xffffffff
  .long 0x168800, 0x1000, 0x0, 0xffffffff, 0x168c00, 0x1000, 0x0, 0xffffffff
  .long 0x16a000, 0x400, 0xffffffff, 0xffffffff, 0x1a4000, 0x1000, 0xffffffff, 0xffffffff
  .long 0x1a4400, 0x1000, 0xffffffff, 0xffffffff, 0x1a4800, 0x1000, 0xffffffff, 0xffffffff
  .long 0x1a4c00, 0x1000, 0xffffffff, 0xffffffff, 0x1a6000, 0x400, 0xffffffff, 0xffffffff
  .long 0x1e0000, 0x1000, 0xffffffff, 0xffffffff, 0x1e0400, 0x1000, 0xffffffff, 0xffffffff
  .long 0x1e0800, 0x1000, 0xffffffff, 0xffffffff, 0x1e0c00, 0x1000, 0xffffffff, 0xffffffff
  .long 0x1e2000, 0x400, 0xffffffff, 0xffffffff, 0x21c000, 0x1000, 0xffffffff, 0xffffffff
  .long 0x21c400, 0x1000, 0xffffffff, 0xffffffff, 0x21c800, 0x1000, 0xffffffff, 0xffffffff
  .long 0x21cc00, 0x1000, 0xffffffff, 0xffffffff, 0x21e000, 0x400, 0xffffffff, 0xffffffff
  .long 0x258000, 0x1000, 0xffffffff, 0xffffffff, 0x258400, 0x1000, 0xffffffff, 0xffffffff
  .long 0x258800, 0x1000, 0xffffffff, 0xffffffff, 0x258c00, 0x1000, 0xffffffff, 0xffffffff
  .long 0x25a000, 0x400, 0xffffffff, 0xffffffff, 0x294000, 0x1000, 0xffffffff, 0xffffffff
  .long 0x294400, 0x1000, 0xffffffff, 0xffffffff, 0x294800, 0x1000, 0xffffffff, 0xffffffff
  .long 0x294c00, 0x1000, 0xffffffff, 0xffffffff, 0x296000, 0x400, 0xffffffff, 0xffffffff
  .long 0x2d0000, 0x1000, 0xffffffff, 0xffffffff, 0x2d0400, 0x1000, 0xffffffff, 0xffffffff
  .long 0x2d0800, 0x1000, 0xffffffff, 0xffffffff, 0x2d0c00, 0x1000, 0xffffffff, 0xffffffff
  .long 0x2d2000, 0x400, 0x0, 0x0, 0x30c000, 0x1000, 0x0, 0x0
  .long 0x30c400, 0x1000, 0x0, 0x0, 0x30c800, 0x1000, 0x0, 0x0
  .long 0x30cc00, 0x1000, 0x0, 0x0, 0x30e000, 0x400, 0x0, 0x0
  .long 0x2d0000, 0x1000, 0x0, 0x0, 0x2d0400, 0x1000, 0x0, 0x0
  .long 0x2d0800, 0x1000, 0x0, 0x0, 0x2d0c00, 0x1000, 0x0, 0x0
  .long 0x2d2000, 0x400, 0xffffffff, 0xffffffff, 0x30c000, 0x1000, 0xffffffff, 0xffffffff
  .long 0x30c400, 0x1000, 0xffffffff, 0xffffffff, 0x30c800, 0x1000, 0xffffffff, 0xffffffff
  .long 0x30cc00, 0x1000, 0xffffffff, 0xffffffff, 0x30e000, 0x400, 0xffffffff, 0xffffffff
  .long 0x348000, 0x1000, 0xffffffff, 0xffffffff, 0x348400, 0x1000, 0xffffffff, 0xffffffff
  .long 0x348800, 0x1000, 0xffffffff, 0xffffffff, 0x348c00, 0x1000, 0xffffffff, 0xffffffff
  .long 0x34a000, 0x400, 0xffffffff, 0xffffffff, 0x384000, 0x1000, 0xffffffff, 0xffffffff
  .long 0x384400, 0x1000, 0xffffffff, 0xffffffff, 0x384800, 0x1000, 0xffffffff, 0xffffffff
  .long 0x384c00, 0x1000, 0xffffffff, 0xffffffff, 0x386000, 0x400, 0xffffffff, 0xffffffff
  .long 0x3c0000, 0x1000, 0xffffffff, 0xffffffff, 0x3c0400, 0x1000, 0xffffffff, 0xffffffff
  .long 0x3c0800, 0x1000, 0xffffffff, 0xffffffff, 0x3c0c00, 0x1000, 0xffffffff, 0xffffffff
  .long 0x3c2000, 0x400, 0xffffffff, 0xffffffff, 0x3fc000, 0x1000, 0xffffffff, 0xffffffff
  .long 0x3fc400, 0x1000, 0xffffffff, 0xffffffff, 0x3fc800, 0x1000, 0xffffffff, 0xffffffff
  .long 0x3fcc00, 0x1000, 0xffffffff, 0xffffffff, 0x3fe000, 0x400, 0xffffffff, 0xffffffff
  .long 0x438000, 0x1000, 0xffffffff, 0xffffffff, 0x438400, 0x1000, 0xffffffff, 0xffffffff
  .long 0x438800, 0x1000, 0xffffffff, 0xffffffff, 0x438c00, 0x1000, 0xffffffff, 0xffffffff
  .long 0x43a000, 0x400, 0xffffffff, 0xffffffff, 0x474000, 0x1000, 0x0, 0x0
  .long 0x474400, 0x1000, 0x0, 0x0, 0x474800, 0x1000, 0x0, 0x0
  .long 0x474c00, 0x1000, 0x0, 0x0, 0x476000, 0x400, 0xffffffff, 0xffffffff
  .long 0x474000, 0x1000, 0xffffffff, 0xffffffff, 0x474400, 0x1000, 0xffffffff, 0xffffffff
  .long 0x474800, 0x1000, 0xffffffff, 0xffffffff, 0x474c00, 0x1000, 0xffffffff, 0xffffffff
  .long 0x476000, 0x400, 0x0, 0x0, 0x4b0000, 0x1000, 0xffffffff, 0xffffffff
  .long 0x4b0400, 0x1000, 0xffffffff, 0xffffffff, 0x4b0800, 0x1000, 0xffffffff, 0xffffffff
  .long 0x4b0c00, 0x1000, 0xffffffff, 0xffffffff, 0x4b2000, 0x400, 0xffffffff, 0xffffffff
  .long 0x4ec000, 0x1000, 0xffffffff, 0xffffffff, 0x4ec400, 0x1000, 0xffffffff, 0xffffffff
  .long 0x4ec800, 0x1000, 0xffffffff, 0xffffffff, 0x4ecc00, 0x1000, 0xffffffff, 0xffffffff
  .long 0x4ee000, 0x400, 0xffffffff, 0xffffffff, 0x528000, 0x1000, 0xffffffff, 0xffffffff
  .long 0x528400, 0x1000, 0xffffffff, 0xffffffff, 0x528800, 0x1000, 0xffffffff, 0xffffffff
  .long 0x528c00, 0x1000, 0xffffffff, 0xffffffff, 0x52a000, 0x400, 0xffffffff, 0xffffffff
  .long 0x564000, 0x1000, 0xffffffff, 0xffffffff, 0x564400, 0x1000, 0xffffffff, 0xffffffff
  .long 0x564800, 0x1000, 0xffffffff, 0xffffffff, 0x564c00, 0x1000, 0xffffffff, 0xffffffff
  .long 0x566000, 0x400, 0xffffffff, 0xffffffff, 0x5a0000, 0x1000, 0xffffffff, 0xffffffff
  .long 0x5a0400, 0x1000, 0xffffffff, 0xffffffff, 0x5a0800, 0x1000, 0xffffffff, 0xffffffff
  .long 0x5a0c00, 0x1000, 0xffffffff, 0xffffffff, 0x5a2000, 0x400, 0xffffffff, 0xffffffff
  .long 0x5dc000, 0x1000, 0xffffffff, 0x0, 0x5dc400, 0x1000, 0xffffffff, 0x0
  .long 0x5dc800, 0x1000, 0xffffffff, 0x0, 0x5dcc00, 0x1000, 0xffffffff, 0x0
  .long 0x5de000, 0x400, 0xffffffff, 0xffffffff, 0x618000, 0x1000, 0x0, 0x0
  .long 0x618400, 0x1000, 0x0, 0x0, 0x618800, 0x1000, 0x0, 0x0
  .long 0x618c00, 0x1000, 0x0, 0x0, 0x61a000, 0x400, 0x0, 0x0
  .long 0x5dc000, 0x1000, 0x0, 0xffffffff, 0x5dc400, 0x1000, 0x0, 0xffffffff
  .long 0x5dc800, 0x1000, 0x0, 0xffffffff, 0x5dcc00, 0x1000, 0x0, 0xffffffff
  .long 0x5de000, 0x400, 0x0, 0x0, 0x618000, 0x1000, 0xffffffff, 0xffffffff
  .long 0x618400, 0x1000, 0xffffffff, 0xffffffff, 0x618800, 0x1000, 0xffffffff, 0xffffffff
  .long 0x618c00, 0x1000, 0xffffffff, 0xffffffff, 0x61a000, 0x400, 0xffffffff, 0xffffffff
  .long 0x654000, 0x1000, 0xffffffff, 0xffffffff, 0x654400, 0x1000, 0xffffffff, 0xffffffff
  .long 0x654800, 0x1000, 0xffffffff, 0xffffffff, 0x654c00, 0x1000, 0xffffffff, 0xffffffff
  .long 0x656000, 0x400, 0xffffffff, 0xffffffff, 0x690000, 0x1000, 0xffffffff, 0xffffffff
  .long 0x690400, 0x1000, 0xffffffff, 0xffffffff, 0x690800, 0x1000, 0xffffffff, 0xffffffff
  .long 0x690c00, 0x1000, 0xffffffff, 0xffffffff, 0x692000, 0x400, 0xffffffff, 0xffffffff
  .long 0x6cc000, 0x1000, 0xffffffff, 0xffffffff, 0x6cc400, 0x1000, 0xffffffff, 0xffffffff
  .long 0x6cc800, 0x1000, 0xffffffff, 0xffffffff, 0x6ccc00, 0x1000, 0xffffffff, 0xffffffff
  .long 0x6ce000, 0x400, 0xffffffff, 0xffffffff, 0x708000, 0x1000, 0xffffffff, 0xffffffff
  .long 0x708400, 0x1000, 0xffffffff, 0xffffffff, 0x708800, 0x1000, 0xffffffff, 0xffffffff
  .long 0x708c00, 0x1000, 0xffffffff, 0xffffffff, 0x70a000, 0x400, 0xffffffff, 0xffffffff
  .long 0x744000, 0x1000, 0xffffffff, 0xffffffff, 0x744400, 0x1000, 0xffffffff, 0xffffffff
  .long 0x744800, 0x1000, 0xffffffff, 0xffffffff, 0x744c00, 0x1000, 0xffffffff, 0xffffffff
  .long 0x746000, 0x400, 0xffffffff, 0xffffffff, 0x0, 0x0, 0x0, 0x0
  .long 0x0, 0x0, 0x0, 0x0, 0x0, 0x0, 0x0, 0x0
  .long 0x0, 0x0, 0x0, 0x0, 0x0, 0x0, 0x0, 0x0
  .long 0x0, 0x1400, 0xffffffff, 0xffffffff, 0x400, 0x1400, 0xffffffff, 0xffffffff
  .long 0x800, 0x1400, 0xffffffff, 0xffffffff, 0xc00, 0x1400, 0xffffffff, 0xffffffff
  .long 0x1000, 0x1400, 0xffffffff, 0xffffffff, 0x3c000, 0x1400, 0xffffffff, 0xffffffff
  .long 0x3c400, 0x1400, 0xffffffff, 0xffffffff, 0x3c800, 0x1400, 0xffffffff, 0xffffffff
  .long 0x3cc00, 0x1400, 0xffffffff, 0xffffffff, 0x3d000, 0x1400, 0xffffffff, 0xffffffff
  .long 0x78000, 0x1400, 0xffffffff, 0xffffffff, 0x78400, 0x1400, 0xffffffff, 0xffffffff
  .long 0x78800, 0x1400, 0xffffffff, 0xffffffff, 0x78c00, 0x1400, 0xffffffff, 0xffffffff
  .long 0x79000, 0x1400, 0xffffffff, 0xffffffff, 0xb4000, 0x1400, 0xffffffff, 0xffffffff
  .long 0xb4400, 0x1400, 0xffffffff, 0xffffffff, 0xb4800, 0x1400, 0xffffffff, 0xffffffff
  .long 0xb4c00, 0x1400, 0xffffffff, 0xffffffff, 0xb5000, 0x1400, 0xffffffff, 0xffffffff
  .long 0xf0000, 0x1400, 0xffffffff, 0xffffffff, 0xf0400, 0x1400, 0xffffffff, 0xffffffff
  .long 0xf0800, 0x1400, 0xffffffff, 0xffffffff, 0xf0c00, 0x1400, 0xffffffff, 0xffffffff
  .long 0xf1000, 0x1400, 0xffffffff, 0xffffffff, 0x12c000, 0x1400, 0xffffffff, 0xffffffff
  .long 0x12c400, 0x1400, 0xffffffff, 0xffffffff, 0x12c800, 0x1400, 0xffffffff, 0xffffffff
  .long 0x12cc00, 0x1400, 0xffffffff, 0xffffffff, 0x12d000, 0x1400, 0xffffffff, 0xffffffff
  .long 0x168000, 0x1400, 0xff000ff, 0xf000ff00, 0x168400, 0x1400, 0xff000f, 0xff000ff0
  .long 0x168800, 0x1400, 0xff000, 0xff000ff, 0x168c00, 0x1400, 0xf000ff00, 0xff000f
  .long 0x169000, 0x1400, 0xff000ff0, 0xff000, 0x1a4000, 0x1400, 0x0, 0x0
  .long 0x1a4400, 0x1400, 0x0, 0x0, 0x1a4800, 0x1400, 0x0, 0x0
  .long 0x1a4c00, 0x1400, 0x0, 0x0, 0x1a5000, 0x1400, 0x0, 0x0
  .long 0x168000, 0x1400, 0xf00fff00, 0xfff00ff, 0x168400, 0x1400, 0xff00fff0, 0xfff00f
  .long 0x168800, 0x1400, 0xfff00fff, 0xf00fff00, 0x168c00, 0x1400, 0xfff00ff, 0xff00fff0
  .long 0x169000, 0x1400, 0xfff00f, 0xfff00fff, 0x1a4000, 0x1400, 0xffffffff, 0xffffffff
  .long 0x1a4400, 0x1400, 0xffffffff, 0xffffffff, 0x1a4800, 0x1400, 0xffffffff, 0xffffffff
  .long 0x1a4c00, 0x1400, 0xffffffff, 0xffffffff, 0x1a5000, 0x1400, 0xffffffff, 0xffffffff
  .long 0x1e0000, 0x1400, 0xffffffff, 0xffffffff, 0x1e0400, 0x1400, 0xffffffff, 0xffffffff
  .long 0x1e0800, 0x1400, 0xffffffff, 0xffffffff, 0x1e0c00, 0x1400, 0xffffffff, 0xffffffff
  .long 0x1e1000, 0x1400, 0xffffffff, 0xffffffff, 0x21c000, 0x1400, 0xffffffff, 0xffffffff
  .long 0x21c400, 0x1400, 0xffffffff, 0xffffffff, 0x21c800, 0x1400, 0xffffffff, 0xffffffff
  .long 0x21cc00, 0x1400, 0xffffffff, 0xffffffff, 0x21d000, 0x1400, 0xffffffff, 0xffffffff
  .long 0x258000, 0x1400, 0xffffffff, 0xffffffff, 0x258400, 0x1400, 0xffffffff, 0xffffffff
  .long 0x258800, 0x1400, 0xffffffff, 0xffffffff, 0x258c00, 0x1400, 0xffffffff, 0xffffffff
  .long 0x259000, 0x1400, 0xffffffff, 0xffffffff, 0x294000, 0x1400, 0xffffffff, 0xffffffff
  .long 0x294400, 0x1400, 0xffffffff, 0xffffffff, 0x294800, 0x1400, 0xffffffff, 0xffffffff
  .long 0x294c00, 0x1400, 0xffffffff, 0xffffffff, 0x295000, 0x1400, 0xffffffff, 0xffffffff
  .long 0x2d0000, 0x1400, 0xfff0ffff, 0xf0ffff0f, 0x2d0400, 0x1400, 0xffff0fff, 0xff0ffff0
  .long 0x2d0800, 0x1400, 0xffff0ff, 0xfff0ffff, 0x2d0c00, 0x1400, 0xf0ffff0f, 0xffff0fff
  .long 0x2d1000, 0x1400, 0xff0ffff0, 0xffff0ff, 0x30c000, 0x1400, 0x0, 0x0
  .long 0x30c400, 0x1400, 0x0, 0x0, 0x30c800, 0x1400, 0x0, 0x0
  .long 0x30cc00, 0x1400, 0x0, 0x0, 0x30d000, 0x1400, 0x0, 0x0
  .long 0x2d0000, 0x1400, 0xf0000, 0xf0000f0, 0x2d0400, 0x1400, 0xf000, 0xf0000f
  .long 0x2d0800, 0x1400, 0xf0000f00, 0xf0000, 0x2d0c00, 0x1400, 0xf0000f0, 0xf000
  .long 0x2d1000, 0x1400, 0xf0000f, 0xf0000f00, 0x30c000, 0x1400, 0xffffffff, 0xffffffff
  .long 0x30c400, 0x1400, 0xffffffff, 0xffffffff, 0x30c800, 0x1400, 0xffffffff, 0xffffffff
  .long 0x30cc00, 0x1400, 0xffffffff, 0xffffffff, 0x30d000, 0x1400, 0xffffffff, 0xffffffff
  .long 0x348000, 0x1400, 0xffffffff, 0xffffffff, 0x348400, 0x1400, 0xffffffff, 0xffffffff
  .long 0x348800, 0x1400, 0xffffffff, 0xffffffff, 0x348c00, 0x1400, 0xffffffff, 0xffffffff
  .long 0x349000, 0x1400, 0xffffffff, 0xffffffff, 0x384000, 0x1400, 0xffffffff, 0xffffffff
  .long 0x384400, 0x1400, 0xffffffff, 0xffffffff, 0x384800, 0x1400, 0xffffffff, 0xffffffff
  .long 0x384c00, 0x1400, 0xffffffff, 0xffffffff, 0x385000, 0x1400, 0xffffffff, 0xffffffff
  .long 0x3c0000, 0x1400, 0xffffffff, 0xffffffff, 0x3c0400, 0x1400, 0xffffffff, 0xffffffff
  .long 0x3c0800, 0x1400, 0xffffffff, 0xffffffff, 0x3c0c00, 0x1400, 0xffffffff, 0xffffffff
  .long 0x3c1000, 0x1400, 0xffffffff, 0xffffffff, 0x3fc000, 0x1400, 0xffffffff, 0xffffffff
  .long 0x3fc400, 0x1400, 0xffffffff, 0xffffffff, 0x3fc800, 0x1400, 0xffffffff, 0xffffffff
  .long 0x3fcc00, 0x1400, 0xffffffff, 0xffffffff, 0x3fd000, 0x1400, 0xffffffff, 0xffffffff
  .long 0x438000, 0x1400, 0xffffffff, 0xffffffff, 0x438400, 0x1400, 0xffffffff, 0xffffffff
  .long 0x438800, 0x1400, 0xffffffff, 0xffffffff, 0x438c00, 0x1400, 0xffffffff, 0xffffffff
  .long 0x439000, 0x1400, 0xffffffff, 0xffffffff, 0x474000, 0x1400, 0xf0000f, 0xf0000f00
  .long 0x474400, 0x1400, 0xf0000, 0xf0000f0, 0x474800, 0x1400, 0xf000, 0xf0000f
  .long 0x474c00, 0x1400, 0xf0000f00, 0xf0000, 0x475000, 0x1400, 0xf0000f0, 0xf000
  .long 0x474000, 0x1400, 0xff0ffff0, 0xffff0ff, 0x474400, 0x1400, 0xfff0ffff, 0xf0ffff0f
  .long 0x474800, 0x1400, 0xffff0fff, 0xff0ffff0, 0x474c00, 0x1400, 0xffff0ff, 0xfff0ffff
  .long 0x475000, 0x1400, 0xf0ffff0f, 0xffff0fff, 0x4b0000, 0x1400, 0xffffffff, 0xffffffff
  .long 0x4b0400, 0x1400, 0xffffffff, 0xffffffff, 0x4b0800, 0x1400, 0xffffffff, 0xffffffff
  .long 0x4b0c00, 0x1400, 0xffffffff, 0xffffffff, 0x4b1000, 0x1400, 0xffffffff, 0xffffffff
  .long 0x4ec000, 0x1400, 0xffffffff, 0xffffffff, 0x4ec400, 0x1400, 0xffffffff, 0xffffffff
  .long 0x4ec800, 0x1400, 0xffffffff, 0xffffffff, 0x4ecc00, 0x1400, 0xffffffff, 0xffffffff
  .long 0x4ed000, 0x1400, 0xffffffff, 0xffffffff, 0x528000, 0x1400, 0xffffffff, 0xffffffff
  .long 0x528400, 0x1400, 0xffffffff, 0xffffffff, 0x528800, 0x1400, 0xffffffff, 0xffffffff
  .long 0x528c00, 0x1400, 0xffffffff, 0xffffffff, 0x529000, 0x1400, 0xffffffff, 0xffffffff
  .long 0x564000, 0x1400, 0xffffffff, 0xffffffff, 0x564400, 0x1400, 0xffffffff, 0xffffffff
  .long 0x564800, 0x1400, 0xffffffff, 0xffffffff, 0x564c00, 0x1400, 0xffffffff, 0xffffffff
  .long 0x565000, 0x1400, 0xffffffff, 0xffffffff, 0x5a0000, 0x1400, 0xffffffff, 0xffffffff
  .long 0x5a0400, 0x1400, 0xffffffff, 0xffffffff, 0x5a0800, 0x1400, 0xffffffff, 0xffffffff
  .long 0x5a0c00, 0x1400, 0xffffffff, 0xffffffff, 0x5a1000, 0x1400, 0xffffffff, 0xffffffff
  .long 0x5dc000, 0x1400, 0xfff00fff, 0xf00fff00, 0x5dc400, 0x1400, 0xfff00ff, 0xff00fff0
  .long 0x5dc800, 0x1400, 0xfff00f, 0xfff00fff, 0x5dcc00, 0x1400, 0xf00fff00, 0xfff00ff
  .long 0x5dd000, 0x1400, 0xff00fff0, 0xfff00f, 0x618000, 0x1400, 0x0, 0x0
  .long 0x618400, 0x1400, 0x0, 0x0, 0x618800, 0x1400, 0x0, 0x0
  .long 0x618c00, 0x1400, 0x0, 0x0, 0x619000, 0x1400, 0x0, 0x0
  .long 0x5dc000, 0x1400, 0xff000, 0xff000ff, 0x5dc400, 0x1400, 0xf000ff00, 0xff000f
  .long 0x5dc800, 0x1400, 0xff000ff0, 0xff000, 0x5dcc00, 0x1400, 0xff000ff, 0xf000ff00
  .long 0x5dd000, 0x1400, 0xff000f, 0xff000ff0, 0x618000, 0x1400, 0xffffffff, 0xffffffff
  .long 0x618400, 0x1400, 0xffffffff, 0xffffffff, 0x618800, 0x1400, 0xffffffff, 0xffffffff
  .long 0x618c00, 0x1400, 0xffffffff, 0xffffffff, 0x619000, 0x1400, 0xffffffff, 0xffffffff
  .long 0x654000, 0x1400, 0xffffffff, 0xffffffff, 0x654400, 0x1400, 0xffffffff, 0xffffffff
  .long 0x654800, 0x1400, 0xffffffff, 0xffffffff, 0x654c00, 0x1400, 0xffffffff, 0xffffffff
  .long 0x655000, 0x1400, 0xffffffff, 0xffffffff, 0x690000, 0x1400, 0xffffffff, 0xffffffff
  .long 0x690400, 0x1400, 0xffffffff, 0xffffffff, 0x690800, 0x1400, 0xffffffff, 0xffffffff
  .long 0x690c00, 0x1400, 0xffffffff, 0xffffffff, 0x691000, 0x1400, 0xffffffff, 0xffffffff
  .long 0x6cc000, 0x1400, 0xffffffff, 0xffffffff, 0x6cc400, 0x1400, 0xffffffff, 0xffffffff
  .long 0x6cc800, 0x1400, 0xffffffff, 0xffffffff, 0x6ccc00, 0x1400, 0xffffffff, 0xffffffff
  .long 0x6cd000, 0x1400, 0xffffffff, 0xffffffff, 0x708000, 0x1400, 0xffffffff, 0xffffffff
  .long 0x708400, 0x1400, 0xffffffff, 0xffffffff, 0x708800, 0x1400, 0xffffffff, 0xffffffff
  .long 0x708c00, 0x1400, 0xffffffff, 0xffffffff, 0x709000, 0x1400, 0xffffffff, 0xffffffff
  .long 0x744000, 0x1400, 0xffffffff, 0xffffffff, 0x744400, 0x1400, 0xffffffff, 0xffffffff
  .long 0x744800, 0x1400, 0xffffffff, 0xffffffff, 0x744c00, 0x1400, 0xffffffff, 0xffffffff
  .long 0x745000, 0x1400, 0xffffffff, 0xffffffff, 0x0, 0x0, 0x0, 0x0
  .long 0x0, 0x0, 0x0, 0x0, 0x0, 0x0, 0x0, 0x0
  .long 0x0, 0x0, 0x0, 0x0, 0x0, 0x0, 0x0, 0x0
  .long 0x0, 0x200, 0x80001000, 0x1408, 0x8, 0x208, 0x1400, 0x1600
  .long 0x1608, 0x2800, 0x2a00, 0x80003800, 0x80002400, 0x2808, 0x2a08, 0x3c00
  .long 0x3c08, 0x3e08, 0x5000, 0x5200, 0x3e00, 0x80004c00, 0x5008, 0x5208
  .long 0x80006000, 0x6408, 0x6608, 0x7800, 0x6400, 0x6600, 0x80007400, 0x7808
  .long 0x200, 0x80001000, 0x1408, 0x1608, 0x208, 0x1400, 0x1600, 0x80002400
  .long 0x2800, 0x2a00, 0x80003800, 0x3c08, 0x2808, 0x2a08, 0x3c00, 0x3e00
  .long 0x3e08, 0x5000, 0x5200, 0x80006000, 0x80004c00, 0x5008, 0x5208, 0x6400
  .long 0x6408, 0x6608, 0x7800, 0x7a00, 0x6600, 0x80007400, 0x7808, 0x7a08
  .long 0x80001000, 0x1408, 0x1608, 0x2800, 0x1400, 0x1600, 0x80002400, 0x2808
  .long 0x2a00, 0x80003800, 0x3c08, 0x3e08, 0x2a08, 0x3c00, 0x3e00, 0x80004c00
  .long 0x5000, 0x5200, 0x80006000, 0x6408, 0x5008, 0x5208, 0x6400, 0x6600
  .long 0x6608, 0x7800, 0x7a00, 0x80008800, 0x80007400, 0x7808, 0x7a08, 0x80009c00
  .long 0x0, 0x200, 0x1400, 0x1600, 0x8, 0x208, 0x1408, 0x1608
  .long 0x80002400, 0x2808, 0x2a08, 0x3c00, 0x2800, 0x2a00, 0x80003800, 0x3c08
  .long 0x3e00, 0x80004c00, 0x5008, 0x5208, 0x3e08, 0x5000, 0x5200, 0x80006000
  .long 0x6400, 0x6600, 0x80007400, 0x7808, 0x6408, 0x6608, 0x7800, 0x80008800
  .long 0x200, 0x1400, 0x1600, 0x80002400, 0x208, 0x1408, 0x1608, 0x2800
  .long 0x2808, 0x2a08, 0x3c00, 0x3e00, 0x2a00, 0x80003800, 0x3c08, 0x3e08
  .long 0x80004c00, 0x5008, 0x5208, 0x6400, 0x5000, 0x5200, 0x80006000, 0x6408
  .long 0x6600, 0x80007400, 0x7808, 0x7a08, 0x6608, 0x7800, 0x7a00, 0x80008800
qkv_kernel_end:

.p2align 6
L_mega_disp:
  s_cmp_ge_u32 s2, 1280
  s_cbranch_scc1 L_mega_exit
  s_lshr_b32 s3, s2, 8
  s_and_b32 s2, s2, 255
  s_cmp_eq_u32 s3, 1
  s_cbranch_scc1 L_mega_j1
  s_cmp_eq_u32 s3, 2
  s_cbranch_scc1 L_mega_j2
  s_cmp_eq_u32 s3, 3
  s_cbranch_scc1 L_mega_j3
  s_cmp_eq_u32 s3, 4
  s_cbranch_scc1 L_mega_j4
  s_endpgm
L_mega_j1:
  s_branch attn_kernel
L_mega_j2:
  s_branch oproj_kernel
L_mega_j3:
  s_branch ffn_kernel
L_mega_j4:
  s_branch down_kernel
L_mega_exit:
  s_endpgm
.p2align 8
attn_kernel:
  s_load_dwordx2 s[4:5], s[0:1], 72
  s_load_dwordx2 s[34:35], s[0:1], 16
  s_load_dwordx4 s[80:83], s[0:1], 32
  s_load_dwordx2 s[36:37], s[0:1], 48
  s_load_dwordx4 s[92:95], s[0:1], 64
  v_and_b32 v1, 63, v0
  v_lshrrev_b32 v2, 6, v0
  v_lshlrev_b32 v13, 4, v1
  v_readfirstlane_b32 s16, v2
  s_and_b32 s21, s2, 7
  s_lshl_b32 s21, s21, 2
  s_lshr_b32 s22, s2, 6
  s_add_u32 s19, s21, s22
  s_lshr_b32 s22, s2, 3
  s_and_b32 s20, s22, 7
  s_and_b32 s17, s16, 3
  s_lshr_b32 s18, s16, 2
  s_mul_i32 s33, s19, 245760
  s_mul_i32 s21, s20, 30720
  s_lshl_b32 s22, s17, 11
  s_add_u32 s22, s22, s21
  s_add_u32 s38, s22, 20480
  s_lshl_b32 s23, s17, 9
  s_add_u32 s23, s23, s21
  s_add_u32 s39, s23, 28672
  s_cmp_eq_u32 s18, 0
  s_cselect_b32 s29, 6, 2
  s_mul_i32 s21, s18, 6
  s_mul_i32 s84, s21, 30720
  s_mul_i32 s23, s17, 5120
  s_add_u32 s84, s84, s23
  s_mul_i32 s32, s21, 20480
  s_add_u32 s85, s32, s23
  v_pk_mov_b32 v[20:21], 0, 0
  v_pk_mov_b32 v[22:23], 0, 0
  v_pk_mov_b32 v[28:29], 0, 0
  v_pk_mov_b32 v[30:31], 0, 0
  v_and_b32 v2, 31, v1
  v_lshlrev_b32 v3, 3, v2
  s_waitcnt lgkmcnt(0)
  s_add_u32 s8, s4, s33
  s_addc_u32 s9, s5, 0
  s_and_b32 s9, s9, 0xffff
  s_mov_b32 s10, 245760
  s_mov_b32 s11, 0x20000
  s_mov_b32 s88, s92
  s_and_b32 s89, s93, 0xffff
  s_mov_b32 s90, 256
  s_mov_b32 s91, 0x20000
  s_add_u32 s96, s94, 24049664
  s_addc_u32 s97, s95, 0
  s_and_b32 s97, s97, 0xffff
  s_mov_b32 s98, 12288
  s_mov_b32 s99, 0x20000
  v_mov_b32 v201, 0
  buffer_load_dword v202, v201, s[88:91], 0 offen sc1
  s_cmp_lg_u32 s16, 0
  s_cbranch_scc1 L_attn_kernel_nopoll_2
  s_mul_i32 s86, s19, 20
  s_lshr_b32 s87, s86, 7
  s_add_u32 s86, s86, 19
  s_lshr_b32 s86, s86, 7
  v_lshrrev_b32 v6, 4, v1
  v_and_b32 v7, 15, v1
  v_and_b32 v8, 1, v6
  v_cmp_eq_u32 vcc, 0, v8
  v_mov_b32 v8, s86
  v_mov_b32 v9, s87
  v_cndmask_b32 v8, v8, v9, vcc
  v_lshrrev_b32 v6, 1, v6
  v_mul_u32_u24 v6, 5, v6
  v_add_u32 v9, v8, v6
  v_add_u32 v9, 5, v9
  v_lshl_add_u32 v9, v9, 4, v7
  v_lshlrev_b32 v9, 2, v9
  v_lshl_add_u32 v8, v8, 4, v7
  v_lshlrev_b32 v8, 2, v8
  buffer_load_dword v176, v201, s[88:91], 0 offen sc1
  buffer_load_dword v177, v9, s[96:99], 0 offen sc1
  buffer_load_dword v178, v8, s[96:99], 0 offen sc1
  s_mov_b32 s87, 0x40000
  s_waitcnt vmcnt(0)
  s_branch L_attn_kernel_poll_chk_4
L_attn_kernel_poll_3:
  s_sleep 1
  buffer_load_dword v176, v201, s[88:91], 0 offen sc1
  buffer_load_dword v177, v9, s[96:99], 0 offen sc1
  buffer_load_dword v178, v8, s[96:99], 0 offen sc1
  s_waitcnt vmcnt(0)
L_attn_kernel_poll_chk_4:
  v_readfirstlane_b32 s100, v176
  s_nop 3
  v_cmp_eq_u32 vcc, 0, v176
  v_cmp_ne_u32 s[94:95], s100, v177
  s_nop 3
  s_or_b64 vcc, vcc, s[94:95]
  v_cmp_ne_u32 s[94:95], s100, v178
  s_nop 3
  s_or_b64 vcc, vcc, s[94:95]
  s_nop 4
  s_cbranch_vccz L_attn_kernel_poll_done_5
  s_sub_u32 s87, s87, 1
  s_cmp_lg_u32 s87, 0
  s_cbranch_scc1 L_attn_kernel_poll_3
L_attn_kernel_poll_done_5:
L_attn_kernel_nopoll_2:
  s_barrier
  buffer_load_dwordx4 v[16:19], v13, s[8:11], s38 offen
  buffer_load_dwordx4 v[24:27], v13, s[8:11], s38 offen offset:1024
  s_mov_b32 exec_hi, 0
  buffer_load_dwordx2 v[20:21], v3, s[8:11], s39 offen
  buffer_load_dwordx2 v[28:29], v3, s[8:11], s39 offen offset:256
  s_mov_b32 exec_hi, -1
  s_mov_b32 m0, s85
  s_add_u32 s28, s84, 4096
  buffer_load_dwordx4 v13, s[8:11], s84 offen offset:0 lds
  buffer_load_dwordx4 v13, s[8:11], s84 offen offset:1024 lds
  buffer_load_dwordx4 v13, s[8:11], s84 offen offset:2048 lds
  buffer_load_dwordx4 v13, s[8:11], s84 offen offset:3072 lds
  s_add_u32 m0, s85, 4096
  s_add_u32 s84, s84, 30720
  buffer_load_dwordx4 v13, s[8:11], s28 offen lds
  s_add_u32 s85, s85, 20480
  s_add_u32 s12, s4, 7864320
  s_addc_u32 s13, s5, 0
  s_and_b32 s13, s13, 0xffff
  s_mov_b32 s14, 3145728
  s_mov_b32 s15, 0x20000
  v_add_u32 v10, s32, v13
  s_add_u32 s21, s32, 8192
  v_add_u32 v11, s21, v3
  v_lshrrev_b32 v4, 5, v1
  v_mul_u32_u24 v5, 320, v4
  v_lshl_add_u32 v5, v2, 4, v5
  s_add_u32 s21, s32, 10240
  v_add_u32 v12, s21, v5
  s_mov_b32 s24, 0x000fffff
  s_mov_b32 s25, 0x000fffff
  s_mov_b32 s30, 0x5f800000
  s_mov_b32 s27, 1
  v_pk_mov_b32 v[38:39], 0, 0
  v_pk_mov_b32 v[46:47], 0, 0
  s_lshl_b32 s21, s20, 8
  s_lshl_b32 s22, s17, 6
  s_add_u32 s21, s21, s22
  s_lshl_b32 s22, s18, 5
  s_add_u32 s21, s21, s22
  v_add_u32 v6, s21, v2
  v_lshrrev_b32 v7, 4, v6
  v_mul_u32_u24 v7, 24576, v7
  v_and_b32 v6, 15, v6
  v_lshl_add_u32 v7, v6, 4, v7
  s_mul_i32 s21, s19, 3
  v_add_u32 v9, s21, v4
  v_lshrrev_b32 v6, 2, v9
  v_lshl_add_u32 v14, v6, 10, v7
  v_and_b32 v6, 3, v9
  v_lshl_add_u32 v14, v6, 8, v14
  s_add_u32 s21, s21, 2
  s_lshr_b32 s22, s21, 2
  s_lshl_b32 s22, s22, 10
  s_and_b32 s21, s21, 3
  s_lshl_b32 s21, s21, 8
  s_add_u32 s21, s21, s22
  v_add_u32 v15, s21, v7
  s_mov_b32 s40, s34
  s_and_b32 s41, s35, 0xffff
  s_mov_b32 s42, 819200
  s_mov_b32 s43, 0x20000
  s_mov_b32 s44, s36
  s_and_b32 s45, s37, 0xffff
  s_mov_b32 s46, 2211840
  s_mov_b32 s47, 0x20000
  s_add_u32 s48, s4, 20854784
  s_addc_u32 s49, s5, 0
  s_and_b32 s49, s49, 0xffff
  s_mov_b32 s50, 3194880
  s_mov_b32 s51, 0x20000
  v_lshrrev_b32 v192, 4, v1
  v_and_b32 v193, 15, v1
  v_lshlrev_b32 v193, 1, v193
  s_lshl_b32 s52, s2, 3
  s_add_u32 s52, s52, s16
  v_lshrrev_b32 v198, 3, v1
  v_mul_u32_u24 v198, 3456, v198
  v_and_b32 v199, 7, v1
  v_lshl_add_u32 v198, v199, 7, v198
  v_min_u32 v198, 14720, v198
  v_and_b32 v8, 31, v1
  v_cmp_eq_u32 vcc, 20, v8
  v_mov_b32 v9, 0x3f803f80
  v_mov_b32 v8, 0
  s_nop 0
  v_cndmask_b32 v8, v8, v9, vcc
  v_mov_b32 v9, v8
  v_pk_mov_b32 v[48:49], v[8:9], v[8:9]
  v_pk_mov_b32 v[50:51], v[8:9], v[8:9]
  v_pk_mov_b32 v[52:53], v[8:9], v[8:9]
  v_pk_mov_b32 v[54:55], v[8:9], v[8:9]
  v_pk_mov_b32 v[56:57], v[8:9], v[8:9]
  v_pk_mov_b32 v[58:59], v[8:9], v[8:9]
  v_pk_mov_b32 v[60:61], v[8:9], v[8:9]
  v_pk_mov_b32 v[62:63], v[8:9], v[8:9]
  v_pk_mov_b32 v[144:145], 0, 0
  v_pk_mov_b32 v[160:161], 0, 0
  v_pk_mov_b32 v[146:147], 0, 0
  v_pk_mov_b32 v[162:163], 0, 0
  v_pk_mov_b32 v[148:149], 0, 0
  v_pk_mov_b32 v[164:165], 0, 0
  v_pk_mov_b32 v[150:151], 0, 0
  v_pk_mov_b32 v[166:167], 0, 0
  v_pk_mov_b32 v[152:153], 0, 0
  v_pk_mov_b32 v[168:169], 0, 0
  v_pk_mov_b32 v[154:155], 0, 0
  v_pk_mov_b32 v[170:171], 0, 0
  v_pk_mov_b32 v[76:77], 0, 0
  v_pk_mov_b32 v[78:79], 0, 0
  s_waitcnt vmcnt(0)
  s_getpc_b64 s[86:87]
L_attn_kernel_here_6:
  s_lshr_b32 s92, s2, 3
  s_and_b32 s92, s92, 31
  s_lshl_b32 s92, s92, 10
  v_lshrrev_b32 v4, 6, v0
  v_lshlrev_b32 v4, 7, v4
  v_add_u32 v4, s92, v4
  s_mov_b64 s[88:89], exec
  s_mov_b64 exec, 1
  s_sub_u32 s90, s86, 0x100000
  s_subb_u32 s91, s87, 0
  v_min_u32 v201, oproj_kernel_end - oproj_kernel - 4, v4
  v_add_u32 v201, oproj_kernel - L_attn_kernel_here_6 + 0x100000, v201
  global_load_dword v200, v201, s[90:91]
  s_mov_b64 exec, s[88:89]
  s_barrier
L_attn_kernel_max_7:
  v_mov_b32 v6, 0xff800000
  v_mov_b32 v7, 0xff800000
  s_mov_b32 s31, 0
L_attn_kernel_mloop_8:
  s_lshr_b32 s21, s31, 3
  s_mul_i32 s21, s21, 20480
  s_and_b32 s22, s31, 7
  s_lshl_b32 s23, s22, 10
  s_add_u32 s23, s23, s21
  s_lshl_b32 s28, s22, 8
  s_add_u32 s28, s28, s21
  v_add_u32 v8, s23, v10
  v_add_u32 v9, s28, v11
  ds_read_b128 v[40:43], v8
  ds_read_b64 v[44:45], v9
  ds_read_b128 v[32:35], v10
  ds_read_b64 v[36:37], v11
  s_mov_b64 exec, s[24:25]
  ds_read_b128 v[48:51], v12
  ds_read_b128 v[52:55], v12 offset:640
  s_mov_b64 exec, -1
  s_waitcnt lgkmcnt(4)
  v_mfma_f32_32x32x16_bf16 v[112:127], v[40:43], v[16:19], 0
  v_mfma_f32_32x32x16_bf16 v[128:143], v[40:43], v[24:27], 0
  v_mfma_f32_32x32x16_bf16 v[112:127], v[44:47], v[20:23], v[112:127]
  v_mfma_f32_32x32x16_bf16 v[128:143], v[44:47], v[28:31], v[128:143]
  s_nop 10
  v_max3_f32 v6, v112, v113, v6
  v_max3_f32 v6, v114, v115, v6
  v_max3_f32 v6, v116, v117, v6
  v_max3_f32 v6, v118, v119, v6
  v_max3_f32 v6, v120, v121, v6
  v_max3_f32 v6, v122, v123, v6
  v_max3_f32 v6, v124, v125, v6
  v_max3_f32 v6, v126, v127, v6
  v_max3_f32 v7, v128, v129, v7
  v_max3_f32 v7, v130, v131, v7
  v_max3_f32 v7, v132, v133, v7
  v_max3_f32 v7, v134, v135, v7
  v_max3_f32 v7, v136, v137, v7
  v_max3_f32 v7, v138, v139, v7
  v_max3_f32 v7, v140, v141, v7
  v_max3_f32 v7, v142, v143, v7
  s_add_u32 s31, s31, 1
  s_cmp_lt_u32 s31, s27
  s_cbranch_scc1 L_attn_kernel_mloop_8
  v_mov_b32 v8, v6
  v_mov_b32 v9, v6
  v_mov_b32 v4, v7
  v_mov_b32 v5, v7
  s_nop 0
  v_permlane32_swap_b32 v8, v9
  v_permlane32_swap_b32 v4, v5
  s_nop 0
  v_max_f32 v8, v8, v9
  v_max_f32 v4, v4, v5
  v_sub_f32 v80, 0, v8
  v_sub_f32 v81, 0, v8
  v_sub_f32 v96, 0, v4
  v_sub_f32 v97, 0, v4
  v_pk_mov_b32 v[82:83], v[80:81], v[80:81]
  v_pk_mov_b32 v[84:85], v[80:81], v[80:81]
  v_pk_mov_b32 v[86:87], v[80:81], v[80:81]
  v_pk_mov_b32 v[88:89], v[80:81], v[80:81]
  v_pk_mov_b32 v[90:91], v[80:81], v[80:81]
  v_pk_mov_b32 v[92:93], v[80:81], v[80:81]
  v_pk_mov_b32 v[94:95], v[80:81], v[80:81]
  s_waitcnt lgkmcnt(0)
  s_nop 0
  v_mfma_f32_32x32x16_bf16 v[112:127], v[32:35], v[16:19], v[80:95]
  v_mfma_f32_32x32x16_bf16 v[112:127], v[36:39], v[20:23], v[112:127]
  v_pk_mov_b32 v[98:99], v[96:97], v[96:97]
  v_pk_mov_b32 v[100:101], v[96:97], v[96:97]
  v_pk_mov_b32 v[102:103], v[96:97], v[96:97]
  v_pk_mov_b32 v[104:105], v[96:97], v[96:97]
  v_pk_mov_b32 v[106:107], v[96:97], v[96:97]
  v_pk_mov_b32 v[108:109], v[96:97], v[96:97]
  v_pk_mov_b32 v[110:111], v[96:97], v[96:97]
  s_mov_b32 s26, 0
  s_nop 2
  s_cmp_lg_u32 s18, 0
  s_cbranch_scc1 L_attn_kernel_p1_11
  s_setprio 1
L_attn_kernel_p1_11:
  s_cmp_lg_u32 s27, 1
  s_cbranch_scc1 L_attn_kernel_loop_9
  v_mfma_f32_32x32x16_bf16 v[128:143], v[32:35], v[24:27], v[96:111]
  ds_read_b128 v[40:43], v10 offset:1024
  ds_read_b64 v[44:45], v11 offset:256
  v_exp_f32 v112, v112
  s_cmp_eq_u32 s18, 0
  s_cselect_b32 s21, 1, 7
  s_mul_i32 s84, s21, 30720
  s_mul_i32 s22, s17, 5120
  s_add_u32 s84, s84, s22
  s_mul_i32 s85, s21, 20480
  s_add_u32 s85, s85, s22
  s_mov_b32 m0, s85
  s_add_u32 s28, s84, 4096
  buffer_load_dwordx4 v13, s[8:11], s84 offen offset:0 lds
  v_exp_f32 v113, v113
  buffer_load_dwordx4 v13, s[8:11], s84 offen offset:1024 lds
  v_exp_f32 v114, v114
  buffer_load_dwordx4 v13, s[8:11], s84 offen offset:2048 lds
  v_exp_f32 v115, v115
  buffer_load_dwordx4 v13, s[8:11], s84 offen offset:3072 lds
  v_cvt_pk_bf16_f32 v64, v112, v113
  v_mfma_f32_32x32x16_bf16 v[160:175], v[60:63], v[76:79], v[160:175]
  v_cvt_pk_bf16_f32 v65, v114, v115
  v_exp_f32 v116, v116
  s_add_u32 m0, s85, 4096
  s_add_u32 s84, s84, 30720
  buffer_load_dwordx4 v13, s[8:11], s28 offen lds
  s_add_u32 s85, s85, 20480
  v_exp_f32 v117, v117
  v_exp_f32 v118, v118
  v_exp_f32 v119, v119
  v_cvt_pk_bf16_f32 v66, v116, v117
  v_mfma_f32_32x32x16_bf16 v[128:143], v[36:39], v[28:31], v[128:143]
  v_cvt_pk_bf16_f32 v67, v118, v119
  v_exp_f32 v120, v120
  v_exp_f32 v121, v121
  v_exp_f32 v122, v122
  v_exp_f32 v123, v123
  v_cvt_pk_bf16_f32 v68, v120, v121
  v_mfma_f32_32x32x16_bf16 v[144:159], v[48:51], v[64:67], v[144:159]
  v_cvt_pk_bf16_f32 v69, v122, v123
  v_exp_f32 v124, v124
  v_exp_f32 v125, v125
  v_exp_f32 v126, v126
  s_waitcnt lgkmcnt(0)
  v_exp_f32 v127, v127
  v_cvt_pk_bf16_f32 v70, v124, v125
  v_cvt_pk_bf16_f32 v71, v126, v127
  v_mfma_f32_32x32x16_bf16 v[112:127], v[40:43], v[16:19], v[80:95]
  s_mov_b64 exec, s[24:25]
  ds_read_b128 v[56:59], v12 offset:1280
  ds_read_b128 v[60:63], v12 offset:1920
  s_mov_b64 exec, -1
  v_exp_f32 v128, v128
  v_exp_f32 v129, v129
  v_exp_f32 v130, v130
  v_exp_f32 v131, v131
  v_cvt_pk_bf16_f32 v72, v128, v129
  v_mfma_f32_32x32x16_bf16 v[144:159], v[52:55], v[68:71], v[144:159]
  v_cvt_pk_bf16_f32 v73, v130, v131
  v_exp_f32 v132, v132
  v_exp_f32 v133, v133
  v_exp_f32 v134, v134
  v_exp_f32 v135, v135
  v_cvt_pk_bf16_f32 v74, v132, v133
  v_mfma_f32_32x32x16_bf16 v[112:127], v[44:47], v[20:23], v[112:127]
  v_cvt_pk_bf16_f32 v75, v134, v135
  v_exp_f32 v136, v136
  v_exp_f32 v137, v137
  v_exp_f32 v138, v138
  v_exp_f32 v139, v139
  v_cvt_pk_bf16_f32 v76, v136, v137
  v_mfma_f32_32x32x16_bf16 v[160:175], v[48:51], v[72:75], v[160:175]
  v_cvt_pk_bf16_f32 v77, v138, v139
  v_exp_f32 v140, v140
  v_exp_f32 v141, v141
  v_exp_f32 v142, v142
  s_waitcnt lgkmcnt(0)
  v_exp_f32 v143, v143
  v_cvt_pk_bf16_f32 v78, v140, v141
  v_cvt_pk_bf16_f32 v79, v142, v143
  v_mfma_f32_32x32x16_bf16 v[128:143], v[40:43], v[24:27], v[96:111]
  ds_read_b128 v[32:35], v10 offset:2048
  ds_read_b64 v[36:37], v11 offset:512
  v_exp_f32 v112, v112
  s_cmp_eq_u32 s18, 0
  s_cselect_b32 s21, 2, 4
  s_mul_i32 s84, s21, 30720
  s_mul_i32 s22, s17, 5120
  s_add_u32 s84, s84, s22
  s_mul_i32 s85, s21, 20480
  s_add_u32 s85, s85, s22
  s_mov_b32 m0, s85
  s_add_u32 s28, s84, 4096
  buffer_load_dwordx4 v13, s[8:11], s84 offen offset:0 lds
  v_exp_f32 v113, v113
  buffer_load_dwordx4 v13, s[8:11], s84 offen offset:1024 lds
  v_exp_f32 v114, v114
  buffer_load_dwordx4 v13, s[8:11], s84 offen offset:2048 lds
  v_exp_f32 v115, v115
  buffer_load_dwordx4 v13, s[8:11], s84 offen offset:3072 lds
  v_cvt_pk_bf16_f32 v64, v112, v113
  v_mfma_f32_32x32x16_bf16 v[160:175], v[52:55], v[76:79], v[160:175]
  v_cvt_pk_bf16_f32 v65, v114, v115
  v_exp_f32 v116, v116
  s_add_u32 m0, s85, 4096
  s_add_u32 s84, s84, 30720
  buffer_load_dwordx4 v13, s[8:11], s28 offen lds
  s_add_u32 s85, s85, 20480
  v_exp_f32 v117, v117
  v_exp_f32 v118, v118
  v_exp_f32 v119, v119
  v_cvt_pk_bf16_f32 v66, v116, v117
  v_mfma_f32_32x32x16_bf16 v[128:143], v[44:47], v[28:31], v[128:143]
  v_cvt_pk_bf16_f32 v67, v118, v119
  v_exp_f32 v120, v120
  v_exp_f32 v121, v121
  v_exp_f32 v122, v122
  v_exp_f32 v123, v123
  v_cvt_pk_bf16_f32 v68, v120, v121
  v_mfma_f32_32x32x16_bf16 v[144:159], v[56:59], v[64:67], v[144:159]
  v_cvt_pk_bf16_f32 v69, v122, v123
  v_exp_f32 v124, v124
  v_exp_f32 v125, v125
  v_exp_f32 v126, v126
  s_waitcnt lgkmcnt(0)
  v_exp_f32 v127, v127
  v_cvt_pk_bf16_f32 v70, v124, v125
  v_cvt_pk_bf16_f32 v71, v126, v127
  v_mfma_f32_32x32x16_bf16 v[112:127], v[32:35], v[16:19], v[80:95]
  s_mov_b64 exec, s[24:25]
  ds_read_b128 v[48:51], v12 offset:2560
  ds_read_b128 v[52:55], v12 offset:3200
  s_mov_b64 exec, -1
  v_exp_f32 v128, v128
  v_exp_f32 v129, v129
  v_exp_f32 v130, v130
  v_exp_f32 v131, v131
  v_cvt_pk_bf16_f32 v72, v128, v129
  v_mfma_f32_32x32x16_bf16 v[144:159], v[60:63], v[68:71], v[144:159]
  v_cvt_pk_bf16_f32 v73, v130, v131
  v_exp_f32 v132, v132
  v_exp_f32 v133, v133
  v_exp_f32 v134, v134
  v_exp_f32 v135, v135
  v_cvt_pk_bf16_f32 v74, v132, v133
  v_mfma_f32_32x32x16_bf16 v[112:127], v[36:39], v[20:23], v[112:127]
  v_cvt_pk_bf16_f32 v75, v134, v135
  v_exp_f32 v136, v136
  v_exp_f32 v137, v137
  v_exp_f32 v138, v138
  v_exp_f32 v139, v139
  v_cvt_pk_bf16_f32 v76, v136, v137
  v_mfma_f32_32x32x16_bf16 v[160:175], v[56:59], v[72:75], v[160:175]
  v_cvt_pk_bf16_f32 v77, v138, v139
  v_exp_f32 v140, v140
  v_exp_f32 v141, v141
  v_exp_f32 v142, v142
  s_waitcnt lgkmcnt(0)
  v_exp_f32 v143, v143
  v_cvt_pk_bf16_f32 v78, v140, v141
  v_cvt_pk_bf16_f32 v79, v142, v143
  v_mfma_f32_32x32x16_bf16 v[128:143], v[32:35], v[24:27], v[96:111]
  ds_read_b128 v[40:43], v10 offset:3072
  ds_read_b64 v[44:45], v11 offset:768
  v_exp_f32 v112, v112
  s_cmp_eq_u32 s18, 0
  s_cselect_b32 s21, 3, 5
  s_mul_i32 s84, s21, 30720
  s_mul_i32 s22, s17, 5120
  s_add_u32 s84, s84, s22
  s_mul_i32 s85, s21, 20480
  s_add_u32 s85, s85, s22
  s_mov_b32 m0, s85
  s_add_u32 s28, s84, 4096
  buffer_load_dwordx4 v13, s[8:11], s84 offen offset:0 lds
  v_exp_f32 v113, v113
  buffer_load_dwordx4 v13, s[8:11], s84 offen offset:1024 lds
  v_exp_f32 v114, v114
  buffer_load_dwordx4 v13, s[8:11], s84 offen offset:2048 lds
  v_exp_f32 v115, v115
  buffer_load_dwordx4 v13, s[8:11], s84 offen offset:3072 lds
  v_cvt_pk_bf16_f32 v64, v112, v113
  v_mfma_f32_32x32x16_bf16 v[160:175], v[60:63], v[76:79], v[160:175]
  v_cvt_pk_bf16_f32 v65, v114, v115
  v_exp_f32 v116, v116
  s_add_u32 m0, s85, 4096
  s_add_u32 s84, s84, 30720
  buffer_load_dwordx4 v13, s[8:11], s28 offen lds
  s_add_u32 s85, s85, 20480
  v_exp_f32 v117, v117
  v_exp_f32 v118, v118
  v_exp_f32 v119, v119
  v_cvt_pk_bf16_f32 v66, v116, v117
  v_mfma_f32_32x32x16_bf16 v[128:143], v[36:39], v[28:31], v[128:143]
  v_cvt_pk_bf16_f32 v67, v118, v119
  v_exp_f32 v120, v120
  v_exp_f32 v121, v121
  v_exp_f32 v122, v122
  v_exp_f32 v123, v123
  v_cvt_pk_bf16_f32 v68, v120, v121
  v_mfma_f32_32x32x16_bf16 v[144:159], v[48:51], v[64:67], v[144:159]
  v_cvt_pk_bf16_f32 v69, v122, v123
  v_exp_f32 v124, v124
  v_exp_f32 v125, v125
  v_exp_f32 v126, v126
  s_waitcnt lgkmcnt(0)
  v_exp_f32 v127, v127
  v_cvt_pk_bf16_f32 v70, v124, v125
  v_cvt_pk_bf16_f32 v71, v126, v127
  v_mfma_f32_32x32x16_bf16 v[112:127], v[40:43], v[16:19], v[80:95]
  s_mov_b64 exec, s[24:25]
  ds_read_b128 v[56:59], v12 offset:3840
  ds_read_b128 v[60:63], v12 offset:4480
  s_mov_b64 exec, -1
  v_exp_f32 v128, v128
  v_exp_f32 v129, v129
  v_exp_f32 v130, v130
  v_exp_f32 v131, v131
  v_cvt_pk_bf16_f32 v72, v128, v129
  v_mfma_f32_32x32x16_bf16 v[144:159], v[52:55], v[68:71], v[144:159]
  v_cvt_pk_bf16_f32 v73, v130, v131
  v_exp_f32 v132, v132
  v_exp_f32 v133, v133
  v_exp_f32 v134, v134
  v_exp_f32 v135, v135
  v_cvt_pk_bf16_f32 v74, v132, v133
  v_mfma_f32_32x32x16_bf16 v[112:127], v[44:47], v[20:23], v[112:127]
  v_cvt_pk_bf16_f32 v75, v134, v135
  v_exp_f32 v136, v136
  v_exp_f32 v137, v137
  v_exp_f32 v138, v138
  v_exp_f32 v139, v139
  v_cvt_pk_bf16_f32 v76, v136, v137
  v_mfma_f32_32x32x16_bf16 v[160:175], v[48:51], v[72:75], v[160:175]
  v_cvt_pk_bf16_f32 v77, v138, v139
  v_exp_f32 v140, v140
  v_exp_f32 v141, v141
  v_exp_f32 v142, v142
  s_waitcnt lgkmcnt(0)
  v_exp_f32 v143, v143
  v_cvt_pk_bf16_f32 v78, v140, v141
  v_cvt_pk_bf16_f32 v79, v142, v143
  v_mfma_f32_32x32x16_bf16 v[128:143], v[40:43], v[24:27], v[96:111]
  ds_read_b128 v[32:35], v10 offset:4096
  ds_read_b64 v[36:37], v11 offset:1024
  v_exp_f32 v112, v112
  s_add_u32 s53, s52, 0
  s_lshl_b32 s54, s53, 10
  s_cmp_lt_u32 s53, 960
  s_cselect_b32 s56, s40, s44
  s_cselect_b32 s57, s41, s45
  s_cselect_b32 s58, s42, s46
  s_mov_b32 s59, 0x20000
  s_cselect_b64 s[92:93], -1, 0
  v_exp_f32 v113, v113
  s_cselect_b32 s60, 0, 960
  s_mov_b32 s61, 270
  s_cselect_b32 s61, 120, s61
  s_mov_b32 s62, 3884
  s_cselect_b32 s62, 8739, s62
  s_sub_u32 s53, s53, s60
  v_exp_f32 v114, v114
  s_mul_i32 s63, s53, s62
  s_lshr_b32 s63, s63, 20
  s_mul_i32 s60, s63, s61
  s_sub_u32 s53, s53, s60
  s_mul_i32 s60, s53, 52429
  s_lshr_b32 s60, s60, 18
  v_exp_f32 v115, v115
  s_mul_i32 s61, s60, 5
  s_sub_u32 s53, s53, s61
  s_mul_i32 s63, s63, 160
  s_lshl_b32 s53, s53, 5
  s_add_u32 s61, s63, s53
  s_lshl_b32 s62, s60, 2
  s_lshl_b32 s63, s60, 3
  v_cvt_pk_bf16_f32 v64, v112, v113
  v_mfma_f32_32x32x16_bf16 v[160:175], v[52:55], v[76:79], v[160:175]
  v_cvt_pk_bf16_f32 v65, v114, v115
  v_exp_f32 v116, v116
  v_add_u32 v196, s62, v192
  v_mul_u32_u24 v197, 43, v196
  v_lshrrev_b32 v197, 7, v197
  v_mul_u32_u24 v194, 3, v197
  v_sub_u32 v196, v196, v194
  v_exp_f32 v117, v117
  v_exp_f32 v118, v118
  v_exp_f32 v119, v119
  v_cvt_pk_bf16_f32 v66, v116, v117
  v_mfma_f32_32x32x16_bf16 v[128:143], v[44:47], v[28:31], v[128:143]
  v_cvt_pk_bf16_f32 v67, v118, v119
  v_exp_f32 v120, v120
  v_exp_f32 v121, v121
  v_exp_f32 v122, v122
  v_exp_f32 v123, v123
  v_cvt_pk_bf16_f32 v68, v120, v121
  v_mfma_f32_32x32x16_bf16 v[144:159], v[56:59], v[64:67], v[144:159]
  v_cvt_pk_bf16_f32 v69, v122, v123
  v_exp_f32 v124, v124
  v_exp_f32 v125, v125
  v_exp_f32 v126, v126
  s_waitcnt lgkmcnt(0)
  v_exp_f32 v127, v127
  v_cvt_pk_bf16_f32 v70, v124, v125
  v_cvt_pk_bf16_f32 v71, v126, v127
  v_mfma_f32_32x32x16_bf16 v[112:127], v[32:35], v[16:19], v[80:95]
  s_mov_b64 exec, s[24:25]
  ds_read_b128 v[48:51], v12 offset:5120
  ds_read_b128 v[52:55], v12 offset:5760
  s_mov_b64 exec, -1
  v_exp_f32 v128, v128
  v_lshlrev_b32 v196, 2, v196
  v_mul_u32_u24 v197, 5, v197
  v_mov_b32 v194, 0x410
  v_lshrrev_b32 v194, v196, v194
  v_and_b32 v194, 7, v194
  v_add_u32 v194, v194, v197
  v_exp_f32 v129, v129
  v_mov_b32 v195, 0x432
  v_lshrrev_b32 v195, v196, v195
  v_and_b32 v195, 7, v195
  v_add_u32 v195, v195, v197
  v_exp_f32 v130, v130
  v_add_u32 v196, s63, v192
  v_add_u32 v197, 4, v196
  v_cndmask_b32 v194, v196, v194, s[92:93]
  v_cndmask_b32 v195, v197, v195, s[92:93]
  v_exp_f32 v131, v131
  v_mul_u32_u24 v194, 5120, v194
  v_mul_u32_u24 v195, 5120, v195
  v_add_u32 v194, v194, v193
  v_add_u32 v195, v195, v193
  v_cvt_pk_bf16_f32 v72, v128, v129
  v_mfma_f32_32x32x16_bf16 v[144:159], v[60:63], v[68:71], v[144:159]
  v_cvt_pk_bf16_f32 v73, v130, v131
  v_exp_f32 v132, v132
  v_exp_f32 v133, v133
  v_exp_f32 v134, v134
  v_exp_f32 v135, v135
  v_cvt_pk_bf16_f32 v74, v132, v133
  v_mfma_f32_32x32x16_bf16 v[112:127], v[36:39], v[20:23], v[112:127]
  v_cvt_pk_bf16_f32 v75, v134, v135
  v_exp_f32 v136, v136
  v_exp_f32 v137, v137
  v_exp_f32 v138, v138
  v_exp_f32 v139, v139
  v_cvt_pk_bf16_f32 v76, v136, v137
  v_mfma_f32_32x32x16_bf16 v[160:175], v[56:59], v[72:75], v[160:175]
  v_cvt_pk_bf16_f32 v77, v138, v139
  v_exp_f32 v140, v140
  v_exp_f32 v141, v141
  v_exp_f32 v142, v142
  s_waitcnt lgkmcnt(0)
  v_exp_f32 v143, v143
  v_cvt_pk_bf16_f32 v78, v140, v141
  v_cvt_pk_bf16_f32 v79, v142, v143
  v_mfma_f32_32x32x16_bf16 v[128:143], v[32:35], v[24:27], v[96:111]
  ds_read_b128 v[40:43], v10 offset:5120
  ds_read_b64 v[44:45], v11 offset:1280
  v_exp_f32 v112, v112
  buffer_load_short_d16 v176, v194, s[56:59], s61 offen offset:0
  v_exp_f32 v113, v113
  buffer_load_short_d16_hi v180, v194, s[56:59], s61 offen offset:1280
  v_exp_f32 v114, v114
  buffer_load_short_d16 v177, v194, s[56:59], s61 offen offset:2560
  v_exp_f32 v115, v115
  buffer_load_short_d16_hi v181, v194, s[56:59], s61 offen offset:3840
  v_cvt_pk_bf16_f32 v64, v112, v113
  v_mfma_f32_32x32x16_bf16 v[160:175], v[60:63], v[76:79], v[160:175]
  v_cvt_pk_bf16_f32 v65, v114, v115
  v_exp_f32 v116, v116
  buffer_load_short_d16 v178, v195, s[56:59], s61 offen offset:0
  v_exp_f32 v117, v117
  v_exp_f32 v118, v118
  v_exp_f32 v119, v119
  v_cvt_pk_bf16_f32 v66, v116, v117
  v_mfma_f32_32x32x16_bf16 v[128:143], v[36:39], v[28:31], v[128:143]
  v_cvt_pk_bf16_f32 v67, v118, v119
  v_exp_f32 v120, v120
  v_exp_f32 v121, v121
  v_exp_f32 v122, v122
  v_exp_f32 v123, v123
  v_cvt_pk_bf16_f32 v68, v120, v121
  v_mfma_f32_32x32x16_bf16 v[144:159], v[48:51], v[64:67], v[144:159]
  v_cvt_pk_bf16_f32 v69, v122, v123
  v_exp_f32 v124, v124
  v_exp_f32 v125, v125
  v_exp_f32 v126, v126
  s_waitcnt lgkmcnt(0)
  v_exp_f32 v127, v127
  v_cvt_pk_bf16_f32 v70, v124, v125
  v_cvt_pk_bf16_f32 v71, v126, v127
  v_mfma_f32_32x32x16_bf16 v[112:127], v[40:43], v[16:19], v[80:95]
  s_mov_b64 exec, s[24:25]
  ds_read_b128 v[56:59], v12 offset:6400
  ds_read_b128 v[60:63], v12 offset:7040
  s_mov_b64 exec, -1
  v_exp_f32 v128, v128
  buffer_load_short_d16_hi v182, v195, s[56:59], s61 offen offset:1280
  v_exp_f32 v129, v129
  buffer_load_short_d16 v179, v195, s[56:59], s61 offen offset:2560
  v_exp_f32 v130, v130
  buffer_load_short_d16_hi v183, v195, s[56:59], s61 offen offset:3840
  v_exp_f32 v131, v131
  s_add_u32 s53, s52, 2048
  s_lshl_b32 s55, s53, 10
  s_cmp_ge_u32 s53, 3120
  s_cselect_b32 s55, -1, s55
  s_cselect_b32 s53, s52, s53
  s_cmp_lt_u32 s53, 960
  s_cselect_b32 s56, s40, s44
  s_cselect_b32 s57, s41, s45
  s_cselect_b32 s58, s42, s46
  s_mov_b32 s59, 0x20000
  s_cselect_b64 s[92:93], -1, 0
  v_cvt_pk_bf16_f32 v72, v128, v129
  v_mfma_f32_32x32x16_bf16 v[144:159], v[52:55], v[68:71], v[144:159]
  v_cvt_pk_bf16_f32 v73, v130, v131
  v_exp_f32 v132, v132
  v_exp_f32 v133, v133
  v_exp_f32 v134, v134
  v_exp_f32 v135, v135
  v_cvt_pk_bf16_f32 v74, v132, v133
  v_mfma_f32_32x32x16_bf16 v[112:127], v[44:47], v[20:23], v[112:127]
  v_cvt_pk_bf16_f32 v75, v134, v135
  v_exp_f32 v136, v136
  v_exp_f32 v137, v137
  v_exp_f32 v138, v138
  v_exp_f32 v139, v139
  v_cvt_pk_bf16_f32 v76, v136, v137
  v_mfma_f32_32x32x16_bf16 v[160:175], v[48:51], v[72:75], v[160:175]
  v_cvt_pk_bf16_f32 v77, v138, v139
  v_exp_f32 v140, v140
  v_exp_f32 v141, v141
  v_exp_f32 v142, v142
  s_waitcnt lgkmcnt(0)
  v_exp_f32 v143, v143
  v_cvt_pk_bf16_f32 v78, v140, v141
  v_cvt_pk_bf16_f32 v79, v142, v143
  v_mfma_f32_32x32x16_bf16 v[128:143], v[40:43], v[24:27], v[96:111]
  ds_read_b128 v[32:35], v10 offset:6144
  ds_read_b64 v[36:37], v11 offset:1536
  v_exp_f32 v112, v112
  s_cselect_b32 s60, 0, 960
  s_mov_b32 s61, 270
  s_cselect_b32 s61, 120, s61
  s_mov_b32 s62, 3884
  s_cselect_b32 s62, 8739, s62
  s_sub_u32 s53, s53, s60
  v_exp_f32 v113, v113
  s_mul_i32 s63, s53, s62
  s_lshr_b32 s63, s63, 20
  s_mul_i32 s60, s63, s61
  s_sub_u32 s53, s53, s60
  s_mul_i32 s60, s53, 52429
  s_lshr_b32 s60, s60, 18
  v_exp_f32 v114, v114
  s_mul_i32 s61, s60, 5
  s_sub_u32 s53, s53, s61
  s_mul_i32 s63, s63, 160
  s_lshl_b32 s53, s53, 5
  s_add_u32 s61, s63, s53
  s_lshl_b32 s62, s60, 2
  s_lshl_b32 s63, s60, 3
  v_exp_f32 v115, v115
  v_add_u32 v196, s62, v192
  v_mul_u32_u24 v197, 43, v196
  v_lshrrev_b32 v197, 7, v197
  v_mul_u32_u24 v194, 3, v197
  v_sub_u32 v196, v196, v194
  v_cvt_pk_bf16_f32 v64, v112, v113
  v_mfma_f32_32x32x16_bf16 v[160:175], v[52:55], v[76:79], v[160:175]
  v_cvt_pk_bf16_f32 v65, v114, v115
  v_exp_f32 v116, v116
  v_lshlrev_b32 v196, 2, v196
  v_mul_u32_u24 v197, 5, v197
  v_mov_b32 v194, 0x410
  v_lshrrev_b32 v194, v196, v194
  v_and_b32 v194, 7, v194
  v_add_u32 v194, v194, v197
  v_exp_f32 v117, v117
  v_exp_f32 v118, v118
  v_exp_f32 v119, v119
  v_cvt_pk_bf16_f32 v66, v116, v117
  v_mfma_f32_32x32x16_bf16 v[128:143], v[44:47], v[28:31], v[128:143]
  v_cvt_pk_bf16_f32 v67, v118, v119
  v_exp_f32 v120, v120
  v_exp_f32 v121, v121
  v_exp_f32 v122, v122
  v_exp_f32 v123, v123
  v_cvt_pk_bf16_f32 v68, v120, v121
  v_mfma_f32_32x32x16_bf16 v[144:159], v[56:59], v[64:67], v[144:159]
  v_cvt_pk_bf16_f32 v69, v122, v123
  v_exp_f32 v124, v124
  v_exp_f32 v125, v125
  v_exp_f32 v126, v126
  s_waitcnt lgkmcnt(0)
  v_exp_f32 v127, v127
  v_cvt_pk_bf16_f32 v70, v124, v125
  v_cvt_pk_bf16_f32 v71, v126, v127
  v_mfma_f32_32x32x16_bf16 v[112:127], v[32:35], v[16:19], v[80:95]
  s_mov_b64 exec, s[24:25]
  ds_read_b128 v[48:51], v12 offset:7680
  ds_read_b128 v[52:55], v12 offset:8320
  s_mov_b64 exec, -1
  v_exp_f32 v128, v128
  v_mov_b32 v195, 0x432
  v_lshrrev_b32 v195, v196, v195
  v_and_b32 v195, 7, v195
  v_add_u32 v195, v195, v197
  v_exp_f32 v129, v129
  v_add_u32 v196, s63, v192
  v_add_u32 v197, 4, v196
  v_cndmask_b32 v194, v196, v194, s[92:93]
  v_cndmask_b32 v195, v197, v195, s[92:93]
  v_exp_f32 v130, v130
  v_mul_u32_u24 v194, 5120, v194
  v_mul_u32_u24 v195, 5120, v195
  v_add_u32 v194, v194, v193
  v_add_u32 v195, v195, v193
  v_exp_f32 v131, v131
  buffer_load_short_d16 v184, v194, s[56:59], s61 offen offset:0
  v_cvt_pk_bf16_f32 v72, v128, v129
  v_mfma_f32_32x32x16_bf16 v[144:159], v[60:63], v[68:71], v[144:159]
  v_cvt_pk_bf16_f32 v73, v130, v131
  v_exp_f32 v132, v132
  v_exp_f32 v133, v133
  v_exp_f32 v134, v134
  v_exp_f32 v135, v135
  v_cvt_pk_bf16_f32 v74, v132, v133
  v_mfma_f32_32x32x16_bf16 v[112:127], v[36:39], v[20:23], v[112:127]
  v_cvt_pk_bf16_f32 v75, v134, v135
  v_exp_f32 v136, v136
  v_exp_f32 v137, v137
  v_exp_f32 v138, v138
  v_exp_f32 v139, v139
  v_cvt_pk_bf16_f32 v76, v136, v137
  v_mfma_f32_32x32x16_bf16 v[160:175], v[56:59], v[72:75], v[160:175]
  v_cvt_pk_bf16_f32 v77, v138, v139
  v_exp_f32 v140, v140
  v_exp_f32 v141, v141
  v_exp_f32 v142, v142
  s_waitcnt lgkmcnt(0)
  v_exp_f32 v143, v143
  v_cvt_pk_bf16_f32 v78, v140, v141
  v_cvt_pk_bf16_f32 v79, v142, v143
  v_mfma_f32_32x32x16_bf16 v[128:143], v[32:35], v[24:27], v[96:111]
  ds_read_b128 v[40:43], v10 offset:7168
  ds_read_b64 v[44:45], v11 offset:1792
  v_exp_f32 v112, v112
  buffer_load_short_d16_hi v188, v194, s[56:59], s61 offen offset:1280
  v_exp_f32 v113, v113
  buffer_load_short_d16 v185, v194, s[56:59], s61 offen offset:2560
  v_exp_f32 v114, v114
  buffer_load_short_d16_hi v189, v194, s[56:59], s61 offen offset:3840
  v_exp_f32 v115, v115
  buffer_load_short_d16 v186, v195, s[56:59], s61 offen offset:0
  v_cvt_pk_bf16_f32 v64, v112, v113
  v_mfma_f32_32x32x16_bf16 v[160:175], v[60:63], v[76:79], v[160:175]
  v_cvt_pk_bf16_f32 v65, v114, v115
  v_exp_f32 v116, v116
  v_exp_f32 v117, v117
  v_exp_f32 v118, v118
  v_exp_f32 v119, v119
  v_cvt_pk_bf16_f32 v66, v116, v117
  v_mfma_f32_32x32x16_bf16 v[128:143], v[36:39], v[28:31], v[128:143]
  v_cvt_pk_bf16_f32 v67, v118, v119
  v_exp_f32 v120, v120
  v_exp_f32 v121, v121
  v_exp_f32 v122, v122
  v_exp_f32 v123, v123
  v_cvt_pk_bf16_f32 v68, v120, v121
  v_mfma_f32_32x32x16_bf16 v[144:159], v[48:51], v[64:67], v[144:159]
  v_cvt_pk_bf16_f32 v69, v122, v123
  v_exp_f32 v124, v124
  v_exp_f32 v125, v125
  v_exp_f32 v126, v126
  s_waitcnt lgkmcnt(0)
  v_exp_f32 v127, v127
  v_cvt_pk_bf16_f32 v70, v124, v125
  v_cvt_pk_bf16_f32 v71, v126, v127
  v_mfma_f32_32x32x16_bf16 v[112:127], v[40:43], v[16:19], v[80:95]
  s_mov_b64 exec, s[24:25]
  ds_read_b128 v[56:59], v12 offset:8960
  ds_read_b128 v[60:63], v12 offset:9600
  s_mov_b64 exec, -1
  v_exp_f32 v128, v128
  buffer_load_short_d16_hi v190, v195, s[56:59], s61 offen offset:1280
  v_exp_f32 v129, v129
  buffer_load_short_d16 v187, v195, s[56:59], s61 offen offset:2560
  v_exp_f32 v130, v130
  buffer_load_short_d16_hi v191, v195, s[56:59], s61 offen offset:3840
  v_exp_f32 v131, v131
  s_and_b32 s21, s2, 3
  s_mul_i32 s21, s21, 27
  s_lshr_b32 s21, s21, 2
  s_lshl_b32 s21, s21, 7
  s_lshr_b32 s22, s2, 3
  s_lshl_b32 s22, s22, 3
  s_add_u32 s22, s22, s16
  s_and_b32 s23, s22, 127
  s_mul_i32 s23, s23, 17280
  s_add_u32 s21, s21, s23
  s_cmp_ge_u32 s22, 128
  s_cselect_b32 s88, s82, s80
  s_cselect_b32 s89, s83, s81
  s_and_b32 s89, s89, 0xffff
  s_mov_b32 s90, 2211840
  s_mov_b32 s91, 0x20000
  buffer_load_dword v199, v198, s[88:91], s21 offen
  v_cvt_pk_bf16_f32 v72, v128, v129
  v_mfma_f32_32x32x16_bf16 v[144:159], v[52:55], v[68:71], v[144:159]
  v_cvt_pk_bf16_f32 v73, v130, v131
  v_exp_f32 v132, v132
  v_exp_f32 v133, v133
  v_exp_f32 v134, v134
  v_exp_f32 v135, v135
  v_cvt_pk_bf16_f32 v74, v132, v133
  v_mfma_f32_32x32x16_bf16 v[112:127], v[44:47], v[20:23], v[112:127]
  v_cvt_pk_bf16_f32 v75, v134, v135
  v_exp_f32 v136, v136
  v_exp_f32 v137, v137
  v_exp_f32 v138, v138
  v_exp_f32 v139, v139
  v_cvt_pk_bf16_f32 v76, v136, v137
  v_mfma_f32_32x32x16_bf16 v[160:175], v[48:51], v[72:75], v[160:175]
  v_cvt_pk_bf16_f32 v77, v138, v139
  v_exp_f32 v140, v140
  v_exp_f32 v141, v141
  v_exp_f32 v142, v142
  s_waitcnt lgkmcnt(0)
  v_exp_f32 v143, v143
  v_cvt_pk_bf16_f32 v78, v140, v141
  v_cvt_pk_bf16_f32 v79, v142, v143
  s_waitcnt vmcnt(17)
  s_barrier
  v_mfma_f32_32x32x16_bf16 v[128:143], v[40:43], v[24:27], v[96:111]
  ds_read_b128 v[32:35], v10 offset:20480
  ds_read_b64 v[36:37], v11 offset:20480
  v_exp_f32 v112, v112
  v_exp_f32 v113, v113
  v_exp_f32 v114, v114
  v_exp_f32 v115, v115
  v_cvt_pk_bf16_f32 v64, v112, v113
  v_mfma_f32_32x32x16_bf16 v[160:175], v[52:55], v[76:79], v[160:175]
  v_cvt_pk_bf16_f32 v65, v114, v115
  v_exp_f32 v116, v116
  v_exp_f32 v117, v117
  v_exp_f32 v118, v118
  v_exp_f32 v119, v119
  v_cvt_pk_bf16_f32 v66, v116, v117
  v_mfma_f32_32x32x16_bf16 v[128:143], v[44:47], v[28:31], v[128:143]
  v_cvt_pk_bf16_f32 v67, v118, v119
  v_exp_f32 v120, v120
  v_exp_f32 v121, v121
  v_exp_f32 v122, v122
  v_exp_f32 v123, v123
  v_cvt_pk_bf16_f32 v68, v120, v121
  v_mfma_f32_32x32x16_bf16 v[144:159], v[56:59], v[64:67], v[144:159]
  v_cvt_pk_bf16_f32 v69, v122, v123
  v_exp_f32 v124, v124
  v_exp_f32 v125, v125
  v_exp_f32 v126, v126
  s_waitcnt lgkmcnt(0)
  v_exp_f32 v127, v127
  v_cvt_pk_bf16_f32 v70, v124, v125
  v_cvt_pk_bf16_f32 v71, v126, v127
  v_mfma_f32_32x32x16_bf16 v[112:127], v[32:35], v[16:19], v[80:95]
  s_mov_b64 exec, s[24:25]
  ds_read_b128 v[48:51], v12 offset:20480
  ds_read_b128 v[52:55], v12 offset:21120
  s_mov_b64 exec, -1
  v_exp_f32 v128, v128
  v_exp_f32 v129, v129
  v_exp_f32 v130, v130
  v_exp_f32 v131, v131
  v_cvt_pk_bf16_f32 v72, v128, v129
  v_mfma_f32_32x32x16_bf16 v[144:159], v[60:63], v[68:71], v[144:159]
  v_cvt_pk_bf16_f32 v73, v130, v131
  v_exp_f32 v132, v132
  v_exp_f32 v133, v133
  v_exp_f32 v134, v134
  v_exp_f32 v135, v135
  v_cvt_pk_bf16_f32 v74, v132, v133
  v_mfma_f32_32x32x16_bf16 v[112:127], v[36:39], v[20:23], v[112:127]
  v_cvt_pk_bf16_f32 v75, v134, v135
  v_exp_f32 v136, v136
  v_exp_f32 v137, v137
  v_exp_f32 v138, v138
  v_exp_f32 v139, v139
  v_cvt_pk_bf16_f32 v76, v136, v137
  v_mfma_f32_32x32x16_bf16 v[160:175], v[56:59], v[72:75], v[160:175]
  v_cvt_pk_bf16_f32 v77, v138, v139
  v_exp_f32 v140, v140
  v_exp_f32 v141, v141
  v_exp_f32 v142, v142
  s_waitcnt lgkmcnt(0)
  v_exp_f32 v143, v143
  v_cvt_pk_bf16_f32 v78, v140, v141
  v_cvt_pk_bf16_f32 v79, v142, v143
  v_add_u32 v10, 20480, v10
  v_add_u32 v11, 20480, v11
  v_add_u32 v12, 20480, v12
  s_waitcnt vmcnt(1)
  s_mov_b32 s53, 0x07060100
  v_perm_b32 v176, v180, v176, s53
  v_perm_b32 v177, v181, v177, s53
  v_perm_b32 v178, v182, v178, s53
  v_perm_b32 v179, v183, v179, s53
  buffer_store_dwordx4 v[176:179], v13, s[48:51], s54 offen sc1
L_attn_kernel_pks_12:
  s_cmp_eq_u32 s55, -1
  s_cbranch_scc1 L_attn_kernel_pks_13
  v_perm_b32 v184, v188, v184, s53
  v_perm_b32 v185, v189, v185, s53
  v_perm_b32 v186, v190, v186, s53
  v_perm_b32 v187, v191, v187, s53
  buffer_store_dwordx4 v[184:187], v13, s[48:51], s55 offen sc1
L_attn_kernel_pks_13:
  s_mov_b32 s26, 1
.p2align 6
L_attn_kernel_loop_9:
  v_mfma_f32_32x32x16_bf16 v[128:143], v[32:35], v[24:27], v[96:111]
  ds_read_b128 v[40:43], v10 offset:1024
  ds_read_b64 v[44:45], v11 offset:256
  v_exp_f32 v112, v112
  v_exp_f32 v113, v113
  v_exp_f32 v114, v114
  v_exp_f32 v115, v115
  v_cvt_pk_bf16_f32 v64, v112, v113
  v_mfma_f32_32x32x16_bf16 v[160:175], v[60:63], v[76:79], v[160:175]
  v_cvt_pk_bf16_f32 v65, v114, v115
  v_exp_f32 v116, v116
  v_exp_f32 v117, v117
  v_exp_f32 v118, v118
  v_exp_f32 v119, v119
  v_cvt_pk_bf16_f32 v66, v116, v117
  v_mfma_f32_32x32x16_bf16 v[128:143], v[36:39], v[28:31], v[128:143]
  v_cvt_pk_bf16_f32 v67, v118, v119
  v_exp_f32 v120, v120
  v_exp_f32 v121, v121
  v_exp_f32 v122, v122
  v_exp_f32 v123, v123
  v_cvt_pk_bf16_f32 v68, v120, v121
  v_mfma_f32_32x32x16_bf16 v[144:159], v[48:51], v[64:67], v[144:159]
  v_cvt_pk_bf16_f32 v69, v122, v123
  v_exp_f32 v124, v124
  v_exp_f32 v125, v125
  v_exp_f32 v126, v126
  s_waitcnt lgkmcnt(0)
  v_exp_f32 v127, v127
  v_cvt_pk_bf16_f32 v70, v124, v125
  v_cvt_pk_bf16_f32 v71, v126, v127
  v_mfma_f32_32x32x16_bf16 v[112:127], v[40:43], v[16:19], v[80:95]
  s_mov_b64 exec, s[24:25]
  ds_read_b128 v[56:59], v12 offset:1280
  ds_read_b128 v[60:63], v12 offset:1920
  s_mov_b64 exec, -1
  v_exp_f32 v128, v128
  v_exp_f32 v129, v129
  v_exp_f32 v130, v130
  v_exp_f32 v131, v131
  v_cvt_pk_bf16_f32 v72, v128, v129
  v_mfma_f32_32x32x16_bf16 v[144:159], v[52:55], v[68:71], v[144:159]
  v_cvt_pk_bf16_f32 v73, v130, v131
  v_exp_f32 v132, v132
  v_exp_f32 v133, v133
  v_exp_f32 v134, v134
  v_exp_f32 v135, v135
  v_cvt_pk_bf16_f32 v74, v132, v133
  v_mfma_f32_32x32x16_bf16 v[112:127], v[44:47], v[20:23], v[112:127]
  v_cvt_pk_bf16_f32 v75, v134, v135
  v_exp_f32 v136, v136
  v_exp_f32 v137, v137
  v_exp_f32 v138, v138
  v_exp_f32 v139, v139
  v_cvt_pk_bf16_f32 v76, v136, v137
  v_mfma_f32_32x32x16_bf16 v[160:175], v[48:51], v[72:75], v[160:175]
  v_cvt_pk_bf16_f32 v77, v138, v139
  v_exp_f32 v140, v140
  v_exp_f32 v141, v141
  v_exp_f32 v142, v142
  s_waitcnt lgkmcnt(0)
  v_exp_f32 v143, v143
  v_cvt_pk_bf16_f32 v78, v140, v141
  v_cvt_pk_bf16_f32 v79, v142, v143
  v_mfma_f32_32x32x16_bf16 v[128:143], v[40:43], v[24:27], v[96:111]
  ds_read_b128 v[32:35], v10 offset:2048
  ds_read_b64 v[36:37], v11 offset:512
  v_exp_f32 v112, v112
  v_exp_f32 v113, v113
  v_exp_f32 v114, v114
  v_exp_f32 v115, v115
  v_cvt_pk_bf16_f32 v64, v112, v113
  v_mfma_f32_32x32x16_bf16 v[160:175], v[52:55], v[76:79], v[160:175]
  v_cvt_pk_bf16_f32 v65, v114, v115
  v_exp_f32 v116, v116
  v_exp_f32 v117, v117
  v_exp_f32 v118, v118
  v_exp_f32 v119, v119
  v_cvt_pk_bf16_f32 v66, v116, v117
  v_mfma_f32_32x32x16_bf16 v[128:143], v[44:47], v[28:31], v[128:143]
  v_cvt_pk_bf16_f32 v67, v118, v119
  v_exp_f32 v120, v120
  v_exp_f32 v121, v121
  v_exp_f32 v122, v122
  v_exp_f32 v123, v123
  v_cvt_pk_bf16_f32 v68, v120, v121
  v_mfma_f32_32x32x16_bf16 v[144:159], v[56:59], v[64:67], v[144:159]
  v_cvt_pk_bf16_f32 v69, v122, v123
  v_exp_f32 v124, v124
  v_exp_f32 v125, v125
  v_exp_f32 v126, v126
  s_waitcnt lgkmcnt(0)
  v_exp_f32 v127, v127
  v_cvt_pk_bf16_f32 v70, v124, v125
  v_cvt_pk_bf16_f32 v71, v126, v127
  v_mfma_f32_32x32x16_bf16 v[112:127], v[32:35], v[16:19], v[80:95]
  s_mov_b64 exec, s[24:25]
  ds_read_b128 v[48:51], v12 offset:2560
  ds_read_b128 v[52:55], v12 offset:3200
  s_mov_b64 exec, -1
  v_exp_f32 v128, v128
  v_exp_f32 v129, v129
  v_exp_f32 v130, v130
  v_exp_f32 v131, v131
  v_cvt_pk_bf16_f32 v72, v128, v129
  v_mfma_f32_32x32x16_bf16 v[144:159], v[60:63], v[68:71], v[144:159]
  v_cvt_pk_bf16_f32 v73, v130, v131
  v_exp_f32 v132, v132
  v_exp_f32 v133, v133
  v_exp_f32 v134, v134
  v_exp_f32 v135, v135
  v_cvt_pk_bf16_f32 v74, v132, v133
  v_mfma_f32_32x32x16_bf16 v[112:127], v[36:39], v[20:23], v[112:127]
  v_cvt_pk_bf16_f32 v75, v134, v135
  v_exp_f32 v136, v136
  v_exp_f32 v137, v137
  v_exp_f32 v138, v138
  v_exp_f32 v139, v139
  v_cvt_pk_bf16_f32 v76, v136, v137
  v_mfma_f32_32x32x16_bf16 v[160:175], v[56:59], v[72:75], v[160:175]
  v_cvt_pk_bf16_f32 v77, v138, v139
  v_exp_f32 v140, v140
  v_exp_f32 v141, v141
  v_exp_f32 v142, v142
  s_waitcnt lgkmcnt(0)
  v_exp_f32 v143, v143
  v_cvt_pk_bf16_f32 v78, v140, v141
  v_cvt_pk_bf16_f32 v79, v142, v143
  v_mfma_f32_32x32x16_bf16 v[128:143], v[32:35], v[24:27], v[96:111]
  ds_read_b128 v[40:43], v10 offset:3072
  ds_read_b64 v[44:45], v11 offset:768
  v_exp_f32 v112, v112
  v_exp_f32 v113, v113
  v_exp_f32 v114, v114
  v_exp_f32 v115, v115
  v_cvt_pk_bf16_f32 v64, v112, v113
  v_mfma_f32_32x32x16_bf16 v[160:175], v[60:63], v[76:79], v[160:175]
  v_cvt_pk_bf16_f32 v65, v114, v115
  v_exp_f32 v116, v116
  v_exp_f32 v117, v117
  v_exp_f32 v118, v118
  v_exp_f32 v119, v119
  v_cvt_pk_bf16_f32 v66, v116, v117
  v_mfma_f32_32x32x16_bf16 v[128:143], v[36:39], v[28:31], v[128:143]
  v_cvt_pk_bf16_f32 v67, v118, v119
  v_exp_f32 v120, v120
  v_exp_f32 v121, v121
  v_exp_f32 v122, v122
  v_exp_f32 v123, v123
  v_cvt_pk_bf16_f32 v68, v120, v121
  v_mfma_f32_32x32x16_bf16 v[144:159], v[48:51], v[64:67], v[144:159]
  v_cvt_pk_bf16_f32 v69, v122, v123
  v_exp_f32 v124, v124
  v_exp_f32 v125, v125
  v_exp_f32 v126, v126
  s_waitcnt lgkmcnt(0)
  v_exp_f32 v127, v127
  v_cvt_pk_bf16_f32 v70, v124, v125
  v_cvt_pk_bf16_f32 v71, v126, v127
  v_mfma_f32_32x32x16_bf16 v[112:127], v[40:43], v[16:19], v[80:95]
  s_mov_b64 exec, s[24:25]
  ds_read_b128 v[56:59], v12 offset:3840
  ds_read_b128 v[60:63], v12 offset:4480
  s_mov_b64 exec, -1
  v_exp_f32 v128, v128
  v_exp_f32 v129, v129
  v_exp_f32 v130, v130
  v_exp_f32 v131, v131
  v_cvt_pk_bf16_f32 v72, v128, v129
  v_mfma_f32_32x32x16_bf16 v[144:159], v[52:55], v[68:71], v[144:159]
  v_cvt_pk_bf16_f32 v73, v130, v131
  v_exp_f32 v132, v132
  v_exp_f32 v133, v133
  v_exp_f32 v134, v134
  v_exp_f32 v135, v135
  v_cvt_pk_bf16_f32 v74, v132, v133
  v_mfma_f32_32x32x16_bf16 v[112:127], v[44:47], v[20:23], v[112:127]
  v_cvt_pk_bf16_f32 v75, v134, v135
  v_exp_f32 v136, v136
  v_exp_f32 v137, v137
  v_exp_f32 v138, v138
  v_exp_f32 v139, v139
  v_cvt_pk_bf16_f32 v76, v136, v137
  v_mfma_f32_32x32x16_bf16 v[160:175], v[48:51], v[72:75], v[160:175]
  v_cvt_pk_bf16_f32 v77, v138, v139
  v_exp_f32 v140, v140
  v_exp_f32 v141, v141
  v_exp_f32 v142, v142
  s_waitcnt lgkmcnt(0)
  v_exp_f32 v143, v143
  v_cvt_pk_bf16_f32 v78, v140, v141
  v_cvt_pk_bf16_f32 v79, v142, v143
  v_mfma_f32_32x32x16_bf16 v[128:143], v[40:43], v[24:27], v[96:111]
  ds_read_b128 v[32:35], v10 offset:4096
  ds_read_b64 v[36:37], v11 offset:1024
  v_exp_f32 v112, v112
  v_exp_f32 v113, v113
  v_exp_f32 v114, v114
  v_exp_f32 v115, v115
  v_cvt_pk_bf16_f32 v64, v112, v113
  v_mfma_f32_32x32x16_bf16 v[160:175], v[52:55], v[76:79], v[160:175]
  v_cvt_pk_bf16_f32 v65, v114, v115
  v_exp_f32 v116, v116
  v_exp_f32 v117, v117
  v_exp_f32 v118, v118
  v_exp_f32 v119, v119
  v_cvt_pk_bf16_f32 v66, v116, v117
  v_mfma_f32_32x32x16_bf16 v[128:143], v[44:47], v[28:31], v[128:143]
  v_cvt_pk_bf16_f32 v67, v118, v119
  v_exp_f32 v120, v120
  v_exp_f32 v121, v121
  v_exp_f32 v122, v122
  v_exp_f32 v123, v123
  v_cvt_pk_bf16_f32 v68, v120, v121
  v_mfma_f32_32x32x16_bf16 v[144:159], v[56:59], v[64:67], v[144:159]
  v_cvt_pk_bf16_f32 v69, v122, v123
  v_exp_f32 v124, v124
  v_exp_f32 v125, v125
  v_exp_f32 v126, v126
  s_waitcnt lgkmcnt(0)
  v_exp_f32 v127, v127
  v_cvt_pk_bf16_f32 v70, v124, v125
  v_cvt_pk_bf16_f32 v71, v126, v127
  v_mfma_f32_32x32x16_bf16 v[112:127], v[32:35], v[16:19], v[80:95]
  s_mov_b64 exec, s[24:25]
  ds_read_b128 v[48:51], v12 offset:5120
  ds_read_b128 v[52:55], v12 offset:5760
  s_mov_b64 exec, -1
  v_exp_f32 v128, v128
  v_exp_f32 v129, v129
  v_exp_f32 v130, v130
  v_exp_f32 v131, v131
  v_cvt_pk_bf16_f32 v72, v128, v129
  v_mfma_f32_32x32x16_bf16 v[144:159], v[60:63], v[68:71], v[144:159]
  v_cvt_pk_bf16_f32 v73, v130, v131
  v_exp_f32 v132, v132
  v_exp_f32 v133, v133
  v_exp_f32 v134, v134
  v_exp_f32 v135, v135
  v_cvt_pk_bf16_f32 v74, v132, v133
  v_mfma_f32_32x32x16_bf16 v[112:127], v[36:39], v[20:23], v[112:127]
  v_cvt_pk_bf16_f32 v75, v134, v135
  v_exp_f32 v136, v136
  v_exp_f32 v137, v137
  v_exp_f32 v138, v138
  v_exp_f32 v139, v139
  v_cvt_pk_bf16_f32 v76, v136, v137
  v_mfma_f32_32x32x16_bf16 v[160:175], v[56:59], v[72:75], v[160:175]
  v_cvt_pk_bf16_f32 v77, v138, v139
  v_exp_f32 v140, v140
  v_exp_f32 v141, v141
  v_exp_f32 v142, v142
  s_waitcnt lgkmcnt(0)
  v_exp_f32 v143, v143
  v_cvt_pk_bf16_f32 v78, v140, v141
  v_cvt_pk_bf16_f32 v79, v142, v143
  v_mfma_f32_32x32x16_bf16 v[128:143], v[32:35], v[24:27], v[96:111]
  ds_read_b128 v[40:43], v10 offset:5120
  ds_read_b64 v[44:45], v11 offset:1280
  v_exp_f32 v112, v112
  v_exp_f32 v113, v113
  v_exp_f32 v114, v114
  v_exp_f32 v115, v115
  v_cvt_pk_bf16_f32 v64, v112, v113
  v_mfma_f32_32x32x16_bf16 v[160:175], v[60:63], v[76:79], v[160:175]
  v_cvt_pk_bf16_f32 v65, v114, v115
  v_exp_f32 v116, v116
  v_exp_f32 v117, v117
  v_exp_f32 v118, v118
  v_exp_f32 v119, v119
  v_cvt_pk_bf16_f32 v66, v116, v117
  v_mfma_f32_32x32x16_bf16 v[128:143], v[36:39], v[28:31], v[128:143]
  v_cvt_pk_bf16_f32 v67, v118, v119
  v_exp_f32 v120, v120
  v_exp_f32 v121, v121
  v_exp_f32 v122, v122
  v_exp_f32 v123, v123
  v_cvt_pk_bf16_f32 v68, v120, v121
  v_mfma_f32_32x32x16_bf16 v[144:159], v[48:51], v[64:67], v[144:159]
  v_cvt_pk_bf16_f32 v69, v122, v123
  v_exp_f32 v124, v124
  v_exp_f32 v125, v125
  v_exp_f32 v126, v126
  s_waitcnt lgkmcnt(0)
  v_exp_f32 v127, v127
  v_cvt_pk_bf16_f32 v70, v124, v125
  v_cvt_pk_bf16_f32 v71, v126, v127
  v_mfma_f32_32x32x16_bf16 v[112:127], v[40:43], v[16:19], v[80:95]
  s_mov_b64 exec, s[24:25]
  ds_read_b128 v[56:59], v12 offset:6400
  ds_read_b128 v[60:63], v12 offset:7040
  s_mov_b64 exec, -1
  v_exp_f32 v128, v128
  v_exp_f32 v129, v129
  v_exp_f32 v130, v130
  v_exp_f32 v131, v131
  v_cvt_pk_bf16_f32 v72, v128, v129
  v_mfma_f32_32x32x16_bf16 v[144:159], v[52:55], v[68:71], v[144:159]
  v_cvt_pk_bf16_f32 v73, v130, v131
  v_exp_f32 v132, v132
  v_exp_f32 v133, v133
  v_exp_f32 v134, v134
  v_exp_f32 v135, v135
  v_cvt_pk_bf16_f32 v74, v132, v133
  v_mfma_f32_32x32x16_bf16 v[112:127], v[44:47], v[20:23], v[112:127]
  v_cvt_pk_bf16_f32 v75, v134, v135
  v_exp_f32 v136, v136
  v_exp_f32 v137, v137
  v_exp_f32 v138, v138
  v_exp_f32 v139, v139
  v_cvt_pk_bf16_f32 v76, v136, v137
  v_mfma_f32_32x32x16_bf16 v[160:175], v[48:51], v[72:75], v[160:175]
  v_cvt_pk_bf16_f32 v77, v138, v139
  v_exp_f32 v140, v140
  v_exp_f32 v141, v141
  v_exp_f32 v142, v142
  s_waitcnt lgkmcnt(0)
  v_exp_f32 v143, v143
  v_cvt_pk_bf16_f32 v78, v140, v141
  v_cvt_pk_bf16_f32 v79, v142, v143
  v_mfma_f32_32x32x16_bf16 v[128:143], v[40:43], v[24:27], v[96:111]
  ds_read_b128 v[32:35], v10 offset:6144
  ds_read_b64 v[36:37], v11 offset:1536
  v_exp_f32 v112, v112
  v_exp_f32 v113, v113
  v_exp_f32 v114, v114
  v_exp_f32 v115, v115
  v_cvt_pk_bf16_f32 v64, v112, v113
  v_mfma_f32_32x32x16_bf16 v[160:175], v[52:55], v[76:79], v[160:175]
  v_cvt_pk_bf16_f32 v65, v114, v115
  v_exp_f32 v116, v116
  v_exp_f32 v117, v117
  v_exp_f32 v118, v118
  v_exp_f32 v119, v119
  v_cvt_pk_bf16_f32 v66, v116, v117
  v_mfma_f32_32x32x16_bf16 v[128:143], v[44:47], v[28:31], v[128:143]
  v_cvt_pk_bf16_f32 v67, v118, v119
  v_exp_f32 v120, v120
  v_exp_f32 v121, v121
  v_exp_f32 v122, v122
  v_exp_f32 v123, v123
  v_cvt_pk_bf16_f32 v68, v120, v121
  v_mfma_f32_32x32x16_bf16 v[144:159], v[56:59], v[64:67], v[144:159]
  v_cvt_pk_bf16_f32 v69, v122, v123
  v_exp_f32 v124, v124
  v_exp_f32 v125, v125
  v_exp_f32 v126, v126
  s_waitcnt lgkmcnt(0)
  v_exp_f32 v127, v127
  v_cvt_pk_bf16_f32 v70, v124, v125
  v_cvt_pk_bf16_f32 v71, v126, v127
  v_mfma_f32_32x32x16_bf16 v[112:127], v[32:35], v[16:19], v[80:95]
  s_mov_b64 exec, s[24:25]
  ds_read_b128 v[48:51], v12 offset:7680
  ds_read_b128 v[52:55], v12 offset:8320
  s_mov_b64 exec, -1
  v_exp_f32 v128, v128
  v_exp_f32 v129, v129
  v_exp_f32 v130, v130
  v_exp_f32 v131, v131
  v_cvt_pk_bf16_f32 v72, v128, v129
  v_mfma_f32_32x32x16_bf16 v[144:159], v[60:63], v[68:71], v[144:159]
  v_cvt_pk_bf16_f32 v73, v130, v131
  v_exp_f32 v132, v132
  v_exp_f32 v133, v133
  v_exp_f32 v134, v134
  v_exp_f32 v135, v135
  v_cvt_pk_bf16_f32 v74, v132, v133
  v_mfma_f32_32x32x16_bf16 v[112:127], v[36:39], v[20:23], v[112:127]
  v_cvt_pk_bf16_f32 v75, v134, v135
  v_exp_f32 v136, v136
  v_exp_f32 v137, v137
  v_exp_f32 v138, v138
  v_exp_f32 v139, v139
  v_cvt_pk_bf16_f32 v76, v136, v137
  v_mfma_f32_32x32x16_bf16 v[160:175], v[56:59], v[72:75], v[160:175]
  v_cvt_pk_bf16_f32 v77, v138, v139
  v_exp_f32 v140, v140
  v_exp_f32 v141, v141
  v_exp_f32 v142, v142
  s_waitcnt lgkmcnt(0)
  v_exp_f32 v143, v143
  v_cvt_pk_bf16_f32 v78, v140, v141
  v_cvt_pk_bf16_f32 v79, v142, v143
  v_mfma_f32_32x32x16_bf16 v[128:143], v[32:35], v[24:27], v[96:111]
  ds_read_b128 v[40:43], v10 offset:7168
  ds_read_b64 v[44:45], v11 offset:1792
  v_exp_f32 v112, v112
  v_exp_f32 v113, v113
  v_exp_f32 v114, v114
  v_exp_f32 v115, v115
  v_cvt_pk_bf16_f32 v64, v112, v113
  v_mfma_f32_32x32x16_bf16 v[160:175], v[60:63], v[76:79], v[160:175]
  v_cvt_pk_bf16_f32 v65, v114, v115
  v_exp_f32 v116, v116
  v_exp_f32 v117, v117
  v_exp_f32 v118, v118
  v_exp_f32 v119, v119
  v_cvt_pk_bf16_f32 v66, v116, v117
  v_mfma_f32_32x32x16_bf16 v[128:143], v[36:39], v[28:31], v[128:143]
  v_cvt_pk_bf16_f32 v67, v118, v119
  v_exp_f32 v120, v120
  v_exp_f32 v121, v121
  v_exp_f32 v122, v122
  v_exp_f32 v123, v123
  v_cvt_pk_bf16_f32 v68, v120, v121
  v_mfma_f32_32x32x16_bf16 v[144:159], v[48:51], v[64:67], v[144:159]
  v_cvt_pk_bf16_f32 v69, v122, v123
  v_exp_f32 v124, v124
  v_exp_f32 v125, v125
  v_exp_f32 v126, v126
  s_waitcnt lgkmcnt(0)
  v_exp_f32 v127, v127
  v_cvt_pk_bf16_f32 v70, v124, v125
  v_cvt_pk_bf16_f32 v71, v126, v127
  v_mfma_f32_32x32x16_bf16 v[112:127], v[40:43], v[16:19], v[80:95]
  s_mov_b64 exec, s[24:25]
  ds_read_b128 v[56:59], v12 offset:8960
  ds_read_b128 v[60:63], v12 offset:9600
  s_mov_b64 exec, -1
  v_exp_f32 v128, v128
  v_exp_f32 v129, v129
  v_exp_f32 v130, v130
  v_exp_f32 v131, v131
  v_cvt_pk_bf16_f32 v72, v128, v129
  v_mfma_f32_32x32x16_bf16 v[144:159], v[52:55], v[68:71], v[144:159]
  v_cvt_pk_bf16_f32 v73, v130, v131
  v_exp_f32 v132, v132
  v_exp_f32 v133, v133
  v_exp_f32 v134, v134
  v_exp_f32 v135, v135
  v_cvt_pk_bf16_f32 v74, v132, v133
  v_mfma_f32_32x32x16_bf16 v[112:127], v[44:47], v[20:23], v[112:127]
  v_cvt_pk_bf16_f32 v75, v134, v135
  v_exp_f32 v136, v136
  v_exp_f32 v137, v137
  v_exp_f32 v138, v138
  v_exp_f32 v139, v139
  v_cvt_pk_bf16_f32 v76, v136, v137
  v_mfma_f32_32x32x16_bf16 v[160:175], v[48:51], v[72:75], v[160:175]
  v_cvt_pk_bf16_f32 v77, v138, v139
  v_exp_f32 v140, v140
  v_exp_f32 v141, v141
  v_exp_f32 v142, v142
  s_waitcnt lgkmcnt(0)
  v_exp_f32 v143, v143
  v_cvt_pk_bf16_f32 v78, v140, v141
  v_cvt_pk_bf16_f32 v79, v142, v143
  v_mfma_f32_32x32x16_bf16 v[128:143], v[40:43], v[24:27], v[96:111]
  ds_read_b128 v[32:35], v10 offset:20480
  ds_read_b64 v[36:37], v11 offset:20480
  v_exp_f32 v112, v112
  v_exp_f32 v113, v113
  v_exp_f32 v114, v114
  v_exp_f32 v115, v115
  v_cvt_pk_bf16_f32 v64, v112, v113
  v_mfma_f32_32x32x16_bf16 v[160:175], v[52:55], v[76:79], v[160:175]
  v_cvt_pk_bf16_f32 v65, v114, v115
  v_exp_f32 v116, v116
  v_exp_f32 v117, v117
  v_exp_f32 v118, v118
  v_exp_f32 v119, v119
  v_cvt_pk_bf16_f32 v66, v116, v117
  v_mfma_f32_32x32x16_bf16 v[128:143], v[44:47], v[28:31], v[128:143]
  v_cvt_pk_bf16_f32 v67, v118, v119
  v_exp_f32 v120, v120
  v_exp_f32 v121, v121
  v_exp_f32 v122, v122
  v_exp_f32 v123, v123
  v_cvt_pk_bf16_f32 v68, v120, v121
  v_mfma_f32_32x32x16_bf16 v[144:159], v[56:59], v[64:67], v[144:159]
  v_cvt_pk_bf16_f32 v69, v122, v123
  v_exp_f32 v124, v124
  v_exp_f32 v125, v125
  v_exp_f32 v126, v126
  s_waitcnt lgkmcnt(0)
  v_exp_f32 v127, v127
  v_cvt_pk_bf16_f32 v70, v124, v125
  v_cvt_pk_bf16_f32 v71, v126, v127
  v_mfma_f32_32x32x16_bf16 v[112:127], v[32:35], v[16:19], v[80:95]
  s_mov_b64 exec, s[24:25]
  ds_read_b128 v[48:51], v12 offset:20480
  ds_read_b128 v[52:55], v12 offset:21120
  s_mov_b64 exec, -1
  v_exp_f32 v128, v128
  v_exp_f32 v129, v129
  v_exp_f32 v130, v130
  v_exp_f32 v131, v131
  v_cvt_pk_bf16_f32 v72, v128, v129
  v_mfma_f32_32x32x16_bf16 v[144:159], v[60:63], v[68:71], v[144:159]
  v_cvt_pk_bf16_f32 v73, v130, v131
  v_exp_f32 v132, v132
  v_exp_f32 v133, v133
  v_exp_f32 v134, v134
  v_exp_f32 v135, v135
  v_cvt_pk_bf16_f32 v74, v132, v133
  v_mfma_f32_32x32x16_bf16 v[112:127], v[36:39], v[20:23], v[112:127]
  v_cvt_pk_bf16_f32 v75, v134, v135
  v_exp_f32 v136, v136
  v_exp_f32 v137, v137
  v_exp_f32 v138, v138
  v_exp_f32 v139, v139
  v_cvt_pk_bf16_f32 v76, v136, v137
  v_mfma_f32_32x32x16_bf16 v[160:175], v[56:59], v[72:75], v[160:175]
  v_cvt_pk_bf16_f32 v77, v138, v139
  v_exp_f32 v140, v140
  v_exp_f32 v141, v141
  v_exp_f32 v142, v142
  s_waitcnt lgkmcnt(0)
  v_exp_f32 v143, v143
  v_cvt_pk_bf16_f32 v78, v140, v141
  v_cvt_pk_bf16_f32 v79, v142, v143
  v_add_u32 v10, 20480, v10
  v_add_u32 v11, 20480, v11
  v_add_u32 v12, 20480, v12
  s_cmp_lg_u32 s27, 1
  s_cbranch_scc1 L_attn_kernel_mp2_15
  s_cmp_lg_u32 s26, 1
  s_cbranch_scc1 L_attn_kernel_mp2_15
  s_waitcnt vmcnt(0)
  v_readfirstlane_b32 s100, v202
  s_lshl_b32 s87, s52, 2
  s_add_u32 s87, s87, 4096
  s_nop 2
  s_cmp_lg_u32 s100, 0
  s_cbranch_scc1 L_attn_kernel_nz_16
  s_load_dwordx4 s[92:95], s[0:1], 64
  s_waitcnt lgkmcnt(0)
  s_mov_b32 s88, s92
  s_and_b32 s89, s93, 0xffff
  s_mov_b32 s90, 256
  s_mov_b32 s91, 0x20000
  s_mov_b32 s86, 0x40000
  v_mov_b32 v200, 0
L_attn_kernel_nonce_17:
  buffer_load_dword v201, v200, s[88:91], 0 offen sc1
  s_waitcnt vmcnt(0)
  v_readfirstlane_b32 s100, v201
  s_nop 3
  s_cmp_lg_u32 s100, 0
  s_cbranch_scc1 L_attn_kernel_nonce_done_18
  s_sleep 1
  s_sub_u32 s86, s86, 1
  s_cmp_lg_u32 s86, 0
  s_cbranch_scc1 L_attn_kernel_nonce_17
L_attn_kernel_nonce_done_18:
L_attn_kernel_nz_16:
  s_mov_b64 exec, 1
  v_mov_b32 v200, 0
  v_mov_b32 v201, s100
  buffer_store_dword v201, v200, s[96:99], s87 offen sc1
  s_mov_b64 exec, -1
L_attn_kernel_mp2_15:
  s_add_u32 s26, s26, 1
  s_cmp_lt_u32 s26, s29
  s_cbranch_scc1 L_attn_kernel_loop_9
  v_mfma_f32_32x32x16_bf16 v[160:175], v[60:63], v[76:79], v[160:175]
L_attn_kernel_after_10:
  s_waitcnt lgkmcnt(0)
  s_nop 13
  v_cmp_ngt_f32 vcc, s30, v152
  v_cmp_ngt_f32 s[86:87], s30, v168
  s_nop 3
  s_or_b32 s21, s87, vcc_hi
  s_cmp_eq_u32 s21, 0
  s_cbranch_scc1 L_attn_kernel_ok_19
  s_cmp_lg_u32 s27, 1
  s_cbranch_scc1 L_attn_kernel_ok_19
  s_lshl_b32 s27, s29, 3
  s_mul_i32 s21, s29, 20480
  v_subrev_u32 v10, s21, v10
  v_subrev_u32 v11, s21, v11
  v_subrev_u32 v12, s21, v12
  v_and_b32 v8, 31, v1
  v_cmp_eq_u32 vcc, 20, v8
  v_mov_b32 v9, 0x3f803f80
  v_mov_b32 v8, 0
  s_nop 0
  v_cndmask_b32 v8, v8, v9, vcc
  v_mov_b32 v9, v8
  v_pk_mov_b32 v[48:49], v[8:9], v[8:9]
  v_pk_mov_b32 v[50:51], v[8:9], v[8:9]
  v_pk_mov_b32 v[52:53], v[8:9], v[8:9]
  v_pk_mov_b32 v[54:55], v[8:9], v[8:9]
  v_pk_mov_b32 v[56:57], v[8:9], v[8:9]
  v_pk_mov_b32 v[58:59], v[8:9], v[8:9]
  v_pk_mov_b32 v[60:61], v[8:9], v[8:9]
  v_pk_mov_b32 v[62:63], v[8:9], v[8:9]
  v_pk_mov_b32 v[144:145], 0, 0
  v_pk_mov_b32 v[160:161], 0, 0
  v_pk_mov_b32 v[146:147], 0, 0
  v_pk_mov_b32 v[162:163], 0, 0
  v_pk_mov_b32 v[148:149], 0, 0
  v_pk_mov_b32 v[164:165], 0, 0
  v_pk_mov_b32 v[150:151], 0, 0
  v_pk_mov_b32 v[166:167], 0, 0
  v_pk_mov_b32 v[152:153], 0, 0
  v_pk_mov_b32 v[168:169], 0, 0
  v_pk_mov_b32 v[154:155], 0, 0
  v_pk_mov_b32 v[170:171], 0, 0
  v_pk_mov_b32 v[76:77], 0, 0
  v_pk_mov_b32 v[78:79], 0, 0
  s_branch L_attn_kernel_max_7
L_attn_kernel_ok_19:
  s_cmp_eq_u32 s18, 0
  s_cbranch_scc1 L_attn_kernel_noswap_20
  v_swap_b32 v144, v160
  v_swap_b32 v145, v161
  v_swap_b32 v146, v162
  v_swap_b32 v147, v163
  v_swap_b32 v148, v164
  v_swap_b32 v149, v165
  v_swap_b32 v150, v166
  v_swap_b32 v151, v167
  v_swap_b32 v152, v168
  v_swap_b32 v153, v169
  v_swap_b32 v154, v170
  v_swap_b32 v155, v171
  v_swap_b32 v80, v96
L_attn_kernel_noswap_20:
  s_lshl_b32 s21, s16, 12
  s_xor_b32 s22, s16, 4
  s_lshl_b32 s22, s22, 12
  s_add_u32 s21, s21, 131072
  s_add_u32 s22, s22, 131072
  v_add_u32 v2, s21, v13
  v_add_u32 v3, s22, v13
  s_barrier
  ds_write_b128 v2, v[160:163] offset:0
  ds_write_b128 v2, v[164:167] offset:1024
  ds_write_b128 v2, v[168:171] offset:2048
  ds_write_b32 v2, v96 offset:3072
  s_waitcnt lgkmcnt(0)
  s_barrier
  ds_read_b128 v[160:163], v3 offset:0
  ds_read_b128 v[164:167], v3 offset:1024
  ds_read_b128 v[168:171], v3 offset:2048
  ds_read_b32 v96, v3 offset:3072
  s_waitcnt lgkmcnt(0)
  v_min_f32 v114, v80, v96
  v_sub_f32 v112, v114, v80
  v_sub_f32 v113, v114, v96
  v_exp_f32 v112, v112
  v_exp_f32 v113, v113
  s_nop 0
  v_mul_f32 v144, v144, v112
  v_mul_f32 v145, v145, v112
  v_mul_f32 v146, v146, v112
  v_mul_f32 v147, v147, v112
  v_mul_f32 v148, v148, v112
  v_mul_f32 v149, v149, v112
  v_mul_f32 v150, v150, v112
  v_mul_f32 v151, v151, v112
  v_mul_f32 v152, v152, v112
  v_mul_f32 v153, v153, v112
  v_mul_f32 v154, v154, v112
  v_mul_f32 v155, v155, v112
  v_fmac_f32 v144, v160, v113
  v_fmac_f32 v145, v161, v113
  v_fmac_f32 v146, v162, v113
  v_fmac_f32 v147, v163, v113
  v_fmac_f32 v148, v164, v113
  v_fmac_f32 v149, v165, v113
  v_fmac_f32 v150, v166, v113
  v_fmac_f32 v151, v167, v113
  v_fmac_f32 v152, v168, v113
  v_fmac_f32 v153, v169, v113
  v_fmac_f32 v154, v170, v113
  v_fmac_f32 v155, v171, v113
  v_mov_b32 v116, v152
  v_mov_b32 v117, v152
  s_nop 1
  v_permlane32_swap_b32 v116, v117
  s_nop 0
  v_rcp_f32 v117, v117
  s_nop 0
  v_mul_f32 v144, v144, v117
  v_mul_f32 v145, v145, v117
  v_mul_f32 v146, v146, v117
  v_mul_f32 v147, v147, v117
  v_mul_f32 v148, v148, v117
  v_mul_f32 v149, v149, v117
  v_mul_f32 v150, v150, v117
  v_mul_f32 v151, v151, v117
  v_mul_f32 v152, v152, v117
  v_mul_f32 v153, v153, v117
  v_mul_f32 v154, v154, v117
  v_mul_f32 v155, v155, v117
  v_cvt_pk_bf16_f32 v64, v144, v145
  v_cvt_pk_bf16_f32 v65, v146, v147
  v_cvt_pk_bf16_f32 v66, v148, v149
  v_cvt_pk_bf16_f32 v67, v150, v151
  v_cvt_pk_bf16_f32 v68, v152, v153
  v_cvt_pk_bf16_f32 v69, v154, v155
  v_pk_mov_b32 v[70:71], 0, 0
  buffer_store_dwordx4 v[64:67], v14, s[12:15], 0 offen sc1
  s_mov_b32 exec_hi, 0
  buffer_store_dwordx4 v[68:71], v15, s[12:15], 0 offen sc1
  s_mov_b64 exec, -1
  s_waitcnt vmcnt(0)
  s_barrier
  s_cmp_lg_u32 s16, 0
  s_cbranch_scc1 L_attn_kernel_nosig_21
  s_lshl_b32 s87, s20, 5
  s_add_u32 s87, s87, s19
  s_lshl_b32 s87, s87, 2
  s_add_u32 s87, s87, 1024
  s_mov_b64 exec, 1
  v_mov_b32 v4, 0
  v_mov_b32 v5, s100
  buffer_store_dword v5, v4, s[96:99], s87 offen sc1
  s_mov_b64 exec, -1
L_attn_kernel_nosig_21:
L_attn_kernel_done_1:
  s_endpgm
attn_kernel_end:

.p2align 8
oproj_kernel:
  s_load_dwordx2 s[4:5], s[0:1], 72
  s_load_dwordx2 s[28:29], s[0:1], 0
  s_load_dwordx4 s[92:95], s[0:1], 64
  s_and_b32 s20, s2, 7
  s_lshr_b32 s21, s2, 3
  s_lshr_b32 s22, s20, 1
  s_lshl_b32 s22, s22, 3
  s_and_b32 s23, s21, 7
  s_add_u32 s17, s22, s23
  s_and_b32 s22, s20, 1
  s_lshl_b32 s22, s22, 2
  s_lshr_b32 s23, s21, 3
  s_add_u32 s18, s22, s23
  v_and_b32 v1, 63, v0
  v_lshrrev_b32 v2, 6, v0
  v_lshlrev_b32 v10, 4, v1
  v_readfirstlane_b32 s16, v2
  s_and_b32 s19, s16, 3
  s_lshr_b32 s27, s16, 2
  s_lshl_b32 s20, s17, 2
  s_add_u32 s20, s20, s19
  s_mul_i32 s24, s20, 24576
  s_mul_i32 s20, s27, 12288
  s_add_u32 s24, s24, s20
  s_mul_i32 s25, s18, 122880
  s_mul_i32 s20, s27, 61440
  s_add_u32 s25, s25, s20
  s_mul_i32 s21, s19, 5120
  s_add_u32 s25, s25, s21
  s_mul_i32 s22, s27, 61440
  s_add_u32 s26, s22, s21
  v_add_u32 v11, s22, v10
  v_add_u32 v12, 40960, v11
  s_waitcnt lgkmcnt(0)
  s_add_u32 s8, s4, 7864320
  s_addc_u32 s9, s5, 0
  s_and_b32 s9, s9, 0xffff
  s_mov_b32 s10, 3145728
  s_mov_b32 s11, 0x20000
  s_add_u32 s12, s4, 20854784
  s_addc_u32 s13, s5, 0
  s_and_b32 s13, s13, 0xffff
  s_mov_b32 s14, 983040
  s_mov_b32 s15, 0x20000
  s_mov_b32 s88, s92
  s_and_b32 s89, s93, 0xffff
  s_mov_b32 s90, 256
  s_mov_b32 s91, 0x20000
  s_add_u32 s96, s94, 24049664
  s_addc_u32 s97, s95, 0
  s_and_b32 s97, s97, 0xffff
  s_mov_b32 s98, 12288
  s_mov_b32 s99, 0x20000
  s_mul_i32 s86, s18, 120
  s_add_u32 s86, s86, 0
  v_add_u32 v92, 0, v1
  v_min_u32 v92, 119, v92
  v_add_u32 v92, s86, v92
  v_lshlrev_b32 v92, 2, v92
  v_add_u32 v92, 4096, v92
  v_add_u32 v93, 64, v1
  v_min_u32 v93, 119, v93
  v_add_u32 v93, s86, v93
  v_lshlrev_b32 v93, 2, v93
  v_add_u32 v93, 4096, v93
  s_lshr_b32 s86, s17, 2
  s_lshl_b32 s86, s86, 5
  v_mov_b32 v101, 0
  v_and_b32 v100, 31, v1
  v_add_u32 v100, s86, v100
  v_lshlrev_b32 v100, 2, v100
  v_add_u32 v100, 1024, v100
  s_cmp_lg_u32 s16, 0
  s_cbranch_scc1 L_oproj_kernel_nop0_2
  buffer_load_dword v120, v101, s[88:91], 0 offen sc1
  buffer_load_dword v121, v100, s[96:99], 0 offen sc1
L_oproj_kernel_nop0_2:
  buffer_load_dword v112, v101, s[88:91], 0 offen sc1
  buffer_load_dword v113, v92, s[96:99], 0 offen sc1
  buffer_load_dword v114, v93, s[96:99], 0 offen sc1
  s_mov_b32 s87, 0x40000
  s_waitcnt vmcnt(0)
  s_branch L_oproj_kernel_poll_chk_4
L_oproj_kernel_poll_3:
  s_sleep 1
  buffer_load_dword v112, v101, s[88:91], 0 offen sc1
  buffer_load_dword v113, v92, s[96:99], 0 offen sc1
  buffer_load_dword v114, v93, s[96:99], 0 offen sc1
  s_waitcnt vmcnt(0)
L_oproj_kernel_poll_chk_4:
  v_readfirstlane_b32 s100, v112
  s_nop 3
  v_cmp_eq_u32 vcc, 0, v112
  v_cmp_ne_u32 s[94:95], s100, v113
  s_nop 3
  s_or_b64 vcc, vcc, s[94:95]
  v_cmp_ne_u32 s[94:95], s100, v114
  s_nop 3
  s_or_b64 vcc, vcc, s[94:95]
  s_nop 4
  s_cbranch_vccz L_oproj_kernel_poll_done_5
  s_sub_u32 s87, s87, 1
  s_cmp_lg_u32 s87, 0
  s_cbranch_scc1 L_oproj_kernel_poll_3
L_oproj_kernel_poll_done_5:
  s_add_u32 m0, s26, 0
  s_add_u32 s20, s25, 0
  buffer_load_dwordx4 v10, s[12:15], s20 offen offset:0 lds
  buffer_load_dwordx4 v10, s[12:15], s20 offen offset:1024 lds
  buffer_load_dwordx4 v10, s[12:15], s20 offen offset:2048 lds
  buffer_load_dwordx4 v10, s[12:15], s20 offen offset:3072 lds
  s_add_u32 m0, s26, 4096
  s_add_u32 s21, s25, 4096
  buffer_load_dwordx4 v10, s[12:15], s21 offen lds
  s_getpc_b64 s[48:49]
L_oproj_kernel_here_6:
  s_lshr_b32 s54, s2, 3
  s_and_b32 s54, s54, 31
  s_lshl_b32 s54, s54, 10
  v_lshrrev_b32 v160, 6, v0
  v_lshlrev_b32 v160, 7, v160
  v_add_u32 v160, s54, v160
  s_mov_b64 s[50:51], exec
  s_mov_b64 exec, 1
  s_sub_u32 s52, s48, 0x100000
  s_subb_u32 s53, s49, 0
  v_min_u32 v159, ffn_kernel_end - ffn_kernel - 4, v160
  v_add_u32 v159, ffn_kernel - L_oproj_kernel_here_6 + 0x100000, v159
  global_load_dword v158, v159, s[52:53]
  s_mov_b64 exec, s[50:51]
  v_and_b32 v6, 15, v1
  v_lshrrev_b32 v7, 4, v1
  s_lshl_b32 s20, s17, 6
  s_lshl_b32 s21, s19, 4
  s_add_u32 s20, s20, s21
  v_add_u32 v6, s20, v6
  v_lshrrev_b32 v2, 5, v6
  v_mul_u32_u24 v8, 40960, v2
  v_and_b32 v2, 31, v6
  v_lshl_add_u32 v8, v2, 4, v8
  v_lshrrev_b32 v2, 1, v7
  v_lshl_add_u32 v8, v2, 9, v8
  v_and_b32 v2, 1, v7
  v_lshl_add_u32 v8, v2, 3, v8
  v_mul_u32_u24 v9, 1280, v6
  v_lshl_add_u32 v9, v7, 3, v9
  s_add_u32 s32, s4, 11010048
  s_addc_u32 s33, s5, 0
  s_and_b32 s33, s33, 0xffff
  s_mov_b32 s34, 2621440
  s_mov_b32 s35, 0x20000
  s_mov_b32 s36, s28
  s_and_b32 s37, s29, 0xffff
  s_mov_b32 s38, 2621440
  s_mov_b32 s39, 0x20000
  s_mul_i32 s40, s18, 5120
  s_mul_i32 s41, s18, 160
  s_add_u32 s42, s40, 4096
  s_cmp_lg_u32 s16, 0
  s_cbranch_scc1 L_oproj_kernel_nop1_7
  s_mov_b32 s87, 0x40000
  s_waitcnt vmcnt(6)
  s_branch L_oproj_kernel_poll_chk_9
L_oproj_kernel_poll_8:
  s_sleep 1
  buffer_load_dword v120, v101, s[88:91], 0 offen sc1
  buffer_load_dword v121, v100, s[96:99], 0 offen sc1
  s_waitcnt vmcnt(0)
L_oproj_kernel_poll_chk_9:
  v_readfirstlane_b32 s100, v120
  s_nop 3
  v_cmp_eq_u32 vcc, 0, v120
  v_cmp_ne_u32 s[94:95], s100, v121
  s_nop 3
  s_or_b64 vcc, vcc, s[94:95]
  s_nop 4
  s_cbranch_vccz L_oproj_kernel_poll_done_10
  s_sub_u32 s87, s87, 1
  s_cmp_lg_u32 s87, 0
  s_cbranch_scc1 L_oproj_kernel_poll_8
L_oproj_kernel_poll_done_10:
L_oproj_kernel_nop1_7:
  s_barrier
  s_add_u32 s22, s24, 0
  buffer_load_dwordx4 v[44:47], v10, s[8:11], s22 offen offset:0
  buffer_load_dwordx4 v[48:51], v10, s[8:11], s22 offen offset:1024
  buffer_load_dwordx4 v[52:55], v10, s[8:11], s22 offen offset:2048
  buffer_load_dwordx4 v[56:59], v10, s[8:11], s22 offen offset:3072
  s_add_u32 m0, s26, 20480
  s_add_u32 s20, s25, 20480
  buffer_load_dwordx4 v10, s[12:15], s20 offen offset:0 lds
  buffer_load_dwordx4 v10, s[12:15], s20 offen offset:1024 lds
  buffer_load_dwordx4 v10, s[12:15], s20 offen offset:2048 lds
  buffer_load_dwordx4 v10, s[12:15], s20 offen offset:3072 lds
  s_add_u32 m0, s26, 24576
  s_add_u32 s21, s25, 24576
  buffer_load_dwordx4 v10, s[12:15], s21 offen lds
  s_add_u32 s22, s24, 4096
  buffer_load_dwordx4 v[60:63], v10, s[8:11], s22 offen offset:0
  buffer_load_dwordx4 v[64:67], v10, s[8:11], s22 offen offset:1024
  buffer_load_dwordx4 v[68:71], v10, s[8:11], s22 offen offset:2048
  buffer_load_dwordx4 v[72:75], v10, s[8:11], s22 offen offset:3072
  s_waitcnt vmcnt(9) lgkmcnt(0)
  s_barrier
  ds_read_b128 v[92:95], v11 offset:0
  ds_read_b128 v[96:99], v11 offset:1024
  ds_read_b128 v[100:103], v11 offset:2048
  ds_read_b128 v[104:107], v11 offset:3072
  ds_read_b128 v[108:111], v11 offset:4096
  s_waitcnt lgkmcnt(4)
  v_mfma_f32_16x16x32_bf16 v[24:27], v[92:95], v[44:47], 0
  ds_read_b128 v[112:115], v11 offset:5120
  s_add_u32 s22, s24, 8192
  buffer_load_dwordx4 v[76:79], v10, s[8:11], s22 offen offset:0
  s_waitcnt lgkmcnt(4)
  v_mfma_f32_16x16x32_bf16 v[28:31], v[96:99], v[44:47], 0
  ds_read_b128 v[116:119], v11 offset:6144
  buffer_load_dwordx4 v[80:83], v10, s[8:11], s22 offen offset:1024
  s_waitcnt lgkmcnt(4)
  v_mfma_f32_16x16x32_bf16 v[32:35], v[100:103], v[44:47], 0
  ds_read_b128 v[120:123], v11 offset:7168
  buffer_load_dwordx4 v[84:87], v10, s[8:11], s22 offen offset:2048
  s_waitcnt lgkmcnt(4)
  v_mfma_f32_16x16x32_bf16 v[36:39], v[104:107], v[44:47], 0
  ds_read_b128 v[124:127], v11 offset:8192
  s_waitcnt lgkmcnt(4)
  v_mfma_f32_16x16x32_bf16 v[40:43], v[108:111], v[44:47], 0
  ds_read_b128 v[128:131], v11 offset:9216
  s_waitcnt lgkmcnt(4)
  v_mfma_f32_16x16x32_bf16 v[24:27], v[112:115], v[48:51], v[24:27]
  ds_read_b128 v[92:95], v11 offset:10240
  buffer_load_dwordx4 v[88:91], v10, s[8:11], s22 offen offset:3072
  s_waitcnt lgkmcnt(4)
  v_mfma_f32_16x16x32_bf16 v[28:31], v[116:119], v[48:51], v[28:31]
  ds_read_b128 v[96:99], v11 offset:11264
  s_add_u32 m0, s26, 40960
  s_add_u32 s20, s25, 40960
  buffer_load_dwordx4 v10, s[12:15], s20 offen offset:0 lds
  s_waitcnt lgkmcnt(4)
  v_mfma_f32_16x16x32_bf16 v[32:35], v[120:123], v[48:51], v[32:35]
  ds_read_b128 v[100:103], v11 offset:12288
  buffer_load_dwordx4 v10, s[12:15], s20 offen offset:1024 lds
  s_waitcnt lgkmcnt(4)
  v_mfma_f32_16x16x32_bf16 v[36:39], v[124:127], v[48:51], v[36:39]
  ds_read_b128 v[104:107], v11 offset:13312
  s_waitcnt lgkmcnt(4)
  v_mfma_f32_16x16x32_bf16 v[40:43], v[128:131], v[48:51], v[40:43]
  ds_read_b128 v[108:111], v11 offset:14336
  s_waitcnt lgkmcnt(4)
  v_mfma_f32_16x16x32_bf16 v[24:27], v[92:95], v[52:55], v[24:27]
  ds_read_b128 v[112:115], v11 offset:15360
  buffer_load_dwordx4 v10, s[12:15], s20 offen offset:2048 lds
  s_waitcnt lgkmcnt(4)
  v_mfma_f32_16x16x32_bf16 v[28:31], v[96:99], v[52:55], v[28:31]
  ds_read_b128 v[116:119], v11 offset:16384
  buffer_load_dwordx4 v10, s[12:15], s20 offen offset:3072 lds
  s_waitcnt lgkmcnt(4)
  v_mfma_f32_16x16x32_bf16 v[32:35], v[100:103], v[52:55], v[32:35]
  ds_read_b128 v[120:123], v11 offset:17408
  s_add_u32 m0, s26, 45056
  s_add_u32 s21, s25, 45056
  buffer_load_dwordx4 v10, s[12:15], s21 offen lds
  s_waitcnt lgkmcnt(4)
  v_mfma_f32_16x16x32_bf16 v[36:39], v[104:107], v[52:55], v[36:39]
  ds_read_b128 v[124:127], v11 offset:18432
  s_waitcnt lgkmcnt(4)
  v_mfma_f32_16x16x32_bf16 v[40:43], v[108:111], v[52:55], v[40:43]
  ds_read_b128 v[128:131], v11 offset:19456
  s_waitcnt vmcnt(9) lgkmcnt(0)
  s_barrier
  s_waitcnt lgkmcnt(4)
  v_mfma_f32_16x16x32_bf16 v[24:27], v[112:115], v[56:59], v[24:27]
  ds_read_b128 v[92:95], v11 offset:20480
  s_waitcnt lgkmcnt(4)
  v_mfma_f32_16x16x32_bf16 v[28:31], v[116:119], v[56:59], v[28:31]
  ds_read_b128 v[96:99], v11 offset:21504
  s_waitcnt lgkmcnt(4)
  v_mfma_f32_16x16x32_bf16 v[32:35], v[120:123], v[56:59], v[32:35]
  ds_read_b128 v[100:103], v11 offset:22528
  s_waitcnt lgkmcnt(4)
  v_mfma_f32_16x16x32_bf16 v[36:39], v[124:127], v[56:59], v[36:39]
  ds_read_b128 v[104:107], v11 offset:23552
  s_waitcnt lgkmcnt(4)
  v_mfma_f32_16x16x32_bf16 v[40:43], v[128:131], v[56:59], v[40:43]
  ds_read_b128 v[108:111], v11 offset:24576
  s_waitcnt lgkmcnt(4)
  v_mfma_f32_16x16x32_bf16 v[24:27], v[92:95], v[60:63], v[24:27]
  ds_read_b128 v[112:115], v11 offset:25600
  s_waitcnt lgkmcnt(4)
  v_mfma_f32_16x16x32_bf16 v[28:31], v[96:99], v[60:63], v[28:31]
  ds_read_b128 v[116:119], v11 offset:26624
  s_waitcnt lgkmcnt(4)
  v_mfma_f32_16x16x32_bf16 v[32:35], v[100:103], v[60:63], v[32:35]
  ds_read_b128 v[120:123], v11 offset:27648
  s_waitcnt lgkmcnt(4)
  v_mfma_f32_16x16x32_bf16 v[36:39], v[104:107], v[60:63], v[36:39]
  ds_read_b128 v[124:127], v11 offset:28672
  s_waitcnt lgkmcnt(4)
  v_mfma_f32_16x16x32_bf16 v[40:43], v[108:111], v[60:63], v[40:43]
  ds_read_b128 v[128:131], v11 offset:29696
  s_waitcnt lgkmcnt(4)
  v_mfma_f32_16x16x32_bf16 v[24:27], v[112:115], v[64:67], v[24:27]
  ds_read_b128 v[92:95], v11 offset:30720
  s_waitcnt lgkmcnt(4)
  v_mfma_f32_16x16x32_bf16 v[28:31], v[116:119], v[64:67], v[28:31]
  ds_read_b128 v[96:99], v11 offset:31744
  s_waitcnt lgkmcnt(4)
  v_mfma_f32_16x16x32_bf16 v[32:35], v[120:123], v[64:67], v[32:35]
  ds_read_b128 v[100:103], v11 offset:32768
  s_waitcnt lgkmcnt(4)
  v_mfma_f32_16x16x32_bf16 v[36:39], v[124:127], v[64:67], v[36:39]
  ds_read_b128 v[104:107], v11 offset:33792
  s_waitcnt lgkmcnt(4)
  v_mfma_f32_16x16x32_bf16 v[40:43], v[128:131], v[64:67], v[40:43]
  ds_read_b128 v[108:111], v11 offset:34816
  s_waitcnt lgkmcnt(4)
  v_mfma_f32_16x16x32_bf16 v[24:27], v[92:95], v[68:71], v[24:27]
  ds_read_b128 v[112:115], v11 offset:35840
  s_waitcnt lgkmcnt(4)
  v_mfma_f32_16x16x32_bf16 v[28:31], v[96:99], v[68:71], v[28:31]
  ds_read_b128 v[116:119], v11 offset:36864
  s_waitcnt lgkmcnt(4)
  v_mfma_f32_16x16x32_bf16 v[32:35], v[100:103], v[68:71], v[32:35]
  ds_read_b128 v[120:123], v11 offset:37888
  s_waitcnt lgkmcnt(4)
  v_mfma_f32_16x16x32_bf16 v[36:39], v[104:107], v[68:71], v[36:39]
  ds_read_b128 v[124:127], v11 offset:38912
  s_waitcnt lgkmcnt(4)
  v_mfma_f32_16x16x32_bf16 v[40:43], v[108:111], v[68:71], v[40:43]
  ds_read_b128 v[128:131], v11 offset:39936
  buffer_load_dwordx2 v[14:15], v9, s[36:39], s41 offen offset:0
  buffer_load_dwordx2 v[16:17], v9, s[36:39], s41 offen offset:32
  buffer_load_dwordx2 v[18:19], v9, s[36:39], s41 offen offset:64
  buffer_load_dwordx2 v[20:21], v9, s[36:39], s41 offen offset:96
  buffer_load_dwordx2 v[22:23], v9, s[36:39], s41 offen offset:128
  s_waitcnt vmcnt(5) lgkmcnt(0)
  s_barrier
  s_waitcnt lgkmcnt(4)
  v_mfma_f32_16x16x32_bf16 v[24:27], v[112:115], v[72:75], v[24:27]
  ds_read_b128 v[92:95], v12 offset:0
  s_waitcnt lgkmcnt(4)
  v_mfma_f32_16x16x32_bf16 v[28:31], v[116:119], v[72:75], v[28:31]
  ds_read_b128 v[96:99], v12 offset:1024
  s_waitcnt lgkmcnt(4)
  v_mfma_f32_16x16x32_bf16 v[32:35], v[120:123], v[72:75], v[32:35]
  ds_read_b128 v[100:103], v12 offset:2048
  s_waitcnt lgkmcnt(4)
  v_mfma_f32_16x16x32_bf16 v[36:39], v[124:127], v[72:75], v[36:39]
  ds_read_b128 v[104:107], v12 offset:3072
  s_waitcnt lgkmcnt(4)
  v_mfma_f32_16x16x32_bf16 v[40:43], v[128:131], v[72:75], v[40:43]
  ds_read_b128 v[108:111], v12 offset:4096
  s_waitcnt lgkmcnt(4)
  v_mfma_f32_16x16x32_bf16 v[24:27], v[92:95], v[76:79], v[24:27]
  ds_read_b128 v[112:115], v12 offset:5120
  s_waitcnt lgkmcnt(4)
  v_mfma_f32_16x16x32_bf16 v[28:31], v[96:99], v[76:79], v[28:31]
  ds_read_b128 v[116:119], v12 offset:6144
  s_waitcnt lgkmcnt(4)
  v_mfma_f32_16x16x32_bf16 v[32:35], v[100:103], v[76:79], v[32:35]
  ds_read_b128 v[120:123], v12 offset:7168
  s_waitcnt lgkmcnt(4)
  v_mfma_f32_16x16x32_bf16 v[36:39], v[104:107], v[76:79], v[36:39]
  ds_read_b128 v[124:127], v12 offset:8192
  s_waitcnt lgkmcnt(4)
  v_mfma_f32_16x16x32_bf16 v[40:43], v[108:111], v[76:79], v[40:43]
  ds_read_b128 v[128:131], v12 offset:9216
  s_waitcnt lgkmcnt(4)
  v_mfma_f32_16x16x32_bf16 v[24:27], v[112:115], v[80:83], v[24:27]
  ds_read_b128 v[92:95], v12 offset:10240
  s_waitcnt lgkmcnt(4)
  v_mfma_f32_16x16x32_bf16 v[28:31], v[116:119], v[80:83], v[28:31]
  ds_read_b128 v[96:99], v12 offset:11264
  s_waitcnt lgkmcnt(4)
  v_mfma_f32_16x16x32_bf16 v[32:35], v[120:123], v[80:83], v[32:35]
  ds_read_b128 v[100:103], v12 offset:12288
  s_waitcnt lgkmcnt(4)
  v_mfma_f32_16x16x32_bf16 v[36:39], v[124:127], v[80:83], v[36:39]
  ds_read_b128 v[104:107], v12 offset:13312
  s_waitcnt lgkmcnt(4)
  v_mfma_f32_16x16x32_bf16 v[40:43], v[128:131], v[80:83], v[40:43]
  ds_read_b128 v[108:111], v12 offset:14336
  s_waitcnt lgkmcnt(4)
  v_mfma_f32_16x16x32_bf16 v[24:27], v[92:95], v[84:87], v[24:27]
  ds_read_b128 v[112:115], v12 offset:15360
  s_waitcnt lgkmcnt(4)
  v_mfma_f32_16x16x32_bf16 v[28:31], v[96:99], v[84:87], v[28:31]
  ds_read_b128 v[116:119], v12 offset:16384
  s_waitcnt lgkmcnt(4)
  v_mfma_f32_16x16x32_bf16 v[32:35], v[100:103], v[84:87], v[32:35]
  ds_read_b128 v[120:123], v12 offset:17408
  s_waitcnt lgkmcnt(4)
  v_mfma_f32_16x16x32_bf16 v[36:39], v[104:107], v[84:87], v[36:39]
  ds_read_b128 v[124:127], v12 offset:18432
  s_waitcnt lgkmcnt(4)
  v_mfma_f32_16x16x32_bf16 v[40:43], v[108:111], v[84:87], v[40:43]
  ds_read_b128 v[128:131], v12 offset:19456
  s_waitcnt lgkmcnt(4)
  v_mfma_f32_16x16x32_bf16 v[24:27], v[112:115], v[88:91], v[24:27]
  s_waitcnt lgkmcnt(3)
  v_mfma_f32_16x16x32_bf16 v[28:31], v[116:119], v[88:91], v[28:31]
  s_waitcnt lgkmcnt(2)
  v_mfma_f32_16x16x32_bf16 v[32:35], v[120:123], v[88:91], v[32:35]
  s_waitcnt lgkmcnt(1)
  v_mfma_f32_16x16x32_bf16 v[36:39], v[124:127], v[88:91], v[36:39]
  s_waitcnt lgkmcnt(0)
  v_mfma_f32_16x16x32_bf16 v[40:43], v[128:131], v[88:91], v[40:43]
  s_nop 7
  s_barrier
  s_mul_i32 s20, s19, 5120
  v_add_u32 v3, s20, v10
  s_cmp_eq_u32 s27, 0
  s_cbranch_scc1 L_oproj_kernel_wr_11
  ds_write_b128 v3, v[24:27] offset:0
  ds_write_b128 v3, v[28:31] offset:1024
  ds_write_b128 v3, v[32:35] offset:2048
  ds_write_b128 v3, v[36:39] offset:3072
  ds_write_b128 v3, v[40:43] offset:4096
  s_waitcnt lgkmcnt(0)
  s_barrier
  s_branch L_oproj_kernel_end_12
L_oproj_kernel_wr_11:
  s_barrier
  ds_read_b128 v[132:135], v3 offset:0
  ds_read_b128 v[136:139], v3 offset:1024
  ds_read_b128 v[140:143], v3 offset:2048
  ds_read_b128 v[144:147], v3 offset:3072
  ds_read_b128 v[148:151], v3 offset:4096
  s_waitcnt lgkmcnt(0)
  v_add_f32 v132, v132, v24
  v_add_f32 v133, v133, v25
  v_add_f32 v134, v134, v26
  v_add_f32 v135, v135, v27
  v_add_f32 v136, v136, v28
  v_add_f32 v137, v137, v29
  v_add_f32 v138, v138, v30
  v_add_f32 v139, v139, v31
  v_add_f32 v140, v140, v32
  v_add_f32 v141, v141, v33
  v_add_f32 v142, v142, v34
  v_add_f32 v143, v143, v35
  v_add_f32 v144, v144, v36
  v_add_f32 v145, v145, v37
  v_add_f32 v146, v146, v38
  v_add_f32 v147, v147, v39
  v_add_f32 v148, v148, v40
  v_add_f32 v149, v149, v41
  v_add_f32 v150, v150, v42
  v_add_f32 v151, v151, v43
  s_waitcnt vmcnt(0)
  v_lshlrev_b32 v152, 16, v14
  v_and_b32 v153, 0xffff0000, v14
  v_add_f32 v132, v132, v152
  v_add_f32 v133, v133, v153
  v_cvt_pk_bf16_f32 v14, v132, v133
  v_lshlrev_b32 v152, 16, v15
  v_and_b32 v153, 0xffff0000, v15
  v_add_f32 v134, v134, v152
  v_add_f32 v135, v135, v153
  v_cvt_pk_bf16_f32 v15, v134, v135
  v_lshlrev_b32 v152, 16, v16
  v_and_b32 v153, 0xffff0000, v16
  v_add_f32 v136, v136, v152
  v_add_f32 v137, v137, v153
  v_cvt_pk_bf16_f32 v16, v136, v137
  v_lshlrev_b32 v152, 16, v17
  v_and_b32 v153, 0xffff0000, v17
  v_add_f32 v138, v138, v152
  v_add_f32 v139, v139, v153
  v_cvt_pk_bf16_f32 v17, v138, v139
  v_lshlrev_b32 v152, 16, v18
  v_and_b32 v153, 0xffff0000, v18
  v_add_f32 v140, v140, v152
  v_add_f32 v141, v141, v153
  v_cvt_pk_bf16_f32 v18, v140, v141
  v_lshlrev_b32 v152, 16, v19
  v_and_b32 v153, 0xffff0000, v19
  v_add_f32 v142, v142, v152
  v_add_f32 v143, v143, v153
  v_cvt_pk_bf16_f32 v19, v142, v143
  v_lshlrev_b32 v152, 16, v20
  v_and_b32 v153, 0xffff0000, v20
  v_add_f32 v144, v144, v152
  v_add_f32 v145, v145, v153
  v_cvt_pk_bf16_f32 v20, v144, v145
  v_lshlrev_b32 v152, 16, v21
  v_and_b32 v153, 0xffff0000, v21
  v_add_f32 v146, v146, v152
  v_add_f32 v147, v147, v153
  v_cvt_pk_bf16_f32 v21, v146, v147
  v_lshlrev_b32 v152, 16, v22
  v_and_b32 v153, 0xffff0000, v22
  v_add_f32 v148, v148, v152
  v_add_f32 v149, v149, v153
  v_cvt_pk_bf16_f32 v22, v148, v149
  v_lshlrev_b32 v152, 16, v23
  v_and_b32 v153, 0xffff0000, v23
  v_add_f32 v150, v150, v152
  v_add_f32 v151, v151, v153
  v_cvt_pk_bf16_f32 v23, v150, v151
  v_mov_b32 v92, v14
  v_mov_b32 v93, v15
  v_mov_b32 v94, v16
  v_mov_b32 v95, v17
  v_mov_b32 v96, v18
  v_mov_b32 v97, v19
  v_mov_b32 v98, v20
  v_mov_b32 v99, v21
  v_mov_b32 v100, v22
  v_mov_b32 v101, v23
  v_mov_b32 v102, v22
  v_mov_b32 v103, v23
  s_nop 1
  v_permlane16_swap_b32 v92, v94
  v_permlane16_swap_b32 v93, v95
  v_permlane16_swap_b32 v96, v98
  v_permlane16_swap_b32 v97, v99
  v_permlane16_swap_b32 v100, v102
  v_permlane16_swap_b32 v101, v103
  v_lshrrev_b32 v2, 5, v6
  v_mul_u32_u24 v8, 40960, v2
  v_and_b32 v2, 31, v6
  v_lshl_add_u32 v8, v2, 4, v8
  v_and_b32 v2, 1, v7
  v_lshl_add_u32 v8, v2, 10, v8
  v_lshrrev_b32 v2, 1, v7
  v_lshl_add_u32 v8, v2, 9, v8
  buffer_store_dwordx4 v[92:95], v8, s[32:35], s40 offen sc1
  buffer_store_dwordx4 v[96:99], v8, s[32:35], s40 offen offset:2048 sc1
  s_mov_b32 exec_lo, 0x0000ffff
  s_mov_b32 exec_hi, 0x0000ffff
  buffer_store_dwordx4 v[100:103], v8, s[32:35], s42 offen sc1
  s_mov_b64 exec, -1
  v_mov_b32 v46, 0
  v_mov_b32 v47, 0
  v_lshlrev_b32 v44, 16, v14
  v_and_b32 v45, 0xffff0000, v14
  v_add_f32 v46, v46, v44
  v_fmac_f32 v47, v44, v44
  v_add_f32 v46, v46, v45
  v_fmac_f32 v47, v45, v45
  v_lshlrev_b32 v44, 16, v15
  v_and_b32 v45, 0xffff0000, v15
  v_add_f32 v46, v46, v44
  v_fmac_f32 v47, v44, v44
  v_add_f32 v46, v46, v45
  v_fmac_f32 v47, v45, v45
  v_lshlrev_b32 v44, 16, v16
  v_and_b32 v45, 0xffff0000, v16
  v_add_f32 v46, v46, v44
  v_fmac_f32 v47, v44, v44
  v_add_f32 v46, v46, v45
  v_fmac_f32 v47, v45, v45
  v_lshlrev_b32 v44, 16, v17
  v_and_b32 v45, 0xffff0000, v17
  v_add_f32 v46, v46, v44
  v_fmac_f32 v47, v44, v44
  v_add_f32 v46, v46, v45
  v_fmac_f32 v47, v45, v45
  v_lshlrev_b32 v44, 16, v18
  v_and_b32 v45, 0xffff0000, v18
  v_add_f32 v46, v46, v44
  v_fmac_f32 v47, v44, v44
  v_add_f32 v46, v46, v45
  v_fmac_f32 v47, v45, v45
  v_lshlrev_b32 v44, 16, v19
  v_and_b32 v45, 0xffff0000, v19
  v_add_f32 v46, v46, v44
  v_fmac_f32 v47, v44, v44
  v_add_f32 v46, v46, v45
  v_fmac_f32 v47, v45, v45
  v_lshlrev_b32 v44, 16, v20
  v_and_b32 v45, 0xffff0000, v20
  v_add_f32 v46, v46, v44
  v_fmac_f32 v47, v44, v44
  v_add_f32 v46, v46, v45
  v_fmac_f32 v47, v45, v45
  v_lshlrev_b32 v44, 16, v21
  v_and_b32 v45, 0xffff0000, v21
  v_add_f32 v46, v46, v44
  v_fmac_f32 v47, v44, v44
  v_add_f32 v46, v46, v45
  v_fmac_f32 v47, v45, v45
  v_lshlrev_b32 v44, 16, v22
  v_and_b32 v45, 0xffff0000, v22
  v_add_f32 v46, v46, v44
  v_fmac_f32 v47, v44, v44
  v_add_f32 v46, v46, v45
  v_fmac_f32 v47, v45, v45
  v_lshlrev_b32 v44, 16, v23
  v_and_b32 v45, 0xffff0000, v23
  v_add_f32 v46, v46, v44
  v_fmac_f32 v47, v44, v44
  v_add_f32 v46, v46, v45
  v_fmac_f32 v47, v45, v45
  v_mov_b32 v48, v46
  v_mov_b32 v49, v46
  v_mov_b32 v50, v47
  v_mov_b32 v51, v47
  s_nop 1
  v_permlane16_swap_b32 v48, v49
  v_permlane16_swap_b32 v50, v51
  s_nop 0
  v_add_f32 v46, v48, v49
  v_add_f32 v47, v50, v51
  v_mov_b32 v48, v46
  v_mov_b32 v49, v46
  v_mov_b32 v50, v47
  v_mov_b32 v51, v47
  s_nop 1
  v_permlane32_swap_b32 v48, v49
  v_permlane32_swap_b32 v50, v51
  s_nop 0
  v_add_f32 v46, v48, v49
  v_add_f32 v47, v50, v51
  s_add_u32 s44, s4, 13631488
  s_addc_u32 s45, s5, 0
  s_and_b32 s45, s45, 0xffff
  s_mov_b32 s46, 131072
  s_mov_b32 s47, 0x20000
  v_lshlrev_b32 v2, 3, v6
  s_lshl_b32 s20, s18, 14
  s_mov_b64 exec, 0xffff
  buffer_store_dwordx2 v[46:47], v2, s[44:47], s20 offen sc1
  s_mov_b64 exec, -1
L_oproj_kernel_end_12:
  s_waitcnt vmcnt(0)
  s_barrier
  s_cmp_lg_u32 s16, 0
  s_cbranch_scc1 L_oproj_kernel_nosig_13
  s_lshr_b32 s87, s17, 2
  s_lshl_b32 s87, s87, 5
  s_and_b32 s86, s17, 3
  s_lshl_b32 s86, s86, 3
  s_add_u32 s87, s87, s86
  s_add_u32 s87, s87, s18
  s_lshl_b32 s87, s87, 2
  s_add_u32 s87, s87, 2048
  s_mov_b64 exec, 1
  v_mov_b32 v4, 0
  v_mov_b32 v5, s100
  buffer_store_dword v5, v4, s[96:99], s87 offen sc1
  s_mov_b64 exec, -1
L_oproj_kernel_nosig_13:
L_oproj_kernel_done_1:
  s_endpgm
oproj_kernel_end:

.p2align 8
ffn_kernel:
  s_load_dwordx2 s[4:5], s[0:1], 72
  s_load_dwordx4 s[28:31], s[0:1], 32
  s_load_dwordx4 s[92:95], s[0:1], 64
  s_and_b32 s20, s2, 7
  s_lshr_b32 s21, s2, 3
  s_cmp_ge_u32 s21, 27
  s_cbranch_scc1 L_ffn_kernel_idle_2
  s_and_b32 s22, s20, 3
  s_mul_i32 s22, s22, 27
  s_add_u32 s22, s22, s21
  s_lshr_b32 s18, s22, 2
  s_and_b32 s22, s22, 3
  s_lshr_b32 s23, s20, 2
  s_lshl_b32 s23, s23, 2
  s_add_u32 s17, s23, s22
  v_and_b32 v1, 63, v0
  v_lshrrev_b32 v2, 6, v0
  s_nop 0
  v_readfirstlane_b32 s16, v2
  v_lshrrev_b32 v2, 3, v1
  s_lshl_b32 s20, s16, 3
  v_add_u32 v2, s20, v2
  v_mul_u32_u24 v2, 3456, v2
  v_bfe_u32 v3, v1, 2, 1
  v_bfe_u32 v4, v1, 4, 1
  v_xor_b32 v3, v3, v4
  v_and_b32 v4, 3, v1
  v_lshl_add_u32 v3, v3, 2, v4
  v_lshl_add_u32 v10, v3, 4, v2
  v_lshlrev_b32 v11, 4, v1
  s_lshl_b32 s20, s17, 3
  s_add_u32 s20, s20, s16
  s_mul_i32 s24, s20, 40960
  s_lshl_b32 s25, s18, 7
  s_lshl_b32 s26, s16, 10
  s_waitcnt lgkmcnt(0)
  s_add_u32 s8, s4, 11010048
  s_addc_u32 s9, s5, 0
  s_and_b32 s9, s9, 0xffff
  s_mov_b32 s10, 2621440
  s_mov_b32 s11, 0x20000
  s_mov_b32 s12, s28
  s_and_b32 s13, s29, 0xffff
  s_mov_b32 s14, 2211840
  s_mov_b32 s15, 0x20000
  s_mov_b32 s32, s30
  s_and_b32 s33, s31, 0xffff
  s_mov_b32 s34, 2211840
  s_mov_b32 s35, 0x20000
  s_mov_b32 s88, s92
  s_and_b32 s89, s93, 0xffff
  s_mov_b32 s90, 256
  s_mov_b32 s91, 0x20000
  s_add_u32 s96, s94, 24049664
  s_addc_u32 s97, s95, 0
  s_and_b32 s97, s97, 0xffff
  s_mov_b32 s98, 12288
  s_mov_b32 s99, 0x20000
  s_lshl_b32 s86, s17, 5
  v_and_b32 v184, 31, v1
  v_add_u32 v184, s86, v184
  v_lshlrev_b32 v184, 2, v184
  v_add_u32 v184, 2048, v184
  v_and_b32 v185, 15, v1
  v_add_u32 v185, 240, v185
  v_lshlrev_b32 v185, 2, v185
  v_add_u32 v185, 0, v185
  v_mov_b32 v186, 0
  s_cmp_lg_u32 s16, 0
  s_cbranch_scc1 L_ffn_kernel_nop0_3
  buffer_load_dword v188, v186, s[88:91], 0 offen sc1
  buffer_load_dword v189, v184, s[96:99], 0 offen sc1
  buffer_load_dword v190, v185, s[96:99], 0 offen sc1
L_ffn_kernel_nop0_3:
  s_add_u32 m0, s26, 0
  s_add_u32 s20, s25, 0
  buffer_load_dwordx4 v10, s[12:15], s20 offen lds
  s_add_u32 m0, s26, 8192
  s_nop 0
  buffer_load_dwordx4 v10, s[32:35], s20 offen lds
  s_add_u32 m0, s26, 16384
  s_add_u32 s20, s25, 221184
  buffer_load_dwordx4 v10, s[12:15], s20 offen lds
  s_add_u32 m0, s26, 24576
  s_nop 0
  buffer_load_dwordx4 v10, s[32:35], s20 offen lds
  s_add_u32 m0, s26, 32768
  s_add_u32 s20, s25, 442368
  buffer_load_dwordx4 v10, s[12:15], s20 offen lds
  s_add_u32 m0, s26, 40960
  s_nop 0
  buffer_load_dwordx4 v10, s[32:35], s20 offen lds
  s_getpc_b64 s[56:57]
L_ffn_kernel_here_4:
  s_lshr_b32 s62, s2, 3
  s_and_b32 s62, s62, 31
  s_lshl_b32 s62, s62, 10
  v_lshrrev_b32 v182, 6, v0
  v_lshlrev_b32 v182, 7, v182
  v_add_u32 v182, s62, v182
  s_mov_b64 s[58:59], exec
  s_mov_b64 exec, 1
  s_sub_u32 s60, s56, 0x100000
  s_subb_u32 s61, s57, 0
  v_min_u32 v181, down_kernel_end - down_kernel - 4, v182
  v_add_u32 v181, down_kernel - L_ffn_kernel_here_4 + 0x100000, v181
  global_load_dword v180, v181, s[60:61]
  s_mov_b64 exec, s[58:59]
  v_lshrrev_b32 v6, 5, v1
  v_bfe_u32 v2, v1, 2, 2
  v_lshl_add_u32 v2, v6, 3, v2
  v_lshlrev_b32 v2, 7, v2
  v_bfe_u32 v3, v1, 3, 1
  v_lshl_add_u32 v2, v3, 6, v2
  v_bfe_u32 v3, v1, 4, 1
  v_lshl_add_u32 v2, v3, 5, v2
  v_and_b32 v3, 3, v1
  v_lshl_add_u32 v12, v3, 3, v2
  v_xor_b32 v13, 64, v12
  v_add_u32 v14, 65536, v12
  v_add_u32 v15, 65536, v13
  v_add_u32 v16, 131072, v12
  v_add_u32 v17, 131072, v13
  s_cmp_lg_u32 s16, 0
  s_cbranch_scc1 L_ffn_kernel_nop1_5
  s_mov_b32 s87, 0x40000
  s_waitcnt vmcnt(7)
  s_branch L_ffn_kernel_poll_chk_7
L_ffn_kernel_poll_6:
  s_sleep 1
  buffer_load_dword v188, v186, s[88:91], 0 offen sc1
  buffer_load_dword v189, v184, s[96:99], 0 offen sc1
  buffer_load_dword v190, v185, s[96:99], 0 offen sc1
  s_waitcnt vmcnt(0)
L_ffn_kernel_poll_chk_7:
  v_readfirstlane_b32 s100, v188
  s_nop 3
  v_cmp_eq_u32 vcc, 0, v188
  v_cmp_ne_u32 s[94:95], s100, v189
  s_nop 3
  s_or_b64 vcc, vcc, s[94:95]
  v_cmp_ne_u32 s[94:95], s100, v190
  s_nop 3
  s_or_b64 vcc, vcc, s[94:95]
  s_nop 4
  s_cbranch_vccz L_ffn_kernel_poll_done_8
  s_sub_u32 s87, s87, 1
  s_cmp_lg_u32 s87, 0
  s_cbranch_scc1 L_ffn_kernel_poll_6
L_ffn_kernel_poll_done_8:
L_ffn_kernel_nop1_5:
  s_barrier
  s_add_u32 s21, s24, 0
  buffer_load_dwordx4 v[84:87], v11, s[8:11], s21 offen offset:0
  buffer_load_dwordx4 v[88:91], v11, s[8:11], s21 offen offset:1024
  buffer_load_dwordx4 v[92:95], v11, s[8:11], s21 offen offset:2048
  buffer_load_dwordx4 v[96:99], v11, s[8:11], s21 offen offset:3072
  s_add_u32 s21, s24, 4096
  buffer_load_dwordx4 v[100:103], v11, s[8:11], s21 offen offset:0
  buffer_load_dwordx4 v[104:107], v11, s[8:11], s21 offen offset:1024
  buffer_load_dwordx4 v[108:111], v11, s[8:11], s21 offen offset:2048
  buffer_load_dwordx4 v[112:115], v11, s[8:11], s21 offen offset:3072
  s_waitcnt vmcnt(4)
  s_barrier
  ds_read_b64_tr_b16 v[148:149], v12 offset:0
  ds_read_b64_tr_b16 v[150:151], v12 offset:512
  ds_read_b64_tr_b16 v[152:153], v13 offset:0
  ds_read_b64_tr_b16 v[154:155], v13 offset:512
  ds_read_b64_tr_b16 v[156:157], v12 offset:8192
  ds_read_b64_tr_b16 v[158:159], v12 offset:8704
  ds_read_b64_tr_b16 v[160:161], v13 offset:8192
  ds_read_b64_tr_b16 v[162:163], v13 offset:8704
  s_waitcnt lgkmcnt(6)
  v_mfma_f32_32x32x16_bf16 v[20:35], v[148:151], v[84:87], 0
  ds_read_b64_tr_b16 v[164:165], v12 offset:2048
  ds_read_b64_tr_b16 v[166:167], v12 offset:2560
  s_add_u32 m0, s26, 49152
  s_add_u32 s20, s25, 663552
  buffer_load_dwordx4 v10, s[12:15], s20 offen lds
  s_waitcnt lgkmcnt(6)
  v_mfma_f32_32x32x16_bf16 v[36:51], v[152:155], v[84:87], 0
  ds_read_b64_tr_b16 v[168:169], v13 offset:2048
  ds_read_b64_tr_b16 v[170:171], v13 offset:2560
  s_add_u32 m0, s26, 57344
  s_nop 0
  buffer_load_dwordx4 v10, s[32:35], s20 offen lds
  s_waitcnt lgkmcnt(6)
  v_mfma_f32_32x32x16_bf16 v[52:67], v[156:159], v[84:87], 0
  ds_read_b64_tr_b16 v[172:173], v12 offset:10240
  ds_read_b64_tr_b16 v[174:175], v12 offset:10752
  s_add_u32 m0, s26, 65536
  s_add_u32 s20, s25, 884736
  buffer_load_dwordx4 v10, s[12:15], s20 offen lds
  s_waitcnt lgkmcnt(6)
  v_mfma_f32_32x32x16_bf16 v[68:83], v[160:163], v[84:87], 0
  ds_read_b64_tr_b16 v[176:177], v13 offset:10240
  ds_read_b64_tr_b16 v[178:179], v13 offset:10752
  s_waitcnt lgkmcnt(6)
  v_mfma_f32_32x32x16_bf16 v[20:35], v[164:167], v[88:91], v[20:35]
  ds_read_b64_tr_b16 v[148:149], v12 offset:4096
  ds_read_b64_tr_b16 v[150:151], v12 offset:4608
  s_add_u32 m0, s26, 73728
  s_nop 0
  buffer_load_dwordx4 v10, s[32:35], s20 offen lds
  s_waitcnt lgkmcnt(6)
  v_mfma_f32_32x32x16_bf16 v[36:51], v[168:171], v[88:91], v[36:51]
  ds_read_b64_tr_b16 v[152:153], v13 offset:4096
  ds_read_b64_tr_b16 v[154:155], v13 offset:4608
  s_add_u32 s21, s24, 8192
  buffer_load_dwordx4 v[116:119], v11, s[8:11], s21 offen offset:0
  s_waitcnt lgkmcnt(6)
  v_mfma_f32_32x32x16_bf16 v[52:67], v[172:175], v[88:91], v[52:67]
  ds_read_b64_tr_b16 v[156:157], v12 offset:12288
  ds_read_b64_tr_b16 v[158:159], v12 offset:12800
  buffer_load_dwordx4 v[120:123], v11, s[8:11], s21 offen offset:1024
  s_waitcnt lgkmcnt(6)
  v_mfma_f32_32x32x16_bf16 v[68:83], v[176:179], v[88:91], v[68:83]
  ds_read_b64_tr_b16 v[160:161], v13 offset:12288
  ds_read_b64_tr_b16 v[162:163], v13 offset:12800
  s_waitcnt lgkmcnt(6)
  v_mfma_f32_32x32x16_bf16 v[20:35], v[148:151], v[92:95], v[20:35]
  ds_read_b64_tr_b16 v[164:165], v12 offset:6144
  ds_read_b64_tr_b16 v[166:167], v12 offset:6656
  buffer_load_dwordx4 v[124:127], v11, s[8:11], s21 offen offset:2048
  s_waitcnt lgkmcnt(6)
  v_mfma_f32_32x32x16_bf16 v[36:51], v[152:155], v[92:95], v[36:51]
  ds_read_b64_tr_b16 v[168:169], v13 offset:6144
  ds_read_b64_tr_b16 v[170:171], v13 offset:6656
  buffer_load_dwordx4 v[128:131], v11, s[8:11], s21 offen offset:3072
  s_waitcnt lgkmcnt(6)
  v_mfma_f32_32x32x16_bf16 v[52:67], v[156:159], v[92:95], v[52:67]
  ds_read_b64_tr_b16 v[172:173], v12 offset:14336
  ds_read_b64_tr_b16 v[174:175], v12 offset:14848
  s_add_u32 s21, s24, 12288
  buffer_load_dwordx4 v[132:135], v11, s[8:11], s21 offen offset:0
  s_waitcnt lgkmcnt(6)
  v_mfma_f32_32x32x16_bf16 v[68:83], v[160:163], v[92:95], v[68:83]
  ds_read_b64_tr_b16 v[176:177], v13 offset:14336
  ds_read_b64_tr_b16 v[178:179], v13 offset:14848
  s_waitcnt vmcnt(9)
  s_barrier
  s_waitcnt lgkmcnt(6)
  v_mfma_f32_32x32x16_bf16 v[20:35], v[164:167], v[96:99], v[20:35]
  ds_read_b64_tr_b16 v[148:149], v12 offset:16384
  ds_read_b64_tr_b16 v[150:151], v12 offset:16896
  buffer_load_dwordx4 v[136:139], v11, s[8:11], s21 offen offset:1024
  s_waitcnt lgkmcnt(6)
  v_mfma_f32_32x32x16_bf16 v[36:51], v[168:171], v[96:99], v[36:51]
  ds_read_b64_tr_b16 v[152:153], v13 offset:16384
  ds_read_b64_tr_b16 v[154:155], v13 offset:16896
  buffer_load_dwordx4 v[140:143], v11, s[8:11], s21 offen offset:2048
  s_waitcnt lgkmcnt(6)
  v_mfma_f32_32x32x16_bf16 v[52:67], v[172:175], v[96:99], v[52:67]
  ds_read_b64_tr_b16 v[156:157], v12 offset:24576
  ds_read_b64_tr_b16 v[158:159], v12 offset:25088
  buffer_load_dwordx4 v[144:147], v11, s[8:11], s21 offen offset:3072
  s_waitcnt lgkmcnt(6)
  v_mfma_f32_32x32x16_bf16 v[68:83], v[176:179], v[96:99], v[68:83]
  ds_read_b64_tr_b16 v[160:161], v13 offset:24576
  ds_read_b64_tr_b16 v[162:163], v13 offset:25088
  s_waitcnt lgkmcnt(6)
  v_mfma_f32_32x32x16_bf16 v[20:35], v[148:151], v[100:103], v[20:35]
  ds_read_b64_tr_b16 v[164:165], v12 offset:18432
  ds_read_b64_tr_b16 v[166:167], v12 offset:18944
  s_add_u32 m0, s26, 81920
  s_add_u32 s20, s25, 1105920
  buffer_load_dwordx4 v10, s[12:15], s20 offen lds
  s_waitcnt lgkmcnt(6)
  v_mfma_f32_32x32x16_bf16 v[36:51], v[152:155], v[100:103], v[36:51]
  ds_read_b64_tr_b16 v[168:169], v13 offset:18432
  ds_read_b64_tr_b16 v[170:171], v13 offset:18944
  s_add_u32 m0, s26, 90112
  s_nop 0
  buffer_load_dwordx4 v10, s[32:35], s20 offen lds
  s_waitcnt lgkmcnt(6)
  v_mfma_f32_32x32x16_bf16 v[52:67], v[156:159], v[100:103], v[52:67]
  ds_read_b64_tr_b16 v[172:173], v12 offset:26624
  ds_read_b64_tr_b16 v[174:175], v12 offset:27136
  s_waitcnt lgkmcnt(6)
  v_mfma_f32_32x32x16_bf16 v[68:83], v[160:163], v[100:103], v[68:83]
  ds_read_b64_tr_b16 v[176:177], v13 offset:26624
  ds_read_b64_tr_b16 v[178:179], v13 offset:27136
  s_waitcnt lgkmcnt(6)
  v_mfma_f32_32x32x16_bf16 v[20:35], v[164:167], v[104:107], v[20:35]
  ds_read_b64_tr_b16 v[148:149], v12 offset:20480
  ds_read_b64_tr_b16 v[150:151], v12 offset:20992
  s_add_u32 m0, s26, 98304
  s_add_u32 s20, s25, 1327104
  buffer_load_dwordx4 v10, s[12:15], s20 offen lds
  s_waitcnt lgkmcnt(6)
  v_mfma_f32_32x32x16_bf16 v[36:51], v[168:171], v[104:107], v[36:51]
  ds_read_b64_tr_b16 v[152:153], v13 offset:20480
  ds_read_b64_tr_b16 v[154:155], v13 offset:20992
  s_add_u32 m0, s26, 106496
  s_nop 0
  buffer_load_dwordx4 v10, s[32:35], s20 offen lds
  s_waitcnt lgkmcnt(6)
  v_mfma_f32_32x32x16_bf16 v[52:67], v[172:175], v[104:107], v[52:67]
  ds_read_b64_tr_b16 v[156:157], v12 offset:28672
  ds_read_b64_tr_b16 v[158:159], v12 offset:29184
  s_waitcnt lgkmcnt(6)
  v_mfma_f32_32x32x16_bf16 v[68:83], v[176:179], v[104:107], v[68:83]
  ds_read_b64_tr_b16 v[160:161], v13 offset:28672
  ds_read_b64_tr_b16 v[162:163], v13 offset:29184
  s_waitcnt lgkmcnt(6)
  v_mfma_f32_32x32x16_bf16 v[20:35], v[148:151], v[108:111], v[20:35]
  ds_read_b64_tr_b16 v[164:165], v12 offset:22528
  ds_read_b64_tr_b16 v[166:167], v12 offset:23040
  s_add_u32 s21, s24, 16384
  buffer_load_dwordx4 v[84:87], v11, s[8:11], s21 offen offset:0
  s_waitcnt lgkmcnt(6)
  v_mfma_f32_32x32x16_bf16 v[36:51], v[152:155], v[108:111], v[36:51]
  ds_read_b64_tr_b16 v[168:169], v13 offset:22528
  ds_read_b64_tr_b16 v[170:171], v13 offset:23040
  buffer_load_dwordx4 v[88:91], v11, s[8:11], s21 offen offset:1024
  s_waitcnt lgkmcnt(6)
  v_mfma_f32_32x32x16_bf16 v[52:67], v[156:159], v[108:111], v[52:67]
  ds_read_b64_tr_b16 v[172:173], v12 offset:30720
  ds_read_b64_tr_b16 v[174:175], v12 offset:31232
  s_waitcnt lgkmcnt(6)
  v_mfma_f32_32x32x16_bf16 v[68:83], v[160:163], v[108:111], v[68:83]
  ds_read_b64_tr_b16 v[176:177], v13 offset:30720
  ds_read_b64_tr_b16 v[178:179], v13 offset:31232
  s_waitcnt vmcnt(10)
  s_barrier
  s_waitcnt lgkmcnt(6)
  v_mfma_f32_32x32x16_bf16 v[20:35], v[164:167], v[112:115], v[20:35]
  ds_read_b64_tr_b16 v[148:149], v12 offset:32768
  ds_read_b64_tr_b16 v[150:151], v12 offset:33280
  buffer_load_dwordx4 v[92:95], v11, s[8:11], s21 offen offset:2048
  s_waitcnt lgkmcnt(6)
  v_mfma_f32_32x32x16_bf16 v[36:51], v[168:171], v[112:115], v[36:51]
  ds_read_b64_tr_b16 v[152:153], v13 offset:32768
  ds_read_b64_tr_b16 v[154:155], v13 offset:33280
  buffer_load_dwordx4 v[96:99], v11, s[8:11], s21 offen offset:3072
  s_waitcnt lgkmcnt(6)
  v_mfma_f32_32x32x16_bf16 v[52:67], v[172:175], v[112:115], v[52:67]
  ds_read_b64_tr_b16 v[156:157], v12 offset:40960
  ds_read_b64_tr_b16 v[158:159], v12 offset:41472
  s_waitcnt lgkmcnt(6)
  v_mfma_f32_32x32x16_bf16 v[68:83], v[176:179], v[112:115], v[68:83]
  ds_read_b64_tr_b16 v[160:161], v13 offset:40960
  ds_read_b64_tr_b16 v[162:163], v13 offset:41472
  s_waitcnt lgkmcnt(6)
  v_mfma_f32_32x32x16_bf16 v[20:35], v[148:151], v[116:119], v[20:35]
  ds_read_b64_tr_b16 v[164:165], v12 offset:34816
  ds_read_b64_tr_b16 v[166:167], v12 offset:35328
  s_add_u32 m0, s26, 114688
  s_add_u32 s20, s25, 1548288
  buffer_load_dwordx4 v10, s[12:15], s20 offen lds
  s_waitcnt lgkmcnt(6)
  v_mfma_f32_32x32x16_bf16 v[36:51], v[152:155], v[116:119], v[36:51]
  ds_read_b64_tr_b16 v[168:169], v13 offset:34816
  ds_read_b64_tr_b16 v[170:171], v13 offset:35328
  s_add_u32 m0, s26, 122880
  s_nop 0
  buffer_load_dwordx4 v10, s[32:35], s20 offen lds
  s_waitcnt lgkmcnt(6)
  v_mfma_f32_32x32x16_bf16 v[52:67], v[156:159], v[116:119], v[52:67]
  ds_read_b64_tr_b16 v[172:173], v12 offset:43008
  ds_read_b64_tr_b16 v[174:175], v12 offset:43520
  s_waitcnt lgkmcnt(6)
  v_mfma_f32_32x32x16_bf16 v[68:83], v[160:163], v[116:119], v[68:83]
  ds_read_b64_tr_b16 v[176:177], v13 offset:43008
  ds_read_b64_tr_b16 v[178:179], v13 offset:43520
  s_waitcnt lgkmcnt(6)
  v_mfma_f32_32x32x16_bf16 v[20:35], v[164:167], v[120:123], v[20:35]
  ds_read_b64_tr_b16 v[148:149], v12 offset:36864
  ds_read_b64_tr_b16 v[150:151], v12 offset:37376
  s_add_u32 m0, s26, 131072
  s_add_u32 s20, s25, 1769472
  buffer_load_dwordx4 v10, s[12:15], s20 offen lds
  s_waitcnt lgkmcnt(6)
  v_mfma_f32_32x32x16_bf16 v[36:51], v[168:171], v[120:123], v[36:51]
  ds_read_b64_tr_b16 v[152:153], v13 offset:36864
  ds_read_b64_tr_b16 v[154:155], v13 offset:37376
  s_add_u32 m0, s26, 139264
  s_nop 0
  buffer_load_dwordx4 v10, s[32:35], s20 offen lds
  s_waitcnt lgkmcnt(6)
  v_mfma_f32_32x32x16_bf16 v[52:67], v[172:175], v[120:123], v[52:67]
  ds_read_b64_tr_b16 v[156:157], v12 offset:45056
  ds_read_b64_tr_b16 v[158:159], v12 offset:45568
  s_waitcnt lgkmcnt(6)
  v_mfma_f32_32x32x16_bf16 v[68:83], v[176:179], v[120:123], v[68:83]
  ds_read_b64_tr_b16 v[160:161], v13 offset:45056
  ds_read_b64_tr_b16 v[162:163], v13 offset:45568
  s_waitcnt lgkmcnt(6)
  v_mfma_f32_32x32x16_bf16 v[20:35], v[148:151], v[124:127], v[20:35]
  ds_read_b64_tr_b16 v[164:165], v12 offset:38912
  ds_read_b64_tr_b16 v[166:167], v12 offset:39424
  s_add_u32 s21, s24, 20480
  buffer_load_dwordx4 v[100:103], v11, s[8:11], s21 offen offset:0
  s_waitcnt lgkmcnt(6)
  v_mfma_f32_32x32x16_bf16 v[36:51], v[152:155], v[124:127], v[36:51]
  ds_read_b64_tr_b16 v[168:169], v13 offset:38912
  ds_read_b64_tr_b16 v[170:171], v13 offset:39424
  buffer_load_dwordx4 v[104:107], v11, s[8:11], s21 offen offset:1024
  s_waitcnt lgkmcnt(6)
  v_mfma_f32_32x32x16_bf16 v[52:67], v[156:159], v[124:127], v[52:67]
  ds_read_b64_tr_b16 v[172:173], v12 offset:47104
  ds_read_b64_tr_b16 v[174:175], v12 offset:47616
  s_waitcnt lgkmcnt(6)
  v_mfma_f32_32x32x16_bf16 v[68:83], v[160:163], v[124:127], v[68:83]
  ds_read_b64_tr_b16 v[176:177], v13 offset:47104
  ds_read_b64_tr_b16 v[178:179], v13 offset:47616
  s_waitcnt vmcnt(14)
  s_barrier
  s_waitcnt lgkmcnt(6)
  v_mfma_f32_32x32x16_bf16 v[20:35], v[164:167], v[128:131], v[20:35]
  ds_read_b64_tr_b16 v[148:149], v12 offset:49152
  ds_read_b64_tr_b16 v[150:151], v12 offset:49664
  buffer_load_dwordx4 v[108:111], v11, s[8:11], s21 offen offset:2048
  s_waitcnt lgkmcnt(6)
  v_mfma_f32_32x32x16_bf16 v[36:51], v[168:171], v[128:131], v[36:51]
  ds_read_b64_tr_b16 v[152:153], v13 offset:49152
  ds_read_b64_tr_b16 v[154:155], v13 offset:49664
  buffer_load_dwordx4 v[112:115], v11, s[8:11], s21 offen offset:3072
  s_waitcnt lgkmcnt(6)
  v_mfma_f32_32x32x16_bf16 v[52:67], v[172:175], v[128:131], v[52:67]
  ds_read_b64_tr_b16 v[156:157], v12 offset:57344
  ds_read_b64_tr_b16 v[158:159], v12 offset:57856
  s_waitcnt lgkmcnt(6)
  v_mfma_f32_32x32x16_bf16 v[68:83], v[176:179], v[128:131], v[68:83]
  ds_read_b64_tr_b16 v[160:161], v13 offset:57344
  ds_read_b64_tr_b16 v[162:163], v13 offset:57856
  s_waitcnt lgkmcnt(6)
  v_mfma_f32_32x32x16_bf16 v[20:35], v[148:151], v[132:135], v[20:35]
  ds_read_b64_tr_b16 v[164:165], v12 offset:51200
  ds_read_b64_tr_b16 v[166:167], v12 offset:51712
  s_add_u32 m0, s26, 147456
  s_add_u32 s20, s25, 1990656
  buffer_load_dwordx4 v10, s[12:15], s20 offen lds
  s_waitcnt lgkmcnt(6)
  v_mfma_f32_32x32x16_bf16 v[36:51], v[152:155], v[132:135], v[36:51]
  ds_read_b64_tr_b16 v[168:169], v13 offset:51200
  ds_read_b64_tr_b16 v[170:171], v13 offset:51712
  s_add_u32 m0, s26, 155648
  s_nop 0
  buffer_load_dwordx4 v10, s[32:35], s20 offen lds
  s_waitcnt lgkmcnt(6)
  v_mfma_f32_32x32x16_bf16 v[52:67], v[156:159], v[132:135], v[52:67]
  ds_read_b64_tr_b16 v[172:173], v12 offset:59392
  ds_read_b64_tr_b16 v[174:175], v12 offset:59904
  s_waitcnt lgkmcnt(6)
  v_mfma_f32_32x32x16_bf16 v[68:83], v[160:163], v[132:135], v[68:83]
  ds_read_b64_tr_b16 v[176:177], v13 offset:59392
  ds_read_b64_tr_b16 v[178:179], v13 offset:59904
  s_waitcnt lgkmcnt(6)
  v_mfma_f32_32x32x16_bf16 v[20:35], v[164:167], v[136:139], v[20:35]
  ds_read_b64_tr_b16 v[148:149], v12 offset:53248
  ds_read_b64_tr_b16 v[150:151], v12 offset:53760
  s_add_u32 s21, s24, 24576
  buffer_load_dwordx4 v[116:119], v11, s[8:11], s21 offen offset:0
  s_waitcnt lgkmcnt(6)
  v_mfma_f32_32x32x16_bf16 v[36:51], v[168:171], v[136:139], v[36:51]
  ds_read_b64_tr_b16 v[152:153], v13 offset:53248
  ds_read_b64_tr_b16 v[154:155], v13 offset:53760
  buffer_load_dwordx4 v[120:123], v11, s[8:11], s21 offen offset:1024
  s_waitcnt lgkmcnt(6)
  v_mfma_f32_32x32x16_bf16 v[52:67], v[172:175], v[136:139], v[52:67]
  ds_read_b64_tr_b16 v[156:157], v12 offset:61440
  ds_read_b64_tr_b16 v[158:159], v12 offset:61952
  s_waitcnt lgkmcnt(6)
  v_mfma_f32_32x32x16_bf16 v[68:83], v[176:179], v[136:139], v[68:83]
  ds_read_b64_tr_b16 v[160:161], v13 offset:61440
  ds_read_b64_tr_b16 v[162:163], v13 offset:61952
  s_waitcnt lgkmcnt(6)
  v_mfma_f32_32x32x16_bf16 v[20:35], v[148:151], v[140:143], v[20:35]
  ds_read_b64_tr_b16 v[164:165], v12 offset:55296
  ds_read_b64_tr_b16 v[166:167], v12 offset:55808
  buffer_load_dwordx4 v[124:127], v11, s[8:11], s21 offen offset:2048
  s_waitcnt lgkmcnt(6)
  v_mfma_f32_32x32x16_bf16 v[36:51], v[152:155], v[140:143], v[36:51]
  ds_read_b64_tr_b16 v[168:169], v13 offset:55296
  ds_read_b64_tr_b16 v[170:171], v13 offset:55808
  buffer_load_dwordx4 v[128:131], v11, s[8:11], s21 offen offset:3072
  s_waitcnt lgkmcnt(6)
  v_mfma_f32_32x32x16_bf16 v[52:67], v[156:159], v[140:143], v[52:67]
  ds_read_b64_tr_b16 v[172:173], v12 offset:63488
  ds_read_b64_tr_b16 v[174:175], v12 offset:64000
  s_waitcnt lgkmcnt(6)
  v_mfma_f32_32x32x16_bf16 v[68:83], v[160:163], v[140:143], v[68:83]
  ds_read_b64_tr_b16 v[176:177], v13 offset:63488
  ds_read_b64_tr_b16 v[178:179], v13 offset:64000
  s_waitcnt vmcnt(14)
  s_barrier
  s_waitcnt lgkmcnt(6)
  v_mfma_f32_32x32x16_bf16 v[20:35], v[164:167], v[144:147], v[20:35]
  ds_read_b64_tr_b16 v[148:149], v14 offset:0
  ds_read_b64_tr_b16 v[150:151], v14 offset:512
  s_waitcnt lgkmcnt(6)
  v_mfma_f32_32x32x16_bf16 v[36:51], v[168:171], v[144:147], v[36:51]
  ds_read_b64_tr_b16 v[152:153], v15 offset:0
  ds_read_b64_tr_b16 v[154:155], v15 offset:512
  s_waitcnt lgkmcnt(6)
  v_mfma_f32_32x32x16_bf16 v[52:67], v[172:175], v[144:147], v[52:67]
  ds_read_b64_tr_b16 v[156:157], v14 offset:8192
  ds_read_b64_tr_b16 v[158:159], v14 offset:8704
  s_waitcnt lgkmcnt(6)
  v_mfma_f32_32x32x16_bf16 v[68:83], v[176:179], v[144:147], v[68:83]
  ds_read_b64_tr_b16 v[160:161], v15 offset:8192
  ds_read_b64_tr_b16 v[162:163], v15 offset:8704
  s_waitcnt lgkmcnt(6)
  v_mfma_f32_32x32x16_bf16 v[20:35], v[148:151], v[84:87], v[20:35]
  ds_read_b64_tr_b16 v[164:165], v14 offset:2048
  ds_read_b64_tr_b16 v[166:167], v14 offset:2560
  s_add_u32 s21, s24, 28672
  buffer_load_dwordx4 v[132:135], v11, s[8:11], s21 offen offset:0
  s_waitcnt lgkmcnt(6)
  v_mfma_f32_32x32x16_bf16 v[36:51], v[152:155], v[84:87], v[36:51]
  ds_read_b64_tr_b16 v[168:169], v15 offset:2048
  ds_read_b64_tr_b16 v[170:171], v15 offset:2560
  s_waitcnt lgkmcnt(6)
  v_mfma_f32_32x32x16_bf16 v[52:67], v[156:159], v[84:87], v[52:67]
  ds_read_b64_tr_b16 v[172:173], v14 offset:10240
  ds_read_b64_tr_b16 v[174:175], v14 offset:10752
  s_waitcnt lgkmcnt(6)
  v_mfma_f32_32x32x16_bf16 v[68:83], v[160:163], v[84:87], v[68:83]
  ds_read_b64_tr_b16 v[176:177], v15 offset:10240
  ds_read_b64_tr_b16 v[178:179], v15 offset:10752
  s_waitcnt lgkmcnt(6)
  v_mfma_f32_32x32x16_bf16 v[20:35], v[164:167], v[88:91], v[20:35]
  ds_read_b64_tr_b16 v[148:149], v14 offset:4096
  ds_read_b64_tr_b16 v[150:151], v14 offset:4608
  buffer_load_dwordx4 v[136:139], v11, s[8:11], s21 offen offset:1024
  s_waitcnt lgkmcnt(6)
  v_mfma_f32_32x32x16_bf16 v[36:51], v[168:171], v[88:91], v[36:51]
  ds_read_b64_tr_b16 v[152:153], v15 offset:4096
  ds_read_b64_tr_b16 v[154:155], v15 offset:4608
  s_waitcnt lgkmcnt(6)
  v_mfma_f32_32x32x16_bf16 v[52:67], v[172:175], v[88:91], v[52:67]
  ds_read_b64_tr_b16 v[156:157], v14 offset:12288
  ds_read_b64_tr_b16 v[158:159], v14 offset:12800
  s_waitcnt lgkmcnt(6)
  v_mfma_f32_32x32x16_bf16 v[68:83], v[176:179], v[88:91], v[68:83]
  ds_read_b64_tr_b16 v[160:161], v15 offset:12288
  ds_read_b64_tr_b16 v[162:163], v15 offset:12800
  s_waitcnt lgkmcnt(6)
  v_mfma_f32_32x32x16_bf16 v[20:35], v[148:151], v[92:95], v[20:35]
  ds_read_b64_tr_b16 v[164:165], v14 offset:6144
  ds_read_b64_tr_b16 v[166:167], v14 offset:6656
  buffer_load_dwordx4 v[140:143], v11, s[8:11], s21 offen offset:2048
  s_waitcnt lgkmcnt(6)
  v_mfma_f32_32x32x16_bf16 v[36:51], v[152:155], v[92:95], v[36:51]
  ds_read_b64_tr_b16 v[168:169], v15 offset:6144
  ds_read_b64_tr_b16 v[170:171], v15 offset:6656
  s_waitcnt lgkmcnt(6)
  v_mfma_f32_32x32x16_bf16 v[52:67], v[156:159], v[92:95], v[52:67]
  ds_read_b64_tr_b16 v[172:173], v14 offset:14336
  ds_read_b64_tr_b16 v[174:175], v14 offset:14848
  s_waitcnt lgkmcnt(6)
  v_mfma_f32_32x32x16_bf16 v[68:83], v[160:163], v[92:95], v[68:83]
  ds_read_b64_tr_b16 v[176:177], v15 offset:14336
  ds_read_b64_tr_b16 v[178:179], v15 offset:14848
  s_waitcnt vmcnt(7)
  s_barrier
  s_waitcnt lgkmcnt(6)
  v_mfma_f32_32x32x16_bf16 v[20:35], v[164:167], v[96:99], v[20:35]
  ds_read_b64_tr_b16 v[148:149], v14 offset:16384
  ds_read_b64_tr_b16 v[150:151], v14 offset:16896
  buffer_load_dwordx4 v[144:147], v11, s[8:11], s21 offen offset:3072
  s_waitcnt lgkmcnt(6)
  v_mfma_f32_32x32x16_bf16 v[36:51], v[168:171], v[96:99], v[36:51]
  ds_read_b64_tr_b16 v[152:153], v15 offset:16384
  ds_read_b64_tr_b16 v[154:155], v15 offset:16896
  s_waitcnt lgkmcnt(6)
  v_mfma_f32_32x32x16_bf16 v[52:67], v[172:175], v[96:99], v[52:67]
  ds_read_b64_tr_b16 v[156:157], v14 offset:24576
  ds_read_b64_tr_b16 v[158:159], v14 offset:25088
  s_waitcnt lgkmcnt(6)
  v_mfma_f32_32x32x16_bf16 v[68:83], v[176:179], v[96:99], v[68:83]
  ds_read_b64_tr_b16 v[160:161], v15 offset:24576
  ds_read_b64_tr_b16 v[162:163], v15 offset:25088
  s_waitcnt lgkmcnt(6)
  v_mfma_f32_32x32x16_bf16 v[20:35], v[148:151], v[100:103], v[20:35]
  ds_read_b64_tr_b16 v[164:165], v14 offset:18432
  ds_read_b64_tr_b16 v[166:167], v14 offset:18944
  s_add_u32 s21, s24, 32768
  buffer_load_dwordx4 v[84:87], v11, s[8:11], s21 offen offset:0
  s_waitcnt lgkmcnt(6)
  v_mfma_f32_32x32x16_bf16 v[36:51], v[152:155], v[100:103], v[36:51]
  ds_read_b64_tr_b16 v[168:169], v15 offset:18432
  ds_read_b64_tr_b16 v[170:171], v15 offset:18944
  s_waitcnt lgkmcnt(6)
  v_mfma_f32_32x32x16_bf16 v[52:67], v[156:159], v[100:103], v[52:67]
  ds_read_b64_tr_b16 v[172:173], v14 offset:26624
  ds_read_b64_tr_b16 v[174:175], v14 offset:27136
  s_waitcnt lgkmcnt(6)
  v_mfma_f32_32x32x16_bf16 v[68:83], v[160:163], v[100:103], v[68:83]
  ds_read_b64_tr_b16 v[176:177], v15 offset:26624
  ds_read_b64_tr_b16 v[178:179], v15 offset:27136
  s_waitcnt lgkmcnt(6)
  v_mfma_f32_32x32x16_bf16 v[20:35], v[164:167], v[104:107], v[20:35]
  ds_read_b64_tr_b16 v[148:149], v14 offset:20480
  ds_read_b64_tr_b16 v[150:151], v14 offset:20992
  buffer_load_dwordx4 v[88:91], v11, s[8:11], s21 offen offset:1024
  s_waitcnt lgkmcnt(6)
  v_mfma_f32_32x32x16_bf16 v[36:51], v[168:171], v[104:107], v[36:51]
  ds_read_b64_tr_b16 v[152:153], v15 offset:20480
  ds_read_b64_tr_b16 v[154:155], v15 offset:20992
  s_waitcnt lgkmcnt(6)
  v_mfma_f32_32x32x16_bf16 v[52:67], v[172:175], v[104:107], v[52:67]
  ds_read_b64_tr_b16 v[156:157], v14 offset:28672
  ds_read_b64_tr_b16 v[158:159], v14 offset:29184
  s_waitcnt lgkmcnt(6)
  v_mfma_f32_32x32x16_bf16 v[68:83], v[176:179], v[104:107], v[68:83]
  ds_read_b64_tr_b16 v[160:161], v15 offset:28672
  ds_read_b64_tr_b16 v[162:163], v15 offset:29184
  s_waitcnt lgkmcnt(6)
  v_mfma_f32_32x32x16_bf16 v[20:35], v[148:151], v[108:111], v[20:35]
  ds_read_b64_tr_b16 v[164:165], v14 offset:22528
  ds_read_b64_tr_b16 v[166:167], v14 offset:23040
  buffer_load_dwordx4 v[92:95], v11, s[8:11], s21 offen offset:2048
  s_waitcnt lgkmcnt(6)
  v_mfma_f32_32x32x16_bf16 v[36:51], v[152:155], v[108:111], v[36:51]
  ds_read_b64_tr_b16 v[168:169], v15 offset:22528
  ds_read_b64_tr_b16 v[170:171], v15 offset:23040
  s_waitcnt lgkmcnt(6)
  v_mfma_f32_32x32x16_bf16 v[52:67], v[156:159], v[108:111], v[52:67]
  ds_read_b64_tr_b16 v[172:173], v14 offset:30720
  ds_read_b64_tr_b16 v[174:175], v14 offset:31232
  s_waitcnt lgkmcnt(6)
  v_mfma_f32_32x32x16_bf16 v[68:83], v[160:163], v[108:111], v[68:83]
  ds_read_b64_tr_b16 v[176:177], v15 offset:30720
  ds_read_b64_tr_b16 v[178:179], v15 offset:31232
  s_waitcnt vmcnt(7)
  s_waitcnt lgkmcnt(6)
  v_mfma_f32_32x32x16_bf16 v[20:35], v[164:167], v[112:115], v[20:35]
  ds_read_b64_tr_b16 v[148:149], v14 offset:32768
  ds_read_b64_tr_b16 v[150:151], v14 offset:33280
  buffer_load_dwordx4 v[96:99], v11, s[8:11], s21 offen offset:3072
  s_waitcnt lgkmcnt(6)
  v_mfma_f32_32x32x16_bf16 v[36:51], v[168:171], v[112:115], v[36:51]
  ds_read_b64_tr_b16 v[152:153], v15 offset:32768
  ds_read_b64_tr_b16 v[154:155], v15 offset:33280
  s_waitcnt lgkmcnt(6)
  v_mfma_f32_32x32x16_bf16 v[52:67], v[172:175], v[112:115], v[52:67]
  ds_read_b64_tr_b16 v[156:157], v14 offset:40960
  ds_read_b64_tr_b16 v[158:159], v14 offset:41472
  s_waitcnt lgkmcnt(6)
  v_mfma_f32_32x32x16_bf16 v[68:83], v[176:179], v[112:115], v[68:83]
  ds_read_b64_tr_b16 v[160:161], v15 offset:40960
  ds_read_b64_tr_b16 v[162:163], v15 offset:41472
  s_waitcnt lgkmcnt(6)
  v_mfma_f32_32x32x16_bf16 v[20:35], v[148:151], v[116:119], v[20:35]
  ds_read_b64_tr_b16 v[164:165], v14 offset:34816
  ds_read_b64_tr_b16 v[166:167], v14 offset:35328
  s_add_u32 s21, s24, 36864
  buffer_load_dwordx4 v[100:103], v11, s[8:11], s21 offen offset:0
  s_waitcnt lgkmcnt(6)
  v_mfma_f32_32x32x16_bf16 v[36:51], v[152:155], v[116:119], v[36:51]
  ds_read_b64_tr_b16 v[168:169], v15 offset:34816
  ds_read_b64_tr_b16 v[170:171], v15 offset:35328
  s_waitcnt lgkmcnt(6)
  v_mfma_f32_32x32x16_bf16 v[52:67], v[156:159], v[116:119], v[52:67]
  ds_read_b64_tr_b16 v[172:173], v14 offset:43008
  ds_read_b64_tr_b16 v[174:175], v14 offset:43520
  s_waitcnt lgkmcnt(6)
  v_mfma_f32_32x32x16_bf16 v[68:83], v[160:163], v[116:119], v[68:83]
  ds_read_b64_tr_b16 v[176:177], v15 offset:43008
  ds_read_b64_tr_b16 v[178:179], v15 offset:43520
  s_waitcnt lgkmcnt(6)
  v_mfma_f32_32x32x16_bf16 v[20:35], v[164:167], v[120:123], v[20:35]
  ds_read_b64_tr_b16 v[148:149], v14 offset:36864
  ds_read_b64_tr_b16 v[150:151], v14 offset:37376
  buffer_load_dwordx4 v[104:107], v11, s[8:11], s21 offen offset:1024
  s_waitcnt lgkmcnt(6)
  v_mfma_f32_32x32x16_bf16 v[36:51], v[168:171], v[120:123], v[36:51]
  ds_read_b64_tr_b16 v[152:153], v15 offset:36864
  ds_read_b64_tr_b16 v[154:155], v15 offset:37376
  s_waitcnt lgkmcnt(6)
  v_mfma_f32_32x32x16_bf16 v[52:67], v[172:175], v[120:123], v[52:67]
  ds_read_b64_tr_b16 v[156:157], v14 offset:45056
  ds_read_b64_tr_b16 v[158:159], v14 offset:45568
  s_waitcnt lgkmcnt(6)
  v_mfma_f32_32x32x16_bf16 v[68:83], v[176:179], v[120:123], v[68:83]
  ds_read_b64_tr_b16 v[160:161], v15 offset:45056
  ds_read_b64_tr_b16 v[162:163], v15 offset:45568
  s_waitcnt lgkmcnt(6)
  v_mfma_f32_32x32x16_bf16 v[20:35], v[148:151], v[124:127], v[20:35]
  ds_read_b64_tr_b16 v[164:165], v14 offset:38912
  ds_read_b64_tr_b16 v[166:167], v14 offset:39424
  buffer_load_dwordx4 v[108:111], v11, s[8:11], s21 offen offset:2048
  s_waitcnt lgkmcnt(6)
  v_mfma_f32_32x32x16_bf16 v[36:51], v[152:155], v[124:127], v[36:51]
  ds_read_b64_tr_b16 v[168:169], v15 offset:38912
  ds_read_b64_tr_b16 v[170:171], v15 offset:39424
  s_waitcnt lgkmcnt(6)
  v_mfma_f32_32x32x16_bf16 v[52:67], v[156:159], v[124:127], v[52:67]
  ds_read_b64_tr_b16 v[172:173], v14 offset:47104
  ds_read_b64_tr_b16 v[174:175], v14 offset:47616
  s_waitcnt lgkmcnt(6)
  v_mfma_f32_32x32x16_bf16 v[68:83], v[160:163], v[124:127], v[68:83]
  ds_read_b64_tr_b16 v[176:177], v15 offset:47104
  ds_read_b64_tr_b16 v[178:179], v15 offset:47616
  s_waitcnt vmcnt(7)
  s_waitcnt lgkmcnt(6)
  v_mfma_f32_32x32x16_bf16 v[20:35], v[164:167], v[128:131], v[20:35]
  ds_read_b64_tr_b16 v[148:149], v14 offset:49152
  ds_read_b64_tr_b16 v[150:151], v14 offset:49664
  buffer_load_dwordx4 v[112:115], v11, s[8:11], s21 offen offset:3072
  s_waitcnt lgkmcnt(6)
  v_mfma_f32_32x32x16_bf16 v[36:51], v[168:171], v[128:131], v[36:51]
  ds_read_b64_tr_b16 v[152:153], v15 offset:49152
  ds_read_b64_tr_b16 v[154:155], v15 offset:49664
  s_waitcnt lgkmcnt(6)
  v_mfma_f32_32x32x16_bf16 v[52:67], v[172:175], v[128:131], v[52:67]
  ds_read_b64_tr_b16 v[156:157], v14 offset:57344
  ds_read_b64_tr_b16 v[158:159], v14 offset:57856
  s_waitcnt lgkmcnt(6)
  v_mfma_f32_32x32x16_bf16 v[68:83], v[176:179], v[128:131], v[68:83]
  ds_read_b64_tr_b16 v[160:161], v15 offset:57344
  ds_read_b64_tr_b16 v[162:163], v15 offset:57856
  v_and_b32 v7, 31, v1
  s_lshl_b32 s20, s17, 8
  s_lshl_b32 s21, s16, 5
  s_add_u32 s20, s20, s21
  v_add_u32 v7, s20, v7
  s_add_u32 s44, s4, 13631488
  s_addc_u32 s45, s5, 0
  s_and_b32 s45, s45, 0xffff
  s_mov_b32 s46, 7222784
  s_mov_b32 s47, 0x20000
  v_lshlrev_b32 v8, 3, v7
  s_mov_b32 s50, 0
  buffer_load_dwordx2 v[184:185], v8, s[44:47], s50 offen
  s_add_u32 s50, s50, 16384
  buffer_load_dwordx2 v[186:187], v8, s[44:47], s50 offen
  s_add_u32 s50, s50, 16384
  buffer_load_dwordx2 v[188:189], v8, s[44:47], s50 offen
  s_add_u32 s50, s50, 16384
  buffer_load_dwordx2 v[190:191], v8, s[44:47], s50 offen
  s_add_u32 s50, s50, 16384
  buffer_load_dwordx2 v[192:193], v8, s[44:47], s50 offen
  s_add_u32 s50, s50, 16384
  buffer_load_dwordx2 v[194:195], v8, s[44:47], s50 offen
  s_add_u32 s50, s50, 16384
  buffer_load_dwordx2 v[196:197], v8, s[44:47], s50 offen
  s_add_u32 s50, s50, 16384
  buffer_load_dwordx2 v[198:199], v8, s[44:47], s50 offen
  s_lshl_b32 s20, s18, 8
  s_add_u32 s48, s20, 7208960
  s_add_u32 s49, s48, 6912
  v_lshlrev_b32 v9, 4, v6
  s_waitcnt lgkmcnt(6)
  v_mfma_f32_32x32x16_bf16 v[20:35], v[148:151], v[132:135], v[20:35]
  ds_read_b64_tr_b16 v[164:165], v14 offset:51200
  ds_read_b64_tr_b16 v[166:167], v14 offset:51712
  s_waitcnt lgkmcnt(6)
  v_mfma_f32_32x32x16_bf16 v[36:51], v[152:155], v[132:135], v[36:51]
  ds_read_b64_tr_b16 v[168:169], v15 offset:51200
  ds_read_b64_tr_b16 v[170:171], v15 offset:51712
  s_waitcnt lgkmcnt(6)
  v_mfma_f32_32x32x16_bf16 v[52:67], v[156:159], v[132:135], v[52:67]
  ds_read_b64_tr_b16 v[172:173], v14 offset:59392
  ds_read_b64_tr_b16 v[174:175], v14 offset:59904
  s_waitcnt lgkmcnt(6)
  v_mfma_f32_32x32x16_bf16 v[68:83], v[160:163], v[132:135], v[68:83]
  ds_read_b64_tr_b16 v[176:177], v15 offset:59392
  ds_read_b64_tr_b16 v[178:179], v15 offset:59904
  s_waitcnt lgkmcnt(6)
  v_mfma_f32_32x32x16_bf16 v[20:35], v[164:167], v[136:139], v[20:35]
  ds_read_b64_tr_b16 v[148:149], v14 offset:53248
  ds_read_b64_tr_b16 v[150:151], v14 offset:53760
  s_waitcnt lgkmcnt(6)
  v_mfma_f32_32x32x16_bf16 v[36:51], v[168:171], v[136:139], v[36:51]
  ds_read_b64_tr_b16 v[152:153], v15 offset:53248
  ds_read_b64_tr_b16 v[154:155], v15 offset:53760
  s_waitcnt lgkmcnt(6)
  v_mfma_f32_32x32x16_bf16 v[52:67], v[172:175], v[136:139], v[52:67]
  ds_read_b64_tr_b16 v[156:157], v14 offset:61440
  ds_read_b64_tr_b16 v[158:159], v14 offset:61952
  s_waitcnt lgkmcnt(6)
  v_mfma_f32_32x32x16_bf16 v[68:83], v[176:179], v[136:139], v[68:83]
  ds_read_b64_tr_b16 v[160:161], v15 offset:61440
  ds_read_b64_tr_b16 v[162:163], v15 offset:61952
  s_waitcnt lgkmcnt(6)
  v_mfma_f32_32x32x16_bf16 v[20:35], v[148:151], v[140:143], v[20:35]
  ds_read_b64_tr_b16 v[164:165], v14 offset:55296
  ds_read_b64_tr_b16 v[166:167], v14 offset:55808
  s_waitcnt lgkmcnt(6)
  v_mfma_f32_32x32x16_bf16 v[36:51], v[152:155], v[140:143], v[36:51]
  ds_read_b64_tr_b16 v[168:169], v15 offset:55296
  ds_read_b64_tr_b16 v[170:171], v15 offset:55808
  s_waitcnt lgkmcnt(6)
  v_mfma_f32_32x32x16_bf16 v[52:67], v[156:159], v[140:143], v[52:67]
  ds_read_b64_tr_b16 v[172:173], v14 offset:63488
  ds_read_b64_tr_b16 v[174:175], v14 offset:64000
  s_waitcnt lgkmcnt(6)
  v_mfma_f32_32x32x16_bf16 v[68:83], v[160:163], v[140:143], v[68:83]
  ds_read_b64_tr_b16 v[176:177], v15 offset:63488
  ds_read_b64_tr_b16 v[178:179], v15 offset:64000
  s_waitcnt vmcnt(12)
  s_waitcnt lgkmcnt(6)
  v_mfma_f32_32x32x16_bf16 v[20:35], v[164:167], v[144:147], v[20:35]
  ds_read_b64_tr_b16 v[148:149], v16 offset:0
  ds_read_b64_tr_b16 v[150:151], v16 offset:512
  s_waitcnt lgkmcnt(6)
  v_mfma_f32_32x32x16_bf16 v[36:51], v[168:171], v[144:147], v[36:51]
  ds_read_b64_tr_b16 v[152:153], v17 offset:0
  ds_read_b64_tr_b16 v[154:155], v17 offset:512
  s_waitcnt lgkmcnt(6)
  v_mfma_f32_32x32x16_bf16 v[52:67], v[172:175], v[144:147], v[52:67]
  ds_read_b64_tr_b16 v[156:157], v16 offset:8192
  ds_read_b64_tr_b16 v[158:159], v16 offset:8704
  s_waitcnt lgkmcnt(6)
  v_mfma_f32_32x32x16_bf16 v[68:83], v[176:179], v[144:147], v[68:83]
  ds_read_b64_tr_b16 v[160:161], v17 offset:8192
  ds_read_b64_tr_b16 v[162:163], v17 offset:8704
  s_waitcnt lgkmcnt(6)
  v_mfma_f32_32x32x16_bf16 v[20:35], v[148:151], v[84:87], v[20:35]
  ds_read_b64_tr_b16 v[164:165], v16 offset:2048
  ds_read_b64_tr_b16 v[166:167], v16 offset:2560
  s_waitcnt lgkmcnt(6)
  v_mfma_f32_32x32x16_bf16 v[36:51], v[152:155], v[84:87], v[36:51]
  ds_read_b64_tr_b16 v[168:169], v17 offset:2048
  ds_read_b64_tr_b16 v[170:171], v17 offset:2560
  s_waitcnt lgkmcnt(6)
  v_mfma_f32_32x32x16_bf16 v[52:67], v[156:159], v[84:87], v[52:67]
  ds_read_b64_tr_b16 v[172:173], v16 offset:10240
  ds_read_b64_tr_b16 v[174:175], v16 offset:10752
  s_waitcnt lgkmcnt(6)
  v_mfma_f32_32x32x16_bf16 v[68:83], v[160:163], v[84:87], v[68:83]
  ds_read_b64_tr_b16 v[176:177], v17 offset:10240
  ds_read_b64_tr_b16 v[178:179], v17 offset:10752
  s_waitcnt lgkmcnt(6)
  v_mfma_f32_32x32x16_bf16 v[20:35], v[164:167], v[88:91], v[20:35]
  ds_read_b64_tr_b16 v[148:149], v16 offset:4096
  ds_read_b64_tr_b16 v[150:151], v16 offset:4608
  s_waitcnt lgkmcnt(6)
  v_mfma_f32_32x32x16_bf16 v[36:51], v[168:171], v[88:91], v[36:51]
  ds_read_b64_tr_b16 v[152:153], v17 offset:4096
  ds_read_b64_tr_b16 v[154:155], v17 offset:4608
  s_waitcnt lgkmcnt(6)
  v_mfma_f32_32x32x16_bf16 v[52:67], v[172:175], v[88:91], v[52:67]
  ds_read_b64_tr_b16 v[156:157], v16 offset:12288
  ds_read_b64_tr_b16 v[158:159], v16 offset:12800
  s_waitcnt lgkmcnt(6)
  v_mfma_f32_32x32x16_bf16 v[68:83], v[176:179], v[88:91], v[68:83]
  ds_read_b64_tr_b16 v[160:161], v17 offset:12288
  ds_read_b64_tr_b16 v[162:163], v17 offset:12800
  s_waitcnt lgkmcnt(6)
  v_mfma_f32_32x32x16_bf16 v[20:35], v[148:151], v[92:95], v[20:35]
  ds_read_b64_tr_b16 v[164:165], v16 offset:6144
  ds_read_b64_tr_b16 v[166:167], v16 offset:6656
  s_waitcnt lgkmcnt(6)
  v_mfma_f32_32x32x16_bf16 v[36:51], v[152:155], v[92:95], v[36:51]
  ds_read_b64_tr_b16 v[168:169], v17 offset:6144
  ds_read_b64_tr_b16 v[170:171], v17 offset:6656
  s_waitcnt lgkmcnt(6)
  v_mfma_f32_32x32x16_bf16 v[52:67], v[156:159], v[92:95], v[52:67]
  ds_read_b64_tr_b16 v[172:173], v16 offset:14336
  ds_read_b64_tr_b16 v[174:175], v16 offset:14848
  s_waitcnt lgkmcnt(6)
  v_mfma_f32_32x32x16_bf16 v[68:83], v[160:163], v[92:95], v[68:83]
  ds_read_b64_tr_b16 v[176:177], v17 offset:14336
  ds_read_b64_tr_b16 v[178:179], v17 offset:14848
  s_waitcnt vmcnt(8)
  s_waitcnt lgkmcnt(6)
  v_mfma_f32_32x32x16_bf16 v[20:35], v[164:167], v[96:99], v[20:35]
  ds_read_b64_tr_b16 v[148:149], v16 offset:16384
  ds_read_b64_tr_b16 v[150:151], v16 offset:16896
  s_waitcnt lgkmcnt(6)
  v_mfma_f32_32x32x16_bf16 v[36:51], v[168:171], v[96:99], v[36:51]
  ds_read_b64_tr_b16 v[152:153], v17 offset:16384
  ds_read_b64_tr_b16 v[154:155], v17 offset:16896
  s_waitcnt lgkmcnt(6)
  v_mfma_f32_32x32x16_bf16 v[52:67], v[172:175], v[96:99], v[52:67]
  ds_read_b64_tr_b16 v[156:157], v16 offset:24576
  ds_read_b64_tr_b16 v[158:159], v16 offset:25088
  s_waitcnt lgkmcnt(6)
  v_mfma_f32_32x32x16_bf16 v[68:83], v[176:179], v[96:99], v[68:83]
  ds_read_b64_tr_b16 v[160:161], v17 offset:24576
  ds_read_b64_tr_b16 v[162:163], v17 offset:25088
  buffer_load_dwordx4 v[116:119], v9, s[44:47], s48 offen offset:0
  buffer_load_dwordx4 v[120:123], v9, s[44:47], s48 offen offset:32
  buffer_load_dwordx4 v[124:127], v9, s[44:47], s48 offen offset:64
  buffer_load_dwordx4 v[128:131], v9, s[44:47], s48 offen offset:96
  buffer_load_dwordx4 v[132:135], v9, s[44:47], s49 offen offset:0
  buffer_load_dwordx4 v[136:139], v9, s[44:47], s49 offen offset:32
  buffer_load_dwordx4 v[140:143], v9, s[44:47], s49 offen offset:64
  buffer_load_dwordx4 v[144:147], v9, s[44:47], s49 offen offset:96
  s_waitcnt lgkmcnt(6)
  v_mfma_f32_32x32x16_bf16 v[20:35], v[148:151], v[100:103], v[20:35]
  ds_read_b64_tr_b16 v[164:165], v16 offset:18432
  ds_read_b64_tr_b16 v[166:167], v16 offset:18944
  s_waitcnt lgkmcnt(6)
  v_mfma_f32_32x32x16_bf16 v[36:51], v[152:155], v[100:103], v[36:51]
  ds_read_b64_tr_b16 v[168:169], v17 offset:18432
  ds_read_b64_tr_b16 v[170:171], v17 offset:18944
  s_waitcnt lgkmcnt(6)
  v_mfma_f32_32x32x16_bf16 v[52:67], v[156:159], v[100:103], v[52:67]
  ds_read_b64_tr_b16 v[172:173], v16 offset:26624
  ds_read_b64_tr_b16 v[174:175], v16 offset:27136
  s_waitcnt lgkmcnt(6)
  v_mfma_f32_32x32x16_bf16 v[68:83], v[160:163], v[100:103], v[68:83]
  ds_read_b64_tr_b16 v[176:177], v17 offset:26624
  ds_read_b64_tr_b16 v[178:179], v17 offset:27136
  s_waitcnt lgkmcnt(6)
  v_mfma_f32_32x32x16_bf16 v[20:35], v[164:167], v[104:107], v[20:35]
  ds_read_b64_tr_b16 v[148:149], v16 offset:20480
  ds_read_b64_tr_b16 v[150:151], v16 offset:20992
  s_waitcnt lgkmcnt(6)
  v_mfma_f32_32x32x16_bf16 v[36:51], v[168:171], v[104:107], v[36:51]
  ds_read_b64_tr_b16 v[152:153], v17 offset:20480
  ds_read_b64_tr_b16 v[154:155], v17 offset:20992
  s_waitcnt lgkmcnt(6)
  v_mfma_f32_32x32x16_bf16 v[52:67], v[172:175], v[104:107], v[52:67]
  ds_read_b64_tr_b16 v[156:157], v16 offset:28672
  ds_read_b64_tr_b16 v[158:159], v16 offset:29184
  s_waitcnt lgkmcnt(6)
  v_mfma_f32_32x32x16_bf16 v[68:83], v[176:179], v[104:107], v[68:83]
  ds_read_b64_tr_b16 v[160:161], v17 offset:28672
  ds_read_b64_tr_b16 v[162:163], v17 offset:29184
  s_waitcnt lgkmcnt(6)
  v_mfma_f32_32x32x16_bf16 v[20:35], v[148:151], v[108:111], v[20:35]
  ds_read_b64_tr_b16 v[164:165], v16 offset:22528
  ds_read_b64_tr_b16 v[166:167], v16 offset:23040
  s_waitcnt lgkmcnt(6)
  v_mfma_f32_32x32x16_bf16 v[36:51], v[152:155], v[108:111], v[36:51]
  ds_read_b64_tr_b16 v[168:169], v17 offset:22528
  ds_read_b64_tr_b16 v[170:171], v17 offset:23040
  s_waitcnt lgkmcnt(6)
  v_mfma_f32_32x32x16_bf16 v[52:67], v[156:159], v[108:111], v[52:67]
  ds_read_b64_tr_b16 v[172:173], v16 offset:30720
  ds_read_b64_tr_b16 v[174:175], v16 offset:31232
  s_waitcnt lgkmcnt(6)
  v_mfma_f32_32x32x16_bf16 v[68:83], v[160:163], v[108:111], v[68:83]
  ds_read_b64_tr_b16 v[176:177], v17 offset:30720
  ds_read_b64_tr_b16 v[178:179], v17 offset:31232
  s_waitcnt lgkmcnt(6)
  v_mfma_f32_32x32x16_bf16 v[20:35], v[164:167], v[112:115], v[20:35]
  s_waitcnt lgkmcnt(4)
  v_mfma_f32_32x32x16_bf16 v[36:51], v[168:171], v[112:115], v[36:51]
  s_waitcnt lgkmcnt(2)
  v_mfma_f32_32x32x16_bf16 v[52:67], v[172:175], v[112:115], v[52:67]
  s_waitcnt lgkmcnt(0)
  v_mfma_f32_32x32x16_bf16 v[68:83], v[176:179], v[112:115], v[68:83]
  buffer_load_dwordx4 v[84:87], v9, s[44:47], s48 offen offset:128
  buffer_load_dwordx4 v[88:91], v9, s[44:47], s48 offen offset:160
  buffer_load_dwordx4 v[92:95], v9, s[44:47], s48 offen offset:192
  buffer_load_dwordx4 v[96:99], v9, s[44:47], s48 offen offset:224
  buffer_load_dwordx4 v[100:103], v9, s[44:47], s49 offen offset:128
  buffer_load_dwordx4 v[104:107], v9, s[44:47], s49 offen offset:160
  buffer_load_dwordx4 v[108:111], v9, s[44:47], s49 offen offset:192
  buffer_load_dwordx4 v[112:115], v9, s[44:47], s49 offen offset:224
  s_waitcnt vmcnt(16)
  v_add_f32 v184, v184, v186
  v_add_f32 v185, v185, v187
  v_add_f32 v188, v188, v190
  v_add_f32 v189, v189, v191
  v_add_f32 v192, v192, v194
  v_add_f32 v193, v193, v195
  v_add_f32 v196, v196, v198
  v_add_f32 v197, v197, v199
  v_add_f32 v184, v184, v188
  v_add_f32 v185, v185, v189
  v_add_f32 v192, v192, v196
  v_add_f32 v193, v193, v197
  v_add_f32 v184, v184, v192
  v_add_f32 v185, v185, v193
  v_mul_f32 v184, 986500301, v184
  v_mul_f32 v185, 986500301, v185
  v_fma_f32 v185, -v184, v184, v185
  v_max_f32 v185, 0, v185
  v_add_f32 v185, 925353388, v185
  v_mov_b32 v189, v185
  v_rsq_f32 v185, v185
  v_sub_f32 v186, 0, v184
  v_mul_f32 v187, 3216550459, v185
  v_lshrrev_b32 v2, 4, v7
  v_mul_u32_u24 v2, 55296, v2
  v_and_b32 v3, 15, v7
  v_lshl_add_u32 v2, v3, 4, v2
  v_lshl_add_u32 v2, v6, 8, v2
  s_add_u32 s52, s4, 13762560
  s_addc_u32 s53, s5, 0
  s_and_b32 s53, s53, 0xffff
  s_mov_b32 s54, 7077888
  s_mov_b32 s55, 0x20000
  s_lshl_b32 s20, s18, 11
  s_waitcnt vmcnt(8)
  v_fmac_f32 v20, v116, v186
  v_fmac_f32 v21, v117, v186
  v_fmac_f32 v22, v118, v186
  v_fmac_f32 v23, v119, v186
  v_fmac_f32 v24, v120, v186
  v_fmac_f32 v25, v121, v186
  v_fmac_f32 v26, v122, v186
  v_fmac_f32 v27, v123, v186
  v_fmac_f32 v28, v124, v186
  v_fmac_f32 v29, v125, v186
  v_fmac_f32 v30, v126, v186
  v_fmac_f32 v31, v127, v186
  v_fmac_f32 v32, v128, v186
  v_fmac_f32 v33, v129, v186
  v_fmac_f32 v34, v130, v186
  v_fmac_f32 v35, v131, v186
  v_fmac_f32 v52, v132, v186
  v_fmac_f32 v53, v133, v186
  v_fmac_f32 v54, v134, v186
  v_fmac_f32 v55, v135, v186
  v_fmac_f32 v56, v136, v186
  v_fmac_f32 v57, v137, v186
  v_fmac_f32 v58, v138, v186
  v_fmac_f32 v59, v139, v186
  v_fmac_f32 v60, v140, v186
  v_fmac_f32 v61, v141, v186
  v_fmac_f32 v62, v142, v186
  v_fmac_f32 v63, v143, v186
  v_fmac_f32 v64, v144, v186
  v_fmac_f32 v65, v145, v186
  v_fmac_f32 v66, v146, v186
  v_fmac_f32 v67, v147, v186
  v_mul_f32 v192, v20, v187
  v_mul_f32 v193, v21, v187
  v_mul_f32 v194, v22, v187
  v_mul_f32 v195, v23, v187
  v_mul_f32 v196, v24, v187
  v_mul_f32 v197, v25, v187
  v_mul_f32 v198, v26, v187
  v_mul_f32 v199, v27, v187
  v_mul_f32 v200, v28, v187
  v_mul_f32 v201, v29, v187
  v_mul_f32 v202, v30, v187
  v_mul_f32 v203, v31, v187
  v_mul_f32 v204, v32, v187
  v_mul_f32 v205, v33, v187
  v_mul_f32 v206, v34, v187
  v_mul_f32 v207, v35, v187
  v_exp_f32 v192, v192
  v_exp_f32 v193, v193
  v_exp_f32 v194, v194
  v_exp_f32 v195, v195
  v_exp_f32 v196, v196
  v_exp_f32 v197, v197
  v_exp_f32 v198, v198
  v_exp_f32 v199, v199
  v_exp_f32 v200, v200
  v_exp_f32 v201, v201
  v_exp_f32 v202, v202
  v_exp_f32 v203, v203
  v_exp_f32 v204, v204
  v_exp_f32 v205, v205
  v_exp_f32 v206, v206
  v_exp_f32 v207, v207
  v_mul_f32 v20, v20, v52
  v_mul_f32 v21, v21, v53
  v_mul_f32 v22, v22, v54
  v_mul_f32 v23, v23, v55
  v_mul_f32 v24, v24, v56
  v_mul_f32 v25, v25, v57
  v_mul_f32 v26, v26, v58
  v_mul_f32 v27, v27, v59
  v_mul_f32 v28, v28, v60
  v_mul_f32 v29, v29, v61
  v_mul_f32 v30, v30, v62
  v_mul_f32 v31, v31, v63
  v_mul_f32 v32, v32, v64
  v_mul_f32 v33, v33, v65
  v_mul_f32 v34, v34, v66
  v_mul_f32 v35, v35, v67
  v_fma_f32 v192, v192, v189, v189
  v_fma_f32 v193, v193, v189, v189
  v_fma_f32 v194, v194, v189, v189
  v_fma_f32 v195, v195, v189, v189
  v_fma_f32 v196, v196, v189, v189
  v_fma_f32 v197, v197, v189, v189
  v_fma_f32 v198, v198, v189, v189
  v_fma_f32 v199, v199, v189, v189
  v_fma_f32 v200, v200, v189, v189
  v_fma_f32 v201, v201, v189, v189
  v_fma_f32 v202, v202, v189, v189
  v_fma_f32 v203, v203, v189, v189
  v_fma_f32 v204, v204, v189, v189
  v_fma_f32 v205, v205, v189, v189
  v_fma_f32 v206, v206, v189, v189
  v_fma_f32 v207, v207, v189, v189
  v_rcp_f32 v192, v192
  v_rcp_f32 v193, v193
  v_rcp_f32 v194, v194
  v_rcp_f32 v195, v195
  v_rcp_f32 v196, v196
  v_rcp_f32 v197, v197
  v_rcp_f32 v198, v198
  v_rcp_f32 v199, v199
  v_rcp_f32 v200, v200
  v_rcp_f32 v201, v201
  v_rcp_f32 v202, v202
  v_rcp_f32 v203, v203
  v_rcp_f32 v204, v204
  v_rcp_f32 v205, v205
  v_rcp_f32 v206, v206
  v_rcp_f32 v207, v207
  v_mul_f32 v20, v20, v192
  v_mul_f32 v21, v21, v193
  v_mul_f32 v22, v22, v194
  v_mul_f32 v23, v23, v195
  v_mul_f32 v24, v24, v196
  v_mul_f32 v25, v25, v197
  v_mul_f32 v26, v26, v198
  v_mul_f32 v27, v27, v199
  v_mul_f32 v28, v28, v200
  v_mul_f32 v29, v29, v201
  v_mul_f32 v30, v30, v202
  v_mul_f32 v31, v31, v203
  v_mul_f32 v32, v32, v204
  v_mul_f32 v33, v33, v205
  v_mul_f32 v34, v34, v206
  v_mul_f32 v35, v35, v207
  v_cvt_pk_bf16_f32 v216, v20, v21
  v_cvt_pk_bf16_f32 v217, v22, v23
  v_cvt_pk_bf16_f32 v218, v28, v29
  v_cvt_pk_bf16_f32 v219, v30, v31
  buffer_store_dwordx4 v[216:219], v2, s[52:55], s20 offen offset:0 sc1
  v_cvt_pk_bf16_f32 v220, v24, v25
  v_cvt_pk_bf16_f32 v221, v26, v27
  v_cvt_pk_bf16_f32 v222, v32, v33
  v_cvt_pk_bf16_f32 v223, v34, v35
  buffer_store_dwordx4 v[220:223], v2, s[52:55], s20 offen offset:512 sc1
  s_waitcnt vmcnt(2)
  v_fmac_f32 v36, v84, v186
  v_fmac_f32 v37, v85, v186
  v_fmac_f32 v38, v86, v186
  v_fmac_f32 v39, v87, v186
  v_fmac_f32 v40, v88, v186
  v_fmac_f32 v41, v89, v186
  v_fmac_f32 v42, v90, v186
  v_fmac_f32 v43, v91, v186
  v_fmac_f32 v44, v92, v186
  v_fmac_f32 v45, v93, v186
  v_fmac_f32 v46, v94, v186
  v_fmac_f32 v47, v95, v186
  v_fmac_f32 v48, v96, v186
  v_fmac_f32 v49, v97, v186
  v_fmac_f32 v50, v98, v186
  v_fmac_f32 v51, v99, v186
  v_fmac_f32 v68, v100, v186
  v_fmac_f32 v69, v101, v186
  v_fmac_f32 v70, v102, v186
  v_fmac_f32 v71, v103, v186
  v_fmac_f32 v72, v104, v186
  v_fmac_f32 v73, v105, v186
  v_fmac_f32 v74, v106, v186
  v_fmac_f32 v75, v107, v186
  v_fmac_f32 v76, v108, v186
  v_fmac_f32 v77, v109, v186
  v_fmac_f32 v78, v110, v186
  v_fmac_f32 v79, v111, v186
  v_fmac_f32 v80, v112, v186
  v_fmac_f32 v81, v113, v186
  v_fmac_f32 v82, v114, v186
  v_fmac_f32 v83, v115, v186
  v_mul_f32 v192, v36, v187
  v_mul_f32 v193, v37, v187
  v_mul_f32 v194, v38, v187
  v_mul_f32 v195, v39, v187
  v_mul_f32 v196, v40, v187
  v_mul_f32 v197, v41, v187
  v_mul_f32 v198, v42, v187
  v_mul_f32 v199, v43, v187
  v_mul_f32 v200, v44, v187
  v_mul_f32 v201, v45, v187
  v_mul_f32 v202, v46, v187
  v_mul_f32 v203, v47, v187
  v_mul_f32 v204, v48, v187
  v_mul_f32 v205, v49, v187
  v_mul_f32 v206, v50, v187
  v_mul_f32 v207, v51, v187
  v_exp_f32 v192, v192
  v_exp_f32 v193, v193
  v_exp_f32 v194, v194
  v_exp_f32 v195, v195
  v_exp_f32 v196, v196
  v_exp_f32 v197, v197
  v_exp_f32 v198, v198
  v_exp_f32 v199, v199
  v_exp_f32 v200, v200
  v_exp_f32 v201, v201
  v_exp_f32 v202, v202
  v_exp_f32 v203, v203
  v_exp_f32 v204, v204
  v_exp_f32 v205, v205
  v_exp_f32 v206, v206
  v_exp_f32 v207, v207
  v_mul_f32 v36, v36, v68
  v_mul_f32 v37, v37, v69
  v_mul_f32 v38, v38, v70
  v_mul_f32 v39, v39, v71
  v_mul_f32 v40, v40, v72
  v_mul_f32 v41, v41, v73
  v_mul_f32 v42, v42, v74
  v_mul_f32 v43, v43, v75
  v_mul_f32 v44, v44, v76
  v_mul_f32 v45, v45, v77
  v_mul_f32 v46, v46, v78
  v_mul_f32 v47, v47, v79
  v_mul_f32 v48, v48, v80
  v_mul_f32 v49, v49, v81
  v_mul_f32 v50, v50, v82
  v_mul_f32 v51, v51, v83
  v_fma_f32 v192, v192, v189, v189
  v_fma_f32 v193, v193, v189, v189
  v_fma_f32 v194, v194, v189, v189
  v_fma_f32 v195, v195, v189, v189
  v_fma_f32 v196, v196, v189, v189
  v_fma_f32 v197, v197, v189, v189
  v_fma_f32 v198, v198, v189, v189
  v_fma_f32 v199, v199, v189, v189
  v_fma_f32 v200, v200, v189, v189
  v_fma_f32 v201, v201, v189, v189
  v_fma_f32 v202, v202, v189, v189
  v_fma_f32 v203, v203, v189, v189
  v_fma_f32 v204, v204, v189, v189
  v_fma_f32 v205, v205, v189, v189
  v_fma_f32 v206, v206, v189, v189
  v_fma_f32 v207, v207, v189, v189
  v_rcp_f32 v192, v192
  v_rcp_f32 v193, v193
  v_rcp_f32 v194, v194
  v_rcp_f32 v195, v195
  v_rcp_f32 v196, v196
  v_rcp_f32 v197, v197
  v_rcp_f32 v198, v198
  v_rcp_f32 v199, v199
  v_rcp_f32 v200, v200
  v_rcp_f32 v201, v201
  v_rcp_f32 v202, v202
  v_rcp_f32 v203, v203
  v_rcp_f32 v204, v204
  v_rcp_f32 v205, v205
  v_rcp_f32 v206, v206
  v_rcp_f32 v207, v207
  v_mul_f32 v36, v36, v192
  v_mul_f32 v37, v37, v193
  v_mul_f32 v38, v38, v194
  v_mul_f32 v39, v39, v195
  v_mul_f32 v40, v40, v196
  v_mul_f32 v41, v41, v197
  v_mul_f32 v42, v42, v198
  v_mul_f32 v43, v43, v199
  v_mul_f32 v44, v44, v200
  v_mul_f32 v45, v45, v201
  v_mul_f32 v46, v46, v202
  v_mul_f32 v47, v47, v203
  v_mul_f32 v48, v48, v204
  v_mul_f32 v49, v49, v205
  v_mul_f32 v50, v50, v206
  v_mul_f32 v51, v51, v207
  v_cvt_pk_bf16_f32 v224, v36, v37
  v_cvt_pk_bf16_f32 v225, v38, v39
  v_cvt_pk_bf16_f32 v226, v44, v45
  v_cvt_pk_bf16_f32 v227, v46, v47
  buffer_store_dwordx4 v[224:227], v2, s[52:55], s20 offen offset:1024 sc1
  v_cvt_pk_bf16_f32 v228, v40, v41
  v_cvt_pk_bf16_f32 v229, v42, v43
  v_cvt_pk_bf16_f32 v230, v48, v49
  v_cvt_pk_bf16_f32 v231, v50, v51
  buffer_store_dwordx4 v[228:231], v2, s[52:55], s20 offen offset:1536 sc1
  s_waitcnt vmcnt(0)
  s_barrier
  s_cmp_lg_u32 s16, 0
  s_cbranch_scc1 L_ffn_kernel_nosig_9
  s_lshl_b32 s87, s17, 5
  s_add_u32 s87, s87, s18
  s_lshl_b32 s87, s87, 2
  s_add_u32 s87, s87, 3072
  s_mov_b64 exec, 1
  v_mov_b32 v4, 0
  v_mov_b32 v5, s100
  buffer_store_dword v5, v4, s[96:99], s87 offen sc1
  s_mov_b64 exec, -1
L_ffn_kernel_nosig_9:
L_ffn_kernel_done_1:
  s_endpgm
L_ffn_kernel_idle_2:
  v_and_b32 v1, 63, v0
  v_lshrrev_b32 v2, 6, v0
  s_nop 0
  v_readfirstlane_b32 s16, v2
  s_sub_u32 s21, s21, 27
  s_lshl_b32 s21, s21, 3
  s_add_u32 s21, s21, s16
  s_mul_i32 s20, s21, 55296
  v_lshlrev_b32 v3, 7, v1
  s_waitcnt lgkmcnt(0)
  s_add_u32 s8, s4, 21837824
  s_addc_u32 s9, s5, 0
  s_and_b32 s9, s9, 0xffff
  s_mov_b32 s10, 2211840
  s_mov_b32 s11, 0x20000
  s_mov_b32 s88, s92
  s_and_b32 s89, s93, 0xffff
  s_mov_b32 s90, 256
  s_mov_b32 s91, 0x20000
  s_add_u32 s96, s94, 24049664
  s_addc_u32 s97, s95, 0
  s_and_b32 s97, s97, 0xffff
  s_mov_b32 s98, 12288
  s_mov_b32 s99, 0x20000
  s_mov_b32 s87, 0x40000
  v_mov_b32 v5, 0
L_ffn_kernel_nonce_10:
  buffer_load_dword v6, v5, s[88:91], 0 offen sc1
  s_waitcnt vmcnt(0)
  v_readfirstlane_b32 s100, v6
  s_nop 3
  s_cmp_lg_u32 s100, 0
  s_cbranch_scc1 L_ffn_kernel_nonce_done_11
  s_sleep 1
  s_sub_u32 s87, s87, 1
  s_cmp_lg_u32 s87, 0
  s_cbranch_scc1 L_ffn_kernel_nonce_10
L_ffn_kernel_nonce_done_11:
  s_lshr_b32 s86, s20, 10
  s_add_u32 s86, s86, 960
  v_min_u32 v5, 53, v1
  v_add_u32 v5, s86, v5
  v_subrev_u32 v6, 2048, v5
  v_min_u32 v5, v5, v6
  v_lshlrev_b32 v5, 2, v5
  v_add_u32 v5, 4096, v5
  s_mov_b32 s87, 0x40000
L_ffn_kernel_poll_12:
  buffer_load_dword v6, v5, s[96:99], 0 offen sc1
  s_waitcnt vmcnt(0)
  v_cmp_ne_u32 vcc, s100, v6
  s_nop 4
  s_cbranch_vccz L_ffn_kernel_poll_done_13
  s_sleep 1
  s_sub_u32 s87, s87, 1
  s_cmp_lg_u32 s87, 0
  s_cbranch_scc1 L_ffn_kernel_poll_12
L_ffn_kernel_poll_done_13:
  buffer_load_dword v4, v3, s[8:11], s20 offen
  s_add_u32 s20, s20, 8192
  buffer_load_dword v4, v3, s[8:11], s20 offen
  s_add_u32 s20, s20, 8192
  buffer_load_dword v4, v3, s[8:11], s20 offen
  s_add_u32 s20, s20, 8192
  buffer_load_dword v4, v3, s[8:11], s20 offen
  s_add_u32 s20, s20, 8192
  buffer_load_dword v4, v3, s[8:11], s20 offen
  s_add_u32 s20, s20, 8192
  buffer_load_dword v4, v3, s[8:11], s20 offen
  s_add_u32 s20, s20, 8192
  v_min_u32 v3, 6016, v3
  buffer_load_dword v4, v3, s[8:11], s20 offen
  s_waitcnt vmcnt(0)
  s_endpgm
ffn_kernel_end:

.p2align 8
down_kernel:
  s_load_dwordx2 s[4:5], s[0:1], 72
  s_load_dwordx2 s[28:29], s[0:1], 56
  s_load_dwordx4 s[92:95], s[0:1], 64
  s_and_b32 s20, s2, 7
  s_lshr_b32 s21, s2, 3
  s_lshl_b32 s22, s20, 2
  s_and_b32 s23, s21, 3
  s_add_u32 s17, s22, s23
  s_lshr_b32 s18, s21, 2
  v_and_b32 v1, 63, v0
  v_lshrrev_b32 v2, 6, v0
  v_lshlrev_b32 v10, 4, v1
  v_readfirstlane_b32 s16, v2
  s_and_b32 s19, s16, 3
  s_lshr_b32 s27, s16, 2
  s_lshl_b32 s20, s17, 2
  s_add_u32 s20, s20, s19
  s_mul_i32 s24, s20, 55296
  s_mul_i32 s20, s27, 27648
  s_add_u32 s24, s24, s20
  s_mul_i32 s25, s18, 276480
  s_mul_i32 s20, s27, 138240
  s_add_u32 s25, s25, s20
  s_mul_i32 s21, s19, 5120
  s_add_u32 s25, s25, s21
  s_mul_i32 s22, s27, 81920
  s_add_u32 s26, s22, s21
  v_add_u32 v11, s22, v10
  v_add_u32 v12, 40960, v11
  s_waitcnt lgkmcnt(0)
  s_add_u32 s8, s4, 13762560
  s_addc_u32 s9, s5, 0
  s_and_b32 s9, s9, 0xffff
  s_mov_b32 s10, 7077888
  s_mov_b32 s11, 0x20000
  s_add_u32 s12, s4, 21837824
  s_addc_u32 s13, s5, 0
  s_and_b32 s13, s13, 0xffff
  s_mov_b32 s14, 2211840
  s_mov_b32 s15, 0x20000
  s_mov_b32 s88, s92
  s_and_b32 s89, s93, 0xffff
  s_mov_b32 s90, 256
  s_mov_b32 s91, 0x20000
  s_add_u32 s96, s94, 24049664
  s_addc_u32 s97, s95, 0
  s_and_b32 s97, s97, 0xffff
  s_mov_b32 s98, 12288
  s_mov_b32 s99, 0x20000
  s_mul_i32 s86, s18, 270
  s_add_u32 s86, s86, 960
  v_add_u32 v92, 0, v1
  v_min_u32 v92, 269, v92
  v_add_u32 v92, s86, v92
  v_subrev_u32 v2, 2048, v92
  v_min_u32 v92, v92, v2
  v_lshlrev_b32 v92, 2, v92
  v_add_u32 v92, 4096, v92
  v_add_u32 v93, 64, v1
  v_min_u32 v93, 269, v93
  v_add_u32 v93, s86, v93
  v_subrev_u32 v2, 2048, v93
  v_min_u32 v93, v93, v2
  v_lshlrev_b32 v93, 2, v93
  v_add_u32 v93, 4096, v93
  v_add_u32 v94, 128, v1
  v_min_u32 v94, 269, v94
  v_add_u32 v94, s86, v94
  v_subrev_u32 v2, 2048, v94
  v_min_u32 v94, v94, v2
  v_lshlrev_b32 v94, 2, v94
  v_add_u32 v94, 4096, v94
  v_add_u32 v95, 192, v1
  v_min_u32 v95, 269, v95
  v_add_u32 v95, s86, v95
  v_subrev_u32 v2, 2048, v95
  v_min_u32 v95, v95, v2
  v_lshlrev_b32 v95, 2, v95
  v_add_u32 v95, 4096, v95
  v_add_u32 v96, 256, v1
  v_min_u32 v96, 269, v96
  v_add_u32 v96, s86, v96
  v_subrev_u32 v2, 2048, v96
  v_min_u32 v96, v96, v2
  v_lshlrev_b32 v96, 2, v96
  v_add_u32 v96, 4096, v96
  s_lshr_b32 s86, s17, 2
  s_lshl_b32 s86, s86, 5
  v_mov_b32 v101, 0
  v_min_u32 v100, 26, v1
  v_add_u32 v100, s86, v100
  v_lshlrev_b32 v100, 2, v100
  v_add_u32 v100, 3072, v100
  s_cmp_lg_u32 s16, 0
  s_cbranch_scc1 L_down_kernel_nop0_2
  buffer_load_dword v120, v101, s[88:91], 0 offen sc1
  buffer_load_dword v121, v100, s[96:99], 0 offen sc1
L_down_kernel_nop0_2:
  buffer_load_dword v112, v101, s[88:91], 0 offen sc1
  buffer_load_dword v113, v92, s[96:99], 0 offen sc1
  buffer_load_dword v114, v93, s[96:99], 0 offen sc1
  buffer_load_dword v115, v94, s[96:99], 0 offen sc1
  buffer_load_dword v116, v95, s[96:99], 0 offen sc1
  buffer_load_dword v117, v96, s[96:99], 0 offen sc1
  s_mov_b32 s87, 0x40000
  s_waitcnt vmcnt(0)
  s_branch L_down_kernel_poll_chk_4
L_down_kernel_poll_3:
  s_sleep 1
  buffer_load_dword v112, v101, s[88:91], 0 offen sc1
  buffer_load_dword v113, v92, s[96:99], 0 offen sc1
  buffer_load_dword v114, v93, s[96:99], 0 offen sc1
  buffer_load_dword v115, v94, s[96:99], 0 offen sc1
  buffer_load_dword v116, v95, s[96:99], 0 offen sc1
  buffer_load_dword v117, v96, s[96:99], 0 offen sc1
  s_waitcnt vmcnt(0)
L_down_kernel_poll_chk_4:
  v_readfirstlane_b32 s100, v112
  s_nop 3
  v_cmp_eq_u32 vcc, 0, v112
  v_cmp_ne_u32 s[94:95], s100, v113
  s_nop 3
  s_or_b64 vcc, vcc, s[94:95]
  v_cmp_ne_u32 s[94:95], s100, v114
  s_nop 3
  s_or_b64 vcc, vcc, s[94:95]
  v_cmp_ne_u32 s[94:95], s100, v115
  s_nop 3
  s_or_b64 vcc, vcc, s[94:95]
  v_cmp_ne_u32 s[94:95], s100, v116
  s_nop 3
  s_or_b64 vcc, vcc, s[94:95]
  v_cmp_ne_u32 s[94:95], s100, v117
  s_nop 3
  s_or_b64 vcc, vcc, s[94:95]
  s_nop 4
  s_cbranch_vccz L_down_kernel_poll_done_5
  s_sub_u32 s87, s87, 1
  s_cmp_lg_u32 s87, 0
  s_cbranch_scc1 L_down_kernel_poll_3
L_down_kernel_poll_done_5:
  s_add_u32 m0, s26, 0
  s_add_u32 s20, s25, 0
  buffer_load_dwordx4 v10, s[12:15], s20 offen offset:0 lds
  buffer_load_dwordx4 v10, s[12:15], s20 offen offset:1024 lds
  buffer_load_dwordx4 v10, s[12:15], s20 offen offset:2048 lds
  buffer_load_dwordx4 v10, s[12:15], s20 offen offset:3072 lds
  s_add_u32 m0, s26, 4096
  s_add_u32 s21, s25, 4096
  buffer_load_dwordx4 v10, s[12:15], s21 offen lds
  s_add_u32 m0, s26, 20480
  s_add_u32 s20, s25, 20480
  buffer_load_dwordx4 v10, s[12:15], s20 offen offset:0 lds
  buffer_load_dwordx4 v10, s[12:15], s20 offen offset:1024 lds
  buffer_load_dwordx4 v10, s[12:15], s20 offen offset:2048 lds
  buffer_load_dwordx4 v10, s[12:15], s20 offen offset:3072 lds
  s_add_u32 m0, s26, 24576
  s_add_u32 s21, s25, 24576
  buffer_load_dwordx4 v10, s[12:15], s21 offen lds
  v_and_b32 v6, 15, v1
  v_lshrrev_b32 v7, 4, v1
  s_lshl_b32 s20, s17, 6
  s_lshl_b32 s21, s19, 4
  s_add_u32 s20, s20, s21
  v_add_u32 v6, s20, v6
  v_lshrrev_b32 v2, 5, v6
  v_mul_u32_u24 v8, 40960, v2
  v_and_b32 v2, 31, v6
  v_lshl_add_u32 v8, v2, 4, v8
  v_lshrrev_b32 v2, 1, v7
  v_lshl_add_u32 v8, v2, 9, v8
  v_and_b32 v2, 1, v7
  v_lshl_add_u32 v8, v2, 3, v8
  v_mul_u32_u24 v9, 1280, v6
  v_lshl_add_u32 v9, v7, 3, v9
  s_add_u32 s32, s4, 11010048
  s_addc_u32 s33, s5, 0
  s_and_b32 s33, s33, 0xffff
  s_mov_b32 s34, 2621440
  s_mov_b32 s35, 0x20000
  s_mov_b32 s36, s28
  s_and_b32 s37, s29, 0xffff
  s_mov_b32 s38, 2621440
  s_mov_b32 s39, 0x20000
  s_mul_i32 s40, s18, 5120
  s_mul_i32 s41, s18, 160
  s_add_u32 s42, s40, 4096
  s_cmp_lg_u32 s16, 0
  s_cbranch_scc1 L_down_kernel_nop1_6
  s_mov_b32 s87, 0x40000
  s_waitcnt vmcnt(10)
  s_branch L_down_kernel_poll_chk_8
L_down_kernel_poll_7:
  s_sleep 1
  buffer_load_dword v120, v101, s[88:91], 0 offen sc1
  buffer_load_dword v121, v100, s[96:99], 0 offen sc1
  s_waitcnt vmcnt(0)
L_down_kernel_poll_chk_8:
  v_readfirstlane_b32 s100, v120
  s_nop 3
  v_cmp_eq_u32 vcc, 0, v120
  v_cmp_ne_u32 s[94:95], s100, v121
  s_nop 3
  s_or_b64 vcc, vcc, s[94:95]
  s_nop 4
  s_cbranch_vccz L_down_kernel_poll_done_9
  s_sub_u32 s87, s87, 1
  s_cmp_lg_u32 s87, 0
  s_cbranch_scc1 L_down_kernel_poll_7
L_down_kernel_poll_done_9:
L_down_kernel_nop1_6:
  s_barrier
  s_add_u32 s22, s24, 0
  buffer_load_dwordx4 v[44:47], v10, s[8:11], s22 offen offset:0
  buffer_load_dwordx4 v[48:51], v10, s[8:11], s22 offen offset:1024
  buffer_load_dwordx4 v[52:55], v10, s[8:11], s22 offen offset:2048
  buffer_load_dwordx4 v[56:59], v10, s[8:11], s22 offen offset:3072
  s_add_u32 s22, s24, 4096
  buffer_load_dwordx4 v[60:63], v10, s[8:11], s22 offen offset:0
  buffer_load_dwordx4 v[64:67], v10, s[8:11], s22 offen offset:1024
  buffer_load_dwordx4 v[68:71], v10, s[8:11], s22 offen offset:2048
  buffer_load_dwordx4 v[72:75], v10, s[8:11], s22 offen offset:3072
  s_waitcnt vmcnt(4) lgkmcnt(0)
  s_barrier
  ds_read_b128 v[92:95], v11 offset:0
  ds_read_b128 v[96:99], v11 offset:1024
  ds_read_b128 v[100:103], v11 offset:2048
  ds_read_b128 v[104:107], v11 offset:3072
  ds_read_b128 v[108:111], v11 offset:4096
  s_waitcnt lgkmcnt(4)
  v_mfma_f32_16x16x32_bf16 v[24:27], v[92:95], v[44:47], 0
  ds_read_b128 v[112:115], v11 offset:5120
  s_add_u32 s22, s24, 8192
  buffer_load_dwordx4 v[76:79], v10, s[8:11], s22 offen offset:0
  s_waitcnt lgkmcnt(4)
  v_mfma_f32_16x16x32_bf16 v[28:31], v[96:99], v[44:47], 0
  ds_read_b128 v[116:119], v11 offset:6144
  buffer_load_dwordx4 v[80:83], v10, s[8:11], s22 offen offset:1024
  s_waitcnt lgkmcnt(4)
  v_mfma_f32_16x16x32_bf16 v[32:35], v[100:103], v[44:47], 0
  ds_read_b128 v[120:123], v11 offset:7168
  buffer_load_dwordx4 v[84:87], v10, s[8:11], s22 offen offset:2048
  s_waitcnt lgkmcnt(4)
  v_mfma_f32_16x16x32_bf16 v[36:39], v[104:107], v[44:47], 0
  ds_read_b128 v[124:127], v11 offset:8192
  buffer_load_dwordx4 v[88:91], v10, s[8:11], s22 offen offset:3072
  s_waitcnt lgkmcnt(4)
  v_mfma_f32_16x16x32_bf16 v[40:43], v[108:111], v[44:47], 0
  ds_read_b128 v[128:131], v11 offset:9216
  s_waitcnt lgkmcnt(4)
  v_mfma_f32_16x16x32_bf16 v[24:27], v[112:115], v[48:51], v[24:27]
  ds_read_b128 v[92:95], v11 offset:10240
  s_add_u32 m0, s26, 40960
  s_add_u32 s20, s25, 40960
  buffer_load_dwordx4 v10, s[12:15], s20 offen offset:0 lds
  s_waitcnt lgkmcnt(4)
  v_mfma_f32_16x16x32_bf16 v[28:31], v[116:119], v[48:51], v[28:31]
  ds_read_b128 v[96:99], v11 offset:11264
  buffer_load_dwordx4 v10, s[12:15], s20 offen offset:1024 lds
  s_waitcnt lgkmcnt(4)
  v_mfma_f32_16x16x32_bf16 v[32:35], v[120:123], v[48:51], v[32:35]
  ds_read_b128 v[100:103], v11 offset:12288
  buffer_load_dwordx4 v10, s[12:15], s20 offen offset:2048 lds
  s_waitcnt lgkmcnt(4)
  v_mfma_f32_16x16x32_bf16 v[36:39], v[124:127], v[48:51], v[36:39]
  ds_read_b128 v[104:107], v11 offset:13312
  buffer_load_dwordx4 v10, s[12:15], s20 offen offset:3072 lds
  s_waitcnt lgkmcnt(4)
  v_mfma_f32_16x16x32_bf16 v[40:43], v[128:131], v[48:51], v[40:43]
  ds_read_b128 v[108:111], v11 offset:14336
  s_waitcnt lgkmcnt(4)
  v_mfma_f32_16x16x32_bf16 v[24:27], v[92:95], v[52:55], v[24:27]
  ds_read_b128 v[112:115], v11 offset:15360
  s_add_u32 m0, s26, 45056
  s_add_u32 s21, s25, 45056
  buffer_load_dwordx4 v10, s[12:15], s21 offen lds
  s_waitcnt lgkmcnt(4)
  v_mfma_f32_16x16x32_bf16 v[28:31], v[96:99], v[52:55], v[28:31]
  ds_read_b128 v[116:119], v11 offset:16384
  s_add_u32 m0, s26, 61440
  s_add_u32 s20, s25, 61440
  buffer_load_dwordx4 v10, s[12:15], s20 offen offset:0 lds
  s_waitcnt lgkmcnt(4)
  v_mfma_f32_16x16x32_bf16 v[32:35], v[100:103], v[52:55], v[32:35]
  ds_read_b128 v[120:123], v11 offset:17408
  buffer_load_dwordx4 v10, s[12:15], s20 offen offset:1024 lds
  s_waitcnt lgkmcnt(4)
  v_mfma_f32_16x16x32_bf16 v[36:39], v[104:107], v[52:55], v[36:39]
  ds_read_b128 v[124:127], v11 offset:18432
  buffer_load_dwordx4 v10, s[12:15], s20 offen offset:2048 lds
  s_waitcnt lgkmcnt(4)
  v_mfma_f32_16x16x32_bf16 v[40:43], v[108:111], v[52:55], v[40:43]
  ds_read_b128 v[128:131], v11 offset:19456
  s_waitcnt vmcnt(12) lgkmcnt(0)
  s_barrier
  s_waitcnt lgkmcnt(4)
  v_mfma_f32_16x16x32_bf16 v[24:27], v[112:115], v[56:59], v[24:27]
  ds_read_b128 v[92:95], v11 offset:20480
  buffer_load_dwordx4 v10, s[12:15], s20 offen offset:3072 lds
  s_waitcnt lgkmcnt(4)
  v_mfma_f32_16x16x32_bf16 v[28:31], v[116:119], v[56:59], v[28:31]
  ds_read_b128 v[96:99], v11 offset:21504
  s_add_u32 m0, s26, 65536
  s_add_u32 s21, s25, 65536
  buffer_load_dwordx4 v10, s[12:15], s21 offen lds
  s_waitcnt lgkmcnt(4)
  v_mfma_f32_16x16x32_bf16 v[32:35], v[120:123], v[56:59], v[32:35]
  ds_read_b128 v[100:103], v11 offset:22528
  s_waitcnt lgkmcnt(4)
  v_mfma_f32_16x16x32_bf16 v[36:39], v[124:127], v[56:59], v[36:39]
  ds_read_b128 v[104:107], v11 offset:23552
  s_waitcnt lgkmcnt(4)
  v_mfma_f32_16x16x32_bf16 v[40:43], v[128:131], v[56:59], v[40:43]
  ds_read_b128 v[108:111], v11 offset:24576
  s_waitcnt lgkmcnt(4)
  v_mfma_f32_16x16x32_bf16 v[24:27], v[92:95], v[60:63], v[24:27]
  ds_read_b128 v[112:115], v11 offset:25600
  s_add_u32 s22, s24, 12288
  buffer_load_dwordx4 v[44:47], v10, s[8:11], s22 offen offset:0
  s_waitcnt lgkmcnt(4)
  v_mfma_f32_16x16x32_bf16 v[28:31], v[96:99], v[60:63], v[28:31]
  ds_read_b128 v[116:119], v11 offset:26624
  buffer_load_dwordx4 v[48:51], v10, s[8:11], s22 offen offset:1024
  s_waitcnt lgkmcnt(4)
  v_mfma_f32_16x16x32_bf16 v[32:35], v[100:103], v[60:63], v[32:35]
  ds_read_b128 v[120:123], v11 offset:27648
  buffer_load_dwordx4 v[52:55], v10, s[8:11], s22 offen offset:2048
  s_waitcnt lgkmcnt(4)
  v_mfma_f32_16x16x32_bf16 v[36:39], v[104:107], v[60:63], v[36:39]
  ds_read_b128 v[124:127], v11 offset:28672
  s_waitcnt lgkmcnt(4)
  v_mfma_f32_16x16x32_bf16 v[40:43], v[108:111], v[60:63], v[40:43]
  ds_read_b128 v[128:131], v11 offset:29696
  s_waitcnt lgkmcnt(4)
  v_mfma_f32_16x16x32_bf16 v[24:27], v[112:115], v[64:67], v[24:27]
  ds_read_b128 v[92:95], v11 offset:30720
  buffer_load_dwordx4 v[56:59], v10, s[8:11], s22 offen offset:3072
  s_waitcnt lgkmcnt(4)
  v_mfma_f32_16x16x32_bf16 v[28:31], v[116:119], v[64:67], v[28:31]
  ds_read_b128 v[96:99], v11 offset:31744
  s_add_u32 m0, s26, 0
  s_add_u32 s20, s25, 81920
  buffer_load_dwordx4 v10, s[12:15], s20 offen offset:0 lds
  s_waitcnt lgkmcnt(4)
  v_mfma_f32_16x16x32_bf16 v[32:35], v[120:123], v[64:67], v[32:35]
  ds_read_b128 v[100:103], v11 offset:32768
  buffer_load_dwordx4 v10, s[12:15], s20 offen offset:1024 lds
  s_waitcnt lgkmcnt(4)
  v_mfma_f32_16x16x32_bf16 v[36:39], v[124:127], v[64:67], v[36:39]
  ds_read_b128 v[104:107], v11 offset:33792
  s_waitcnt lgkmcnt(4)
  v_mfma_f32_16x16x32_bf16 v[40:43], v[128:131], v[64:67], v[40:43]
  ds_read_b128 v[108:111], v11 offset:34816
  s_waitcnt lgkmcnt(4)
  v_mfma_f32_16x16x32_bf16 v[24:27], v[92:95], v[68:71], v[24:27]
  ds_read_b128 v[112:115], v11 offset:35840
  buffer_load_dwordx4 v10, s[12:15], s20 offen offset:2048 lds
  s_waitcnt lgkmcnt(4)
  v_mfma_f32_16x16x32_bf16 v[28:31], v[96:99], v[68:71], v[28:31]
  ds_read_b128 v[116:119], v11 offset:36864
  buffer_load_dwordx4 v10, s[12:15], s20 offen offset:3072 lds
  s_waitcnt lgkmcnt(4)
  v_mfma_f32_16x16x32_bf16 v[32:35], v[100:103], v[68:71], v[32:35]
  ds_read_b128 v[120:123], v11 offset:37888
  s_add_u32 m0, s26, 4096
  s_add_u32 s21, s25, 86016
  buffer_load_dwordx4 v10, s[12:15], s21 offen lds
  s_waitcnt lgkmcnt(4)
  v_mfma_f32_16x16x32_bf16 v[36:39], v[104:107], v[68:71], v[36:39]
  ds_read_b128 v[124:127], v11 offset:38912
  s_waitcnt lgkmcnt(4)
  v_mfma_f32_16x16x32_bf16 v[40:43], v[108:111], v[68:71], v[40:43]
  ds_read_b128 v[128:131], v11 offset:39936
  s_waitcnt vmcnt(14) lgkmcnt(0)
  s_barrier
  s_waitcnt lgkmcnt(4)
  v_mfma_f32_16x16x32_bf16 v[24:27], v[112:115], v[72:75], v[24:27]
  ds_read_b128 v[92:95], v12 offset:0
  s_waitcnt lgkmcnt(4)
  v_mfma_f32_16x16x32_bf16 v[28:31], v[116:119], v[72:75], v[28:31]
  ds_read_b128 v[96:99], v12 offset:1024
  s_waitcnt lgkmcnt(4)
  v_mfma_f32_16x16x32_bf16 v[32:35], v[120:123], v[72:75], v[32:35]
  ds_read_b128 v[100:103], v12 offset:2048
  s_waitcnt lgkmcnt(4)
  v_mfma_f32_16x16x32_bf16 v[36:39], v[124:127], v[72:75], v[36:39]
  ds_read_b128 v[104:107], v12 offset:3072
  s_waitcnt lgkmcnt(4)
  v_mfma_f32_16x16x32_bf16 v[40:43], v[128:131], v[72:75], v[40:43]
  ds_read_b128 v[108:111], v12 offset:4096
  s_waitcnt lgkmcnt(4)
  v_mfma_f32_16x16x32_bf16 v[24:27], v[92:95], v[76:79], v[24:27]
  ds_read_b128 v[112:115], v12 offset:5120
  s_add_u32 s22, s24, 16384
  buffer_load_dwordx4 v[60:63], v10, s[8:11], s22 offen offset:0
  s_waitcnt lgkmcnt(4)
  v_mfma_f32_16x16x32_bf16 v[28:31], v[96:99], v[76:79], v[28:31]
  ds_read_b128 v[116:119], v12 offset:6144
  buffer_load_dwordx4 v[64:67], v10, s[8:11], s22 offen offset:1024
  s_waitcnt lgkmcnt(4)
  v_mfma_f32_16x16x32_bf16 v[32:35], v[100:103], v[76:79], v[32:35]
  ds_read_b128 v[120:123], v12 offset:7168
  buffer_load_dwordx4 v[68:71], v10, s[8:11], s22 offen offset:2048
  s_waitcnt lgkmcnt(4)
  v_mfma_f32_16x16x32_bf16 v[36:39], v[104:107], v[76:79], v[36:39]
  ds_read_b128 v[124:127], v12 offset:8192
  s_waitcnt lgkmcnt(4)
  v_mfma_f32_16x16x32_bf16 v[40:43], v[108:111], v[76:79], v[40:43]
  ds_read_b128 v[128:131], v12 offset:9216
  s_waitcnt lgkmcnt(4)
  v_mfma_f32_16x16x32_bf16 v[24:27], v[112:115], v[80:83], v[24:27]
  ds_read_b128 v[92:95], v12 offset:10240
  buffer_load_dwordx4 v[72:75], v10, s[8:11], s22 offen offset:3072
  s_waitcnt lgkmcnt(4)
  v_mfma_f32_16x16x32_bf16 v[28:31], v[116:119], v[80:83], v[28:31]
  ds_read_b128 v[96:99], v12 offset:11264
  s_add_u32 m0, s26, 20480
  s_add_u32 s20, s25, 102400
  buffer_load_dwordx4 v10, s[12:15], s20 offen offset:0 lds
  s_waitcnt lgkmcnt(4)
  v_mfma_f32_16x16x32_bf16 v[32:35], v[120:123], v[80:83], v[32:35]
  ds_read_b128 v[100:103], v12 offset:12288
  buffer_load_dwordx4 v10, s[12:15], s20 offen offset:1024 lds
  s_waitcnt lgkmcnt(4)
  v_mfma_f32_16x16x32_bf16 v[36:39], v[124:127], v[80:83], v[36:39]
  ds_read_b128 v[104:107], v12 offset:13312
  s_waitcnt lgkmcnt(4)
  v_mfma_f32_16x16x32_bf16 v[40:43], v[128:131], v[80:83], v[40:43]
  ds_read_b128 v[108:111], v12 offset:14336
  s_waitcnt lgkmcnt(4)
  v_mfma_f32_16x16x32_bf16 v[24:27], v[92:95], v[84:87], v[24:27]
  ds_read_b128 v[112:115], v12 offset:15360
  buffer_load_dwordx4 v10, s[12:15], s20 offen offset:2048 lds
  s_waitcnt lgkmcnt(4)
  v_mfma_f32_16x16x32_bf16 v[28:31], v[96:99], v[84:87], v[28:31]
  ds_read_b128 v[116:119], v12 offset:16384
  buffer_load_dwordx4 v10, s[12:15], s20 offen offset:3072 lds
  s_waitcnt lgkmcnt(4)
  v_mfma_f32_16x16x32_bf16 v[32:35], v[100:103], v[84:87], v[32:35]
  ds_read_b128 v[120:123], v12 offset:17408
  s_add_u32 m0, s26, 24576
  s_add_u32 s21, s25, 106496
  buffer_load_dwordx4 v10, s[12:15], s21 offen lds
  s_waitcnt lgkmcnt(4)
  v_mfma_f32_16x16x32_bf16 v[36:39], v[104:107], v[84:87], v[36:39]
  ds_read_b128 v[124:127], v12 offset:18432
  s_waitcnt lgkmcnt(4)
  v_mfma_f32_16x16x32_bf16 v[40:43], v[108:111], v[84:87], v[40:43]
  ds_read_b128 v[128:131], v12 offset:19456
  s_waitcnt vmcnt(14) lgkmcnt(0)
  s_barrier
  s_waitcnt lgkmcnt(4)
  v_mfma_f32_16x16x32_bf16 v[24:27], v[112:115], v[88:91], v[24:27]
  ds_read_b128 v[92:95], v12 offset:20480
  s_waitcnt lgkmcnt(4)
  v_mfma_f32_16x16x32_bf16 v[28:31], v[116:119], v[88:91], v[28:31]
  ds_read_b128 v[96:99], v12 offset:21504
  s_waitcnt lgkmcnt(4)
  v_mfma_f32_16x16x32_bf16 v[32:35], v[120:123], v[88:91], v[32:35]
  ds_read_b128 v[100:103], v12 offset:22528
  s_waitcnt lgkmcnt(4)
  v_mfma_f32_16x16x32_bf16 v[36:39], v[124:127], v[88:91], v[36:39]
  ds_read_b128 v[104:107], v12 offset:23552
  s_waitcnt lgkmcnt(4)
  v_mfma_f32_16x16x32_bf16 v[40:43], v[128:131], v[88:91], v[40:43]
  ds_read_b128 v[108:111], v12 offset:24576
  s_waitcnt lgkmcnt(4)
  v_mfma_f32_16x16x32_bf16 v[24:27], v[92:95], v[44:47], v[24:27]
  ds_read_b128 v[112:115], v12 offset:25600
  s_add_u32 s22, s24, 20480
  buffer_load_dwordx4 v[76:79], v10, s[8:11], s22 offen offset:0
  s_waitcnt lgkmcnt(4)
  v_mfma_f32_16x16x32_bf16 v[28:31], v[96:99], v[44:47], v[28:31]
  ds_read_b128 v[116:119], v12 offset:26624
  buffer_load_dwordx4 v[80:83], v10, s[8:11], s22 offen offset:1024
  s_waitcnt lgkmcnt(4)
  v_mfma_f32_16x16x32_bf16 v[32:35], v[100:103], v[44:47], v[32:35]
  ds_read_b128 v[120:123], v12 offset:27648
  buffer_load_dwordx4 v[84:87], v10, s[8:11], s22 offen offset:2048
  s_waitcnt lgkmcnt(4)
  v_mfma_f32_16x16x32_bf16 v[36:39], v[104:107], v[44:47], v[36:39]
  ds_read_b128 v[124:127], v12 offset:28672
  s_waitcnt lgkmcnt(4)
  v_mfma_f32_16x16x32_bf16 v[40:43], v[108:111], v[44:47], v[40:43]
  ds_read_b128 v[128:131], v12 offset:29696
  s_waitcnt lgkmcnt(4)
  v_mfma_f32_16x16x32_bf16 v[24:27], v[112:115], v[48:51], v[24:27]
  ds_read_b128 v[92:95], v12 offset:30720
  buffer_load_dwordx4 v[88:91], v10, s[8:11], s22 offen offset:3072
  s_waitcnt lgkmcnt(4)
  v_mfma_f32_16x16x32_bf16 v[28:31], v[116:119], v[48:51], v[28:31]
  ds_read_b128 v[96:99], v12 offset:31744
  s_add_u32 m0, s26, 40960
  s_add_u32 s20, s25, 122880
  buffer_load_dwordx4 v10, s[12:15], s20 offen offset:0 lds
  s_waitcnt lgkmcnt(4)
  v_mfma_f32_16x16x32_bf16 v[32:35], v[120:123], v[48:51], v[32:35]
  ds_read_b128 v[100:103], v12 offset:32768
  buffer_load_dwordx4 v10, s[12:15], s20 offen offset:1024 lds
  s_waitcnt lgkmcnt(4)
  v_mfma_f32_16x16x32_bf16 v[36:39], v[124:127], v[48:51], v[36:39]
  ds_read_b128 v[104:107], v12 offset:33792
  s_waitcnt lgkmcnt(4)
  v_mfma_f32_16x16x32_bf16 v[40:43], v[128:131], v[48:51], v[40:43]
  ds_read_b128 v[108:111], v12 offset:34816
  s_waitcnt lgkmcnt(4)
  v_mfma_f32_16x16x32_bf16 v[24:27], v[92:95], v[52:55], v[24:27]
  ds_read_b128 v[112:115], v12 offset:35840
  buffer_load_dwordx4 v10, s[12:15], s20 offen offset:2048 lds
  s_waitcnt lgkmcnt(4)
  v_mfma_f32_16x16x32_bf16 v[28:31], v[96:99], v[52:55], v[28:31]
  ds_read_b128 v[116:119], v12 offset:36864
  buffer_load_dwordx4 v10, s[12:15], s20 offen offset:3072 lds
  s_waitcnt lgkmcnt(4)
  v_mfma_f32_16x16x32_bf16 v[32:35], v[100:103], v[52:55], v[32:35]
  ds_read_b128 v[120:123], v12 offset:37888
  s_add_u32 m0, s26, 45056
  s_add_u32 s21, s25, 126976
  buffer_load_dwordx4 v10, s[12:15], s21 offen lds
  s_waitcnt lgkmcnt(4)
  v_mfma_f32_16x16x32_bf16 v[36:39], v[104:107], v[52:55], v[36:39]
  ds_read_b128 v[124:127], v12 offset:38912
  s_waitcnt lgkmcnt(4)
  v_mfma_f32_16x16x32_bf16 v[40:43], v[108:111], v[52:55], v[40:43]
  ds_read_b128 v[128:131], v12 offset:39936
  s_waitcnt vmcnt(14) lgkmcnt(0)
  s_barrier
  s_waitcnt lgkmcnt(4)
  v_mfma_f32_16x16x32_bf16 v[24:27], v[112:115], v[56:59], v[24:27]
  ds_read_b128 v[92:95], v11 offset:0
  s_waitcnt lgkmcnt(4)
  v_mfma_f32_16x16x32_bf16 v[28:31], v[116:119], v[56:59], v[28:31]
  ds_read_b128 v[96:99], v11 offset:1024
  s_waitcnt lgkmcnt(4)
  v_mfma_f32_16x16x32_bf16 v[32:35], v[120:123], v[56:59], v[32:35]
  ds_read_b128 v[100:103], v11 offset:2048
  s_waitcnt lgkmcnt(4)
  v_mfma_f32_16x16x32_bf16 v[36:39], v[124:127], v[56:59], v[36:39]
  ds_read_b128 v[104:107], v11 offset:3072
  s_waitcnt lgkmcnt(4)
  v_mfma_f32_16x16x32_bf16 v[40:43], v[128:131], v[56:59], v[40:43]
  ds_read_b128 v[108:111], v11 offset:4096
  s_waitcnt lgkmcnt(4)
  v_mfma_f32_16x16x32_bf16 v[24:27], v[92:95], v[60:63], v[24:27]
  ds_read_b128 v[112:115], v11 offset:5120
  s_add_u32 s22, s24, 24576
  buffer_load_dwordx4 v[44:47], v10, s[8:11], s22 offen offset:0
  s_waitcnt lgkmcnt(4)
  v_mfma_f32_16x16x32_bf16 v[28:31], v[96:99], v[60:63], v[28:31]
  ds_read_b128 v[116:119], v11 offset:6144
  s_waitcnt lgkmcnt(4)
  v_mfma_f32_16x16x32_bf16 v[32:35], v[100:103], v[60:63], v[32:35]
  ds_read_b128 v[120:123], v11 offset:7168
  s_waitcnt lgkmcnt(4)
  v_mfma_f32_16x16x32_bf16 v[36:39], v[104:107], v[60:63], v[36:39]
  ds_read_b128 v[124:127], v11 offset:8192
  s_waitcnt lgkmcnt(4)
  v_mfma_f32_16x16x32_bf16 v[40:43], v[108:111], v[60:63], v[40:43]
  ds_read_b128 v[128:131], v11 offset:9216
  s_waitcnt lgkmcnt(4)
  v_mfma_f32_16x16x32_bf16 v[24:27], v[112:115], v[64:67], v[24:27]
  ds_read_b128 v[92:95], v11 offset:10240
  buffer_load_dwordx4 v[48:51], v10, s[8:11], s22 offen offset:1024
  s_waitcnt lgkmcnt(4)
  v_mfma_f32_16x16x32_bf16 v[28:31], v[116:119], v[64:67], v[28:31]
  ds_read_b128 v[96:99], v11 offset:11264
  s_waitcnt lgkmcnt(4)
  v_mfma_f32_16x16x32_bf16 v[32:35], v[120:123], v[64:67], v[32:35]
  ds_read_b128 v[100:103], v11 offset:12288
  s_waitcnt lgkmcnt(4)
  v_mfma_f32_16x16x32_bf16 v[36:39], v[124:127], v[64:67], v[36:39]
  ds_read_b128 v[104:107], v11 offset:13312
  s_waitcnt lgkmcnt(4)
  v_mfma_f32_16x16x32_bf16 v[40:43], v[128:131], v[64:67], v[40:43]
  ds_read_b128 v[108:111], v11 offset:14336
  s_waitcnt lgkmcnt(4)
  v_mfma_f32_16x16x32_bf16 v[24:27], v[92:95], v[68:71], v[24:27]
  ds_read_b128 v[112:115], v11 offset:15360
  buffer_load_dwordx4 v[52:55], v10, s[8:11], s22 offen offset:2048
  s_waitcnt lgkmcnt(4)
  v_mfma_f32_16x16x32_bf16 v[28:31], v[96:99], v[68:71], v[28:31]
  ds_read_b128 v[116:119], v11 offset:16384
  s_waitcnt lgkmcnt(4)
  v_mfma_f32_16x16x32_bf16 v[32:35], v[100:103], v[68:71], v[32:35]
  ds_read_b128 v[120:123], v11 offset:17408
  s_waitcnt lgkmcnt(4)
  v_mfma_f32_16x16x32_bf16 v[36:39], v[104:107], v[68:71], v[36:39]
  ds_read_b128 v[124:127], v11 offset:18432
  s_waitcnt lgkmcnt(4)
  v_mfma_f32_16x16x32_bf16 v[40:43], v[108:111], v[68:71], v[40:43]
  ds_read_b128 v[128:131], v11 offset:19456
  s_waitcnt vmcnt(8) lgkmcnt(0)
  s_barrier
  s_waitcnt lgkmcnt(4)
  v_mfma_f32_16x16x32_bf16 v[24:27], v[112:115], v[72:75], v[24:27]
  ds_read_b128 v[92:95], v11 offset:20480
  s_waitcnt lgkmcnt(4)
  v_mfma_f32_16x16x32_bf16 v[28:31], v[116:119], v[72:75], v[28:31]
  ds_read_b128 v[96:99], v11 offset:21504
  s_waitcnt lgkmcnt(4)
  v_mfma_f32_16x16x32_bf16 v[32:35], v[120:123], v[72:75], v[32:35]
  ds_read_b128 v[100:103], v11 offset:22528
  s_waitcnt lgkmcnt(4)
  v_mfma_f32_16x16x32_bf16 v[36:39], v[124:127], v[72:75], v[36:39]
  ds_read_b128 v[104:107], v11 offset:23552
  s_waitcnt lgkmcnt(4)
  v_mfma_f32_16x16x32_bf16 v[40:43], v[128:131], v[72:75], v[40:43]
  ds_read_b128 v[108:111], v11 offset:24576
  s_waitcnt lgkmcnt(4)
  v_mfma_f32_16x16x32_bf16 v[24:27], v[92:95], v[76:79], v[24:27]
  ds_read_b128 v[112:115], v11 offset:25600
  s_waitcnt lgkmcnt(4)
  v_mfma_f32_16x16x32_bf16 v[28:31], v[96:99], v[76:79], v[28:31]
  ds_read_b128 v[116:119], v11 offset:26624
  s_waitcnt lgkmcnt(4)
  v_mfma_f32_16x16x32_bf16 v[32:35], v[100:103], v[76:79], v[32:35]
  ds_read_b128 v[120:123], v11 offset:27648
  s_waitcnt lgkmcnt(4)
  v_mfma_f32_16x16x32_bf16 v[36:39], v[104:107], v[76:79], v[36:39]
  ds_read_b128 v[124:127], v11 offset:28672
  s_waitcnt lgkmcnt(4)
  v_mfma_f32_16x16x32_bf16 v[40:43], v[108:111], v[76:79], v[40:43]
  ds_read_b128 v[128:131], v11 offset:29696
  s_waitcnt lgkmcnt(4)
  v_mfma_f32_16x16x32_bf16 v[24:27], v[112:115], v[80:83], v[24:27]
  ds_read_b128 v[92:95], v11 offset:30720
  s_waitcnt lgkmcnt(4)
  v_mfma_f32_16x16x32_bf16 v[28:31], v[116:119], v[80:83], v[28:31]
  ds_read_b128 v[96:99], v11 offset:31744
  s_waitcnt lgkmcnt(4)
  v_mfma_f32_16x16x32_bf16 v[32:35], v[120:123], v[80:83], v[32:35]
  ds_read_b128 v[100:103], v11 offset:32768
  s_waitcnt lgkmcnt(4)
  v_mfma_f32_16x16x32_bf16 v[36:39], v[124:127], v[80:83], v[36:39]
  ds_read_b128 v[104:107], v11 offset:33792
  s_waitcnt lgkmcnt(4)
  v_mfma_f32_16x16x32_bf16 v[40:43], v[128:131], v[80:83], v[40:43]
  ds_read_b128 v[108:111], v11 offset:34816
  buffer_load_dwordx2 v[14:15], v8, s[32:35], s40 offen offset:0
  buffer_load_dwordx2 v[16:17], v8, s[32:35], s40 offen offset:1024
  buffer_load_dwordx2 v[18:19], v8, s[32:35], s40 offen offset:2048
  buffer_load_dwordx2 v[20:21], v8, s[32:35], s40 offen offset:3072
  buffer_load_dwordx2 v[22:23], v8, s[32:35], s42 offen
  s_waitcnt lgkmcnt(4)
  v_mfma_f32_16x16x32_bf16 v[24:27], v[92:95], v[84:87], v[24:27]
  ds_read_b128 v[112:115], v11 offset:35840
  s_waitcnt lgkmcnt(4)
  v_mfma_f32_16x16x32_bf16 v[28:31], v[96:99], v[84:87], v[28:31]
  ds_read_b128 v[116:119], v11 offset:36864
  s_waitcnt lgkmcnt(4)
  v_mfma_f32_16x16x32_bf16 v[32:35], v[100:103], v[84:87], v[32:35]
  ds_read_b128 v[120:123], v11 offset:37888
  s_waitcnt lgkmcnt(4)
  v_mfma_f32_16x16x32_bf16 v[36:39], v[104:107], v[84:87], v[36:39]
  ds_read_b128 v[124:127], v11 offset:38912
  s_waitcnt lgkmcnt(4)
  v_mfma_f32_16x16x32_bf16 v[40:43], v[108:111], v[84:87], v[40:43]
  ds_read_b128 v[128:131], v11 offset:39936
  s_waitcnt vmcnt(5) lgkmcnt(0)
  s_barrier
  s_waitcnt lgkmcnt(4)
  v_mfma_f32_16x16x32_bf16 v[24:27], v[112:115], v[88:91], v[24:27]
  ds_read_b128 v[92:95], v12 offset:0
  s_waitcnt lgkmcnt(4)
  v_mfma_f32_16x16x32_bf16 v[28:31], v[116:119], v[88:91], v[28:31]
  ds_read_b128 v[96:99], v12 offset:1024
  s_waitcnt lgkmcnt(4)
  v_mfma_f32_16x16x32_bf16 v[32:35], v[120:123], v[88:91], v[32:35]
  ds_read_b128 v[100:103], v12 offset:2048
  s_waitcnt lgkmcnt(4)
  v_mfma_f32_16x16x32_bf16 v[36:39], v[124:127], v[88:91], v[36:39]
  ds_read_b128 v[104:107], v12 offset:3072
  s_waitcnt lgkmcnt(4)
  v_mfma_f32_16x16x32_bf16 v[40:43], v[128:131], v[88:91], v[40:43]
  ds_read_b128 v[108:111], v12 offset:4096
  s_waitcnt lgkmcnt(4)
  v_mfma_f32_16x16x32_bf16 v[24:27], v[92:95], v[44:47], v[24:27]
  ds_read_b128 v[112:115], v12 offset:5120
  s_waitcnt lgkmcnt(4)
  v_mfma_f32_16x16x32_bf16 v[28:31], v[96:99], v[44:47], v[28:31]
  ds_read_b128 v[116:119], v12 offset:6144
  s_waitcnt lgkmcnt(4)
  v_mfma_f32_16x16x32_bf16 v[32:35], v[100:103], v[44:47], v[32:35]
  ds_read_b128 v[120:123], v12 offset:7168
  s_waitcnt lgkmcnt(4)
  v_mfma_f32_16x16x32_bf16 v[36:39], v[104:107], v[44:47], v[36:39]
  ds_read_b128 v[124:127], v12 offset:8192
  s_waitcnt lgkmcnt(4)
  v_mfma_f32_16x16x32_bf16 v[40:43], v[108:111], v[44:47], v[40:43]
  ds_read_b128 v[128:131], v12 offset:9216
  s_waitcnt lgkmcnt(4)
  v_mfma_f32_16x16x32_bf16 v[24:27], v[112:115], v[48:51], v[24:27]
  ds_read_b128 v[92:95], v12 offset:10240
  s_waitcnt lgkmcnt(4)
  v_mfma_f32_16x16x32_bf16 v[28:31], v[116:119], v[48:51], v[28:31]
  ds_read_b128 v[96:99], v12 offset:11264
  s_waitcnt lgkmcnt(4)
  v_mfma_f32_16x16x32_bf16 v[32:35], v[120:123], v[48:51], v[32:35]
  ds_read_b128 v[100:103], v12 offset:12288
  s_waitcnt lgkmcnt(4)
  v_mfma_f32_16x16x32_bf16 v[36:39], v[124:127], v[48:51], v[36:39]
  ds_read_b128 v[104:107], v12 offset:13312
  s_waitcnt lgkmcnt(4)
  v_mfma_f32_16x16x32_bf16 v[40:43], v[128:131], v[48:51], v[40:43]
  ds_read_b128 v[108:111], v12 offset:14336
  s_waitcnt lgkmcnt(4)
  v_mfma_f32_16x16x32_bf16 v[24:27], v[92:95], v[52:55], v[24:27]
  s_waitcnt lgkmcnt(3)
  v_mfma_f32_16x16x32_bf16 v[28:31], v[96:99], v[52:55], v[28:31]
  s_waitcnt lgkmcnt(2)
  v_mfma_f32_16x16x32_bf16 v[32:35], v[100:103], v[52:55], v[32:35]
  s_waitcnt lgkmcnt(1)
  v_mfma_f32_16x16x32_bf16 v[36:39], v[104:107], v[52:55], v[36:39]
  s_waitcnt lgkmcnt(0)
  v_mfma_f32_16x16x32_bf16 v[40:43], v[108:111], v[52:55], v[40:43]
  s_nop 7
  s_barrier
  s_mul_i32 s20, s19, 5120
  v_add_u32 v3, s20, v10
  s_cmp_eq_u32 s27, 0
  s_cbranch_scc1 L_down_kernel_wr_10
  ds_write_b128 v3, v[24:27] offset:0
  ds_write_b128 v3, v[28:31] offset:1024
  ds_write_b128 v3, v[32:35] offset:2048
  ds_write_b128 v3, v[36:39] offset:3072
  ds_write_b128 v3, v[40:43] offset:4096
  s_waitcnt lgkmcnt(0)
  s_barrier
  s_branch L_down_kernel_end_11
L_down_kernel_wr_10:
  s_barrier
  ds_read_b128 v[132:135], v3 offset:0
  ds_read_b128 v[136:139], v3 offset:1024
  ds_read_b128 v[140:143], v3 offset:2048
  ds_read_b128 v[144:147], v3 offset:3072
  ds_read_b128 v[148:151], v3 offset:4096
  s_waitcnt lgkmcnt(0)
  v_add_f32 v132, v132, v24
  v_add_f32 v133, v133, v25
  v_add_f32 v134, v134, v26
  v_add_f32 v135, v135, v27
  v_add_f32 v136, v136, v28
  v_add_f32 v137, v137, v29
  v_add_f32 v138, v138, v30
  v_add_f32 v139, v139, v31
  v_add_f32 v140, v140, v32
  v_add_f32 v141, v141, v33
  v_add_f32 v142, v142, v34
  v_add_f32 v143, v143, v35
  v_add_f32 v144, v144, v36
  v_add_f32 v145, v145, v37
  v_add_f32 v146, v146, v38
  v_add_f32 v147, v147, v39
  v_add_f32 v148, v148, v40
  v_add_f32 v149, v149, v41
  v_add_f32 v150, v150, v42
  v_add_f32 v151, v151, v43
  s_waitcnt vmcnt(0)
  v_lshlrev_b32 v152, 16, v14
  v_and_b32 v153, 0xffff0000, v14
  v_add_f32 v132, v132, v152
  v_add_f32 v133, v133, v153
  v_cvt_pk_bf16_f32 v14, v132, v133
  v_lshlrev_b32 v152, 16, v15
  v_and_b32 v153, 0xffff0000, v15
  v_add_f32 v134, v134, v152
  v_add_f32 v135, v135, v153
  v_cvt_pk_bf16_f32 v15, v134, v135
  v_lshlrev_b32 v152, 16, v16
  v_and_b32 v153, 0xffff0000, v16
  v_add_f32 v136, v136, v152
  v_add_f32 v137, v137, v153
  v_cvt_pk_bf16_f32 v16, v136, v137
  v_lshlrev_b32 v152, 16, v17
  v_and_b32 v153, 0xffff0000, v17
  v_add_f32 v138, v138, v152
  v_add_f32 v139, v139, v153
  v_cvt_pk_bf16_f32 v17, v138, v139
  v_lshlrev_b32 v152, 16, v18
  v_and_b32 v153, 0xffff0000, v18
  v_add_f32 v140, v140, v152
  v_add_f32 v141, v141, v153
  v_cvt_pk_bf16_f32 v18, v140, v141
  v_lshlrev_b32 v152, 16, v19
  v_and_b32 v153, 0xffff0000, v19
  v_add_f32 v142, v142, v152
  v_add_f32 v143, v143, v153
  v_cvt_pk_bf16_f32 v19, v142, v143
  v_lshlrev_b32 v152, 16, v20
  v_and_b32 v153, 0xffff0000, v20
  v_add_f32 v144, v144, v152
  v_add_f32 v145, v145, v153
  v_cvt_pk_bf16_f32 v20, v144, v145
  v_lshlrev_b32 v152, 16, v21
  v_and_b32 v153, 0xffff0000, v21
  v_add_f32 v146, v146, v152
  v_add_f32 v147, v147, v153
  v_cvt_pk_bf16_f32 v21, v146, v147
  v_lshlrev_b32 v152, 16, v22
  v_and_b32 v153, 0xffff0000, v22
  v_add_f32 v148, v148, v152
  v_add_f32 v149, v149, v153
  v_cvt_pk_bf16_f32 v22, v148, v149
  v_lshlrev_b32 v152, 16, v23
  v_and_b32 v153, 0xffff0000, v23
  v_add_f32 v150, v150, v152
  v_add_f32 v151, v151, v153
  v_cvt_pk_bf16_f32 v23, v150, v151
  buffer_store_dwordx2 v[14:15], v9, s[36:39], s41 offen offset:0 sc1
  buffer_store_dwordx2 v[16:17], v9, s[36:39], s41 offen offset:32 sc1
  buffer_store_dwordx2 v[18:19], v9, s[36:39], s41 offen offset:64 sc1
  buffer_store_dwordx2 v[20:21], v9, s[36:39], s41 offen offset:96 sc1
  buffer_store_dwordx2 v[22:23], v9, s[36:39], s41 offen offset:128 sc1
L_down_kernel_end_11:
L_down_kernel_done_1:
  s_endpgm
down_kernel_end:

sequential_preLN__softmax_full_mha__glu_gated_swiglu__prompt_kernel_end:

.section .rodata,"a"
.p2align 6
.amdhsa_kernel sequential_preLN__softmax_full_mha__glu_gated_swiglu__prompt_kernel
  .amdhsa_next_free_vgpr 256
  .amdhsa_next_free_sgpr 102
  .amdhsa_accum_offset 256
  .amdhsa_group_segment_fixed_size 0
  .amdhsa_kernarg_size 80
  .amdhsa_user_sgpr_count 2
  .amdhsa_user_sgpr_kernarg_segment_ptr 1
  .amdhsa_system_sgpr_workgroup_id_x 1
  .amdhsa_float_denorm_mode_32 3
  .amdhsa_float_denorm_mode_16_64 3
.end_amdhsa_kernel
```
